```python
import torch

def _softmax(x, axis=-1):
    return torch.softmax(x, dim=axis)

def _gelu(x):
    return torch.nn.functional.gelu(x, approximate='tanh')

def _silu(x):
    return torch.nn.functional.silu(x)

def _sigmoid(x):
    return torch.sigmoid(x)

def _layernorm(x, axis=-1, eps=1e-05):
    m = x.mean(dim=axis, keepdim=True)
    v = x.var(dim=axis, keepdim=True, unbiased=False)
    return (x - m) / torch.sqrt(v + eps)

def _scatter_add(tgt, idx, src, axis=0):
    return tgt.clone().index_add_(axis, idx, src)

def _segment_sum(src, seg, n):
    out = torch.zeros((n,) + src.shape[1:], dtype=src.dtype)
    return out.index_add_(0, seg, src)

def _pad(x, pw):
    flat = tuple((v for pair in reversed(pw) for v in pair))
    return torch.nn.functional.pad(x, flat)
kernel_name = 'adaLN_cond__ssm_conv_s4__glu_gated_reglu__prompt'

def setup_inputs():

    _w = lambda a: (lambda t: t.to(torch.bfloat16) if t.is_floating_point() else t)(torch.as_tensor(a))

    def _A_setup():
        B, L, D, N = (1, 2048, 576, 128)
        A_re = -(lambda _x: torch.exp(torch.as_tensor(_x)))((lambda *s: torch.randn(*s, dtype=torch.bfloat16) * 3.2)(D, N))
        A_im = torch.pi * (lambda *s: torch.randn(*s, dtype=torch.bfloat16) * 0.05)(D, N)
        B_re = (lambda *s: torch.randn(*s, dtype=torch.bfloat16) * 0.1)(D, N)
        B_im = (lambda *s: torch.randn(*s, dtype=torch.bfloat16) * 0.1)(D, N)
        C_re = (lambda *s: torch.randn(*s, dtype=torch.bfloat16) * 0.1)(D, N)
        C_im = (lambda *s: torch.randn(*s, dtype=torch.bfloat16) * 0.1)(D, N)
        log_dt = (lambda *s: torch.randn(*s, dtype=torch.bfloat16) * 0.05)(D) * 0.5 - 4.0
        Dskip = (lambda *s: torch.randn(*s, dtype=torch.bfloat16) * 0.05)(D)
        return {'u': _w((lambda *s: torch.randn(*s, dtype=torch.bfloat16) * 0.05)(B, L, D)), 'A_re': _w(A_re), 'A_im': _w(A_im), 'B_re': _w(B_re), 'B_im': _w(B_im), 'C_re': _w(C_re), 'C_im': _w(C_im), 'log_dt': _w(log_dt), 'Dskip': _w(Dskip)}
    _A_in = _A_setup()

    def _B_setup():
        B, S, D, F = (1, 2048, 576, 4608)
        return {'x': _w((lambda *s: torch.randn(*s, dtype=torch.bfloat16) * 0.05)(B, S, D)), 'W_gate': _w((lambda *s: torch.randn(*s, dtype=torch.bfloat16) * 0.8)(D, F) * (2.0 / D) ** 0.5), 'W_up': _w((lambda *s: torch.randn(*s, dtype=torch.bfloat16) * 0.8)(D, F) * (2.0 / D) ** 0.5), 'W_down': _w((lambda *s: torch.randn(*s, dtype=torch.bfloat16) * 0.8)(F, D) * (1.0 / F) ** 0.5)}
    _B_in = _B_setup()
    return {'A_u': _A_in['u'], 'A_A_re': _A_in['A_re'], 'A_A_im': _A_in['A_im'], 'A_B_re': _A_in['B_re'], 'A_B_im': _A_in['B_im'], 'A_C_re': _A_in['C_re'], 'A_C_im': _A_in['C_im'], 'A_log_dt': _A_in['log_dt'], 'A_Dskip': _A_in['Dskip'], 'B_x': _B_in['x'], 'B_W_gate': _B_in['W_gate'], 'B_W_up': _B_in['W_up'], 'B_W_down': _B_in['W_down'], 'c': _w((lambda *s: torch.randn(*s, dtype=torch.bfloat16) * 0.2)(1, 576) * 8.0), 'w_mod': _w((lambda *s: torch.randn(*s, dtype=torch.bfloat16) * 0.2)(576, 6 * 576) * 576 ** (-0.5) * 8.0)}

def reference(A_u, A_A_re, A_A_im, A_B_re, A_B_im, A_C_re, A_C_im, A_log_dt, A_Dskip, B_x, B_W_gate, B_W_up, B_W_down, c, w_mod):

    def _A_ref(u, A_re, A_im, B_re, B_im, C_re, C_im, log_dt, Dskip):
        Bsz, L, D = u.shape
        dt = torch.exp(log_dt)[:, None]
        A = A_re + 1j * A_im
        Bc = B_re + 1j * B_im
        Cc = C_re + 1j * C_im
        logdA = dt * A
        dB = dt * Bc
        l = (lambda x, dt: x.to(dt))(torch.arange(L), A_re.dtype)
        P = torch.exp(logdA[:, :, None] * l[None, None, :])
        K = torch.einsum('dn,dnl,dn->dl', Cc, P, dB).real
        L2 = 2 * L
        Kp = _pad(K, ((0, 0), (0, L)))
        up = (lambda x, *d: x.permute(*d))(u, 0, 2, 1)
        up = _pad(up, ((0, 0), (0, 0), (0, L)))
        Kf = (lambda x, axes=(-2, -1): torch.fft.rfft2(x.float(), dim=axes))(Kp[:, None, :], axes=(-2, -1))
        Uf = (lambda x, axes=(-2, -1): torch.fft.rfft2(x.float(), dim=axes))(up[:, :, None, :], axes=(-2, -1))
        Yf = Uf * Kf[None, :, :, :]
        y = (lambda x, s, axes=(-2, -1): torch.fft.irfft2(x, s=s, dim=axes).to(torch.bfloat16))(Yf, (1, L2), axes=(-2, -1))[:, :, 0, :L]
        y = (lambda x, *d: x.permute(*d))(y, 0, 2, 1) + u * Dskip[None, None, :]
        return y

    def _B_ref(x, W_gate, W_up, W_down):
        gate = torch.einsum('bsd,df->bsf', x, W_gate)
        up = torch.einsum('bsd,df->bsf', x, W_up)
        gate = gate * (lambda x, dt: x.to(dt))(gate > 0, gate.dtype)
        h = gate * up
        return torch.einsum('bsf,fd->bsd', h, W_down)
    x = A_u
    mod = (_silu(c) @ w_mod).reshape(c.shape[0], 6, 1, -1)
    sa, ca, ga, sb, cb, gb = (mod[:, 0].clone(), mod[:, 1].clone(), mod[:, 2].clone(), mod[:, 3].clone(), mod[:, 4].clone(), mod[:, 5].clone())
    h = _layernorm(x, axis=-1) * (1 + ca) + sa
    x = x + ga * _A_ref(h, A_A_re, A_A_im, A_B_re, A_B_im, A_C_re, A_C_im, A_log_dt, A_Dskip)
    h = _layernorm(x, axis=-1) * (1 + cb) + sb
    x = x + gb * _B_ref(h, B_W_gate, B_W_up, B_W_down)
    return x
```

```asm
; @launch grid=(256,1,1) block=(256,1,1) lds=163840
.amdgcn_target "amdgcn-amd-amdhsa--gfx950"
.text
.globl adaLN_cond__ssm_conv_s4__glu_gated_reglu__prompt_kernel
.p2align 8
.type adaLN_cond__ssm_conv_s4__glu_gated_reglu__prompt_kernel,@function
adaLN_cond__ssm_conv_s4__glu_gated_reglu__prompt_kernel:
    s_load_dwordx16 s[48:63], s[0:1], 8
    s_load_dwordx2 s[36:37], s[0:1], 0
    s_load_dwordx4 s[64:67], s[0:1], 104
    s_load_dwordx2 s[28:29], s[0:1], 136
    s_load_dwordx2 s[20:21], s[0:1], 80
    s_load_dwordx2 s[24:25], s[0:1], 88
    s_load_dwordx2 s[32:33], s[0:1], 120
    s_cmp_ge_u32 s2, 256
    s_cbranch_scc1 KB_EXIT
    s_cmp_lt_u32 s2, 248
    s_cbranch_scc1 NOPF
    s_getpc_b64 s[4:5]
PC0:
    v_lshlrev_b32 v1, 7, v0
    v_min_u32 v2, CODE_END-PC0-4, v1
    global_load_dword v250, v2, s[4:5]
    v_add_u32 v1, 0x8000, v1
    v_min_u32 v2, CODE_END-PC0-4, v1
    global_load_dword v251, v2, s[4:5]
NOPF:
    v_lshrrev_b32 v1, 6, v0
    s_nop 0
    v_readfirstlane_b32 s3, v1
    v_and_b32 v0, 63, v0
    v_lshlrev_b32 v1, 4, v0
    s_mov_b32 s22, 5308416
    s_mov_b32 s23, 0x00020000
    s_mov_b32 s26, 5309440
    s_mov_b32 s27, 0x00020000
    s_mov_b32 s30, 67108864
    s_mov_b32 s31, 0x00020000
    s_mov_b32 s34, 2359296
    s_mov_b32 s35, 0x00020000
    s_and_b32 s11, s2, 7
    s_bfe_u32 s12, s2, 0x20003
    s_mul_i32 s44, s11, 1152
    s_lshl_b32 s12, s12, 1
    s_sub_u32 s13, 3, s11
    s_and_b32 s13, s13, 7
    s_cselect_b32 s13, s13, 8
    s_cmp_ge_u32 s12, s13
    s_addc_u32 s12, s12, 0
    s_lshl_b32 s12, s12, 7
    s_add_u32 s44, s44, s12
    s_lshl_b32 s46, s3, 11
    s_cmp_ge_u32 s2, 144
    s_cbranch_scc1 KB_SIDE
    s_and_b32 s14, s2, 7
    s_mul_i32 s14, s14, 18
    s_lshr_b32 s16, s2, 3
    s_add_u32 s14, s14, s16
    s_lshl_b32 s13, s14, 2
    s_add_u32 s13, s13, s3
    s_mul_i32 s5, s3, 21376
    v_mul_u32_u24 v141, 9216, v0
    s_mul_i32 s9, s3, 589824
    s_lshl_b32 s16, s14, 3
    s_add_u32 s9, s9, s16
    s_add_u32 s10, s9, 4608
    s_mov_b32 s38, 2359296
    s_mov_b32 s39, 0x00020000
    s_lshl_b32 s16, s13, 8
    v_lshl_add_u32 v2, v0, 2, s16
    s_lshl_b32 s16, s13, 1
    v_mov_b32 v7, s16
    v_and_b32 v3, 15, v0
    v_bfe_u32 v4, v0, 4, 2
    s_waitcnt lgkmcnt(0)
    global_load_ushort v14, v7, s[60:61]
    global_load_ushort v15, v7, s[62:63]
    global_load_dword v8, v2, s[48:49] nt
    global_load_dword v9, v2, s[50:51] nt
    global_load_dword v10, v2, s[52:53] nt
    global_load_dword v11, v2, s[54:55] nt
    global_load_dword v12, v2, s[56:57] nt
    global_load_dword v13, v2, s[58:59] nt
    v_and_b32 v140, 1, v0
    v_mul_u32_u24 v140, 201728, v140
    v_lshlrev_b32 v140, 8, v140
    v_add_u32 v140, 524288, v140
    global_load_dword v140, v140, s[28:29]
    buffer_load_dwordx2 v[160:161], v141, s[36:39], s9 offen offset:0
    buffer_load_dwordx2 v[162:163], v141, s[36:39], s9 offen offset:1152
    s_sub_u32 s24, s24, 1024
    s_subb_u32 s25, s25, 0
    s_add_u32 s16, s5, 12928
    v_lshl_add_u32 v136, v0, 3, s16
    v_add_u32 v137, 2112, v136
    v_add_u32 v138, 4224, v136
    v_add_u32 v139, 6336, v136
    v_mul_u32_u24 v5, 528, v3
    v_add_u32 v5, s16, v5
    v_lshl_add_u32 v5, v4, 4, v5
    v_lshrrev_b32 v100, 1, v4
    v_lshlrev_b32 v100, 8, v100
    v_and_b32 v101, 1, v4
    v_lshl_add_u32 v100, v101, 3, v100
    v_lshl_add_u32 v100, v3, 4, v100
    v_add_u32 v100, s16, v100
    v_lshrrev_b32 v101, 1, v4
    v_sub_u32 v102, 3, v101
    v_lshlrev_b32 v102, v102, v3
    v_lshl_add_u32 v102, v4, 7, v102
    v_add_u32 v102, s16, v102
    v_mul_u32_u24 v101, 60, v101
    v_add_u32 v101, v101, v102
    v_lshlrev_b32 v103, 5, v3
    v_lshl_add_u32 v103, v4, 3, v103
    v_add_u32 v103, s16, v103
    v_lshl_add_u32 v224, v0, 3, s5
    v_lshl_add_u32 v225, v0, 2, s16
    v_add_u32 v225, 512, v225
    v_add_u32 v226, s5, v1
    v_lshl_add_u32 v227, v0, 5, s5
    v_mov_b32 v152, 0
    v_mov_b32 v153, 0
    ds_write_b64 v224, v[152:153] offset:4096
    v_bfe_u32 v248, v0, 2, 1
    v_mul_u32_u24 v248, 4160, v248
    v_and_b32 v154, 3, v0
    v_lshl_add_u32 v248, v154, 3, v248
    v_add_u32 v248, s5, v248
    s_lshl_b32 s17, s14, 5
    s_add_u32 s17, s17, 131072
    v_lshl_add_u32 v249, v154, 3, s17
    v_bfe_u32 v154, v0, 2, 1
    v_mul_u32_u24 v155, 4608, v154
    v_add_u32 v249, v249, v155
    v_cvt_f32_u32 v250, v154
    v_lshrrev_b32 v154, 3, v0
    v_lshl_add_u32 v249, v154, 14, v249
    s_lshl_b32 s18, s3, 12
    s_add_u32 s18, s18, 589824
    s_sub_u32 s17, 3, s3
    s_lshl_b32 s17, s17, 10
    s_add_u32 s17, s17, 1008
    v_sub_u32 v251, s17, v1
    v_lshlrev_b32 v154, 5, v3
    v_sub_u32 v154, s5, v154
    v_lshl_add_u32 v252, v4, 4, v154
    v_add_u32 v252, 480, v252
    v_add_u32 v154, 1, v3
    v_and_b32 v155, 1, v154
    v_mul_u32_u24 v155, 4158, v155
    v_lshl_add_u32 v253, v154, 1, v155
    v_lshl_add_u32 v253, v4, 4, v253
    v_add_u32 v253, s5, v253
    v_add_u32 v253, 4608, v253
    ds_write_b64 v224, v[152:153] offset:6688
    ds_write_b64 v224, v[152:153] offset:10848
    v_lshl_add_u32 v154, v4, 3, v3
    s_mov_b32 s19, 0x10001
    s_movk_i32 s15, 0x3f80
    s_mov_b32 s6, 133169152
    s_mov_b32 s7, 0
    v_lshrrev_b64 v[156:157], v154, s[6:7]
    v_bfe_u32 v155, v156, 0, 2
    v_lshl_or_b32 v155, v155, 15, v155
    v_and_b32 v155, s19, v155
    v_mul_u32_u24 v155, s15, v155
    v_accvgpr_write_b32 a0, v155
    v_bfe_u32 v155, v156, 2, 2
    v_lshl_or_b32 v155, v155, 15, v155
    v_and_b32 v155, s19, v155
    v_mul_u32_u24 v155, s15, v155
    v_accvgpr_write_b32 a1, v155
    v_bfe_u32 v155, v156, 4, 2
    v_lshl_or_b32 v155, v155, 15, v155
    v_and_b32 v155, s19, v155
    v_mul_u32_u24 v155, s15, v155
    v_accvgpr_write_b32 a2, v155
    v_bfe_u32 v155, v156, 6, 2
    v_lshl_or_b32 v155, v155, 15, v155
    v_and_b32 v155, s19, v155
    v_mul_u32_u24 v155, s15, v155
    v_accvgpr_write_b32 a3, v155
    s_mov_b32 s6, 4160749568
    s_mov_b32 s7, 15
    v_lshrrev_b64 v[156:157], v154, s[6:7]
    v_bfe_u32 v155, v156, 0, 2
    v_lshl_or_b32 v155, v155, 15, v155
    v_and_b32 v155, s19, v155
    v_mul_u32_u24 v155, s15, v155
    v_accvgpr_write_b32 a4, v155
    v_bfe_u32 v155, v156, 2, 2
    v_lshl_or_b32 v155, v155, 15, v155
    v_and_b32 v155, s19, v155
    v_mul_u32_u24 v155, s15, v155
    v_accvgpr_write_b32 a5, v155
    v_bfe_u32 v155, v156, 4, 2
    v_lshl_or_b32 v155, v155, 15, v155
    v_and_b32 v155, s19, v155
    v_mul_u32_u24 v155, s15, v155
    v_accvgpr_write_b32 a6, v155
    v_bfe_u32 v155, v156, 6, 2
    v_lshl_or_b32 v155, v155, 15, v155
    v_and_b32 v155, s19, v155
    v_mul_u32_u24 v155, s15, v155
    v_accvgpr_write_b32 a7, v155
    s_mov_b32 s6, 15
    s_mov_b32 s7, 0
    v_lshrrev_b64 v[156:157], v154, s[6:7]
    v_bfe_u32 v155, v156, 0, 2
    v_lshl_or_b32 v155, v155, 15, v155
    v_and_b32 v155, s19, v155
    v_mul_u32_u24 v155, s15, v155
    v_accvgpr_write_b32 a8, v155
    v_bfe_u32 v155, v156, 2, 2
    v_lshl_or_b32 v155, v155, 15, v155
    v_and_b32 v155, s19, v155
    v_mul_u32_u24 v155, s15, v155
    v_accvgpr_write_b32 a9, v155
    v_bfe_u32 v155, v156, 4, 2
    v_lshl_or_b32 v155, v155, 15, v155
    v_and_b32 v155, s19, v155
    v_mul_u32_u24 v155, s15, v155
    v_accvgpr_write_b32 a10, v155
    v_bfe_u32 v155, v156, 6, 2
    v_lshl_or_b32 v155, v155, 15, v155
    v_and_b32 v155, s19, v155
    v_mul_u32_u24 v155, s15, v155
    v_accvgpr_write_b32 a11, v155
    v_lshl_add_u32 v158, v0, 2, s5
    v_lshlrev_b32 v159, 2, v4
    v_sub_u32 v159, v3, v159
    v_lshl_add_u32 v159, v159, 2, s5
    v_add_u32 v159, 6932, v159
    s_mov_b32 s43, 0xffff0000
    s_mov_b32 s41, 1069066811
    s_mov_b32 s42, 1042479491
    s_waitcnt vmcnt(9)
    v_lshlrev_b32 v14, 16, v14
    v_mul_f32 v14, s41, v14
    v_exp_f32 v14, v14
    s_nop 0
    v_cvt_pk_bf16_f32 v14, v14, v14
    v_lshlrev_b32 v14, 16, v14
    v_lshlrev_b32 v15, 16, v15
    v_cmp_eq_u32 vcc, 0, v0
    v_mov_b32 v89, 0
    v_mov_b32 v90, 0
    v_mov_b32 v91, 0
    v_cndmask_b32 v88, 0, v15, vcc
    v_mul_f32 v16, s41, v14
    v_mul_f32 v17, s42, v14
    s_waitcnt vmcnt(3)
    buffer_load_dwordx2 v[164:165], v141, s[36:39], s9 offen offset:2304
    v_lshlrev_b32 v18, 16, v8
    v_and_b32 v19, s43, v8
    v_lshlrev_b32 v20, 16, v9
    v_and_b32 v21, s43, v9
    v_lshlrev_b32 v22, 16, v10
    v_and_b32 v23, s43, v10
    v_lshlrev_b32 v24, 16, v11
    v_and_b32 v25, s43, v11
    v_lshlrev_b32 v26, 16, v12
    v_and_b32 v27, s43, v12
    v_lshlrev_b32 v28, 16, v13
    v_and_b32 v29, s43, v13
    v_pk_mul_f32 v[18:19], v[18:19], v[16:17] op_sel_hi:[1,0]
    v_pk_mul_f32 v[20:21], v[20:21], v[16:17] op_sel:[0,1] op_sel_hi:[1,1]
    v_pk_mul_f32 v[22:23], v[22:23], v[14:15] op_sel_hi:[1,0]
    v_pk_mul_f32 v[24:25], v[24:25], v[14:15] op_sel_hi:[1,0]
    v_pk_mul_f32 v[8:9], v[24:25], v[28:29]
    v_pk_mul_f32 v[10:11], v[24:25], v[26:27]
    v_pk_fma_f32 v[32:33], v[22:23], v[28:29], v[10:11]
    v_pk_fma_f32 v[30:31], v[22:23], v[26:27], v[8:9] neg_lo:[0,0,1] neg_hi:[0,0,1]
    s_mov_b32 s16, 1090519040
    v_mul_f32 v8, s16, v18
    v_mul_f32 v9, s16, v19
    v_mul_f32 v10, s16, v20
    v_mul_f32 v11, s16, v21
    v_exp_f32 v8, v8
    v_exp_f32 v9, v9
    v_fract_f32 v10, v10
    v_fract_f32 v11, v11
    v_cos_f32 v38, v10
    v_cos_f32 v39, v11
    v_sin_f32 v40, v10
    v_sin_f32 v41, v11
    v_pk_mul_f32 v[38:39], v[38:39], v[8:9]
    v_pk_mul_f32 v[40:41], v[40:41], v[8:9]
    v_exp_f32 v8, v18
    v_exp_f32 v9, v19
    v_fract_f32 v10, v20
    v_fract_f32 v11, v21
    v_cos_f32 v34, v10
    v_cos_f32 v35, v11
    v_sin_f32 v36, v10
    v_sin_f32 v37, v11
    v_pk_mul_f32 v[34:35], v[34:35], v[8:9]
    v_pk_mul_f32 v[36:37], v[36:37], v[8:9]
    s_mov_b32 s16, 1124073472
    v_mul_f32 v8, s16, v18
    v_mul_f32 v9, s16, v19
    v_mul_f32 v10, s16, v20
    v_mul_f32 v11, s16, v21
    v_exp_f32 v8, v8
    v_exp_f32 v9, v9
    v_fract_f32 v10, v10
    v_fract_f32 v11, v11
    v_cos_f32 v42, v10
    v_cos_f32 v43, v11
    v_sin_f32 v44, v10
    v_sin_f32 v45, v11
    v_pk_mul_f32 v[42:43], v[42:43], v[8:9]
    v_pk_mul_f32 v[44:45], v[44:45], v[8:9]
    v_cvt_pk_bf16_f32 v144, v30, v31
    v_cvt_pk_bf16_f32 v145, -v32, -v33
    v_pk_mul_f32 v[8:9], v[32:33], v[40:41]
    v_pk_mul_f32 v[10:11], v[32:33], v[38:39]
    v_pk_fma_f32 v[32:33], v[30:31], v[40:41], v[10:11]
    v_pk_fma_f32 v[30:31], v[30:31], v[38:39], v[8:9] neg_lo:[0,0,1] neg_hi:[0,0,1]
    v_cvt_pk_bf16_f32 v146, v30, v31
    v_cvt_pk_bf16_f32 v147, -v32, -v33
    ds_write2_b64 v136, v[144:145], v[146:147] offset0:0 offset1:66
    v_pk_mul_f32 v[8:9], v[32:33], v[40:41]
    v_pk_mul_f32 v[10:11], v[32:33], v[38:39]
    v_pk_fma_f32 v[32:33], v[30:31], v[40:41], v[10:11]
    v_pk_fma_f32 v[30:31], v[30:31], v[38:39], v[8:9] neg_lo:[0,0,1] neg_hi:[0,0,1]
    v_cvt_pk_bf16_f32 v148, v30, v31
    v_cvt_pk_bf16_f32 v149, -v32, -v33
    v_pk_mul_f32 v[8:9], v[32:33], v[40:41]
    v_pk_mul_f32 v[10:11], v[32:33], v[38:39]
    v_pk_fma_f32 v[32:33], v[30:31], v[40:41], v[10:11]
    v_pk_fma_f32 v[30:31], v[30:31], v[38:39], v[8:9] neg_lo:[0,0,1] neg_hi:[0,0,1]
    v_cvt_pk_bf16_f32 v150, v30, v31
    v_cvt_pk_bf16_f32 v151, -v32, -v33
    ds_write2_b64 v136, v[148:149], v[150:151] offset0:132 offset1:198
    v_pk_mul_f32 v[8:9], v[32:33], v[40:41]
    v_pk_mul_f32 v[10:11], v[32:33], v[38:39]
    v_pk_fma_f32 v[32:33], v[30:31], v[40:41], v[10:11]
    v_pk_fma_f32 v[30:31], v[30:31], v[38:39], v[8:9] neg_lo:[0,0,1] neg_hi:[0,0,1]
    v_cvt_pk_bf16_f32 v144, v30, v31
    v_cvt_pk_bf16_f32 v145, -v32, -v33
    v_pk_mul_f32 v[8:9], v[32:33], v[40:41]
    v_pk_mul_f32 v[10:11], v[32:33], v[38:39]
    v_pk_fma_f32 v[32:33], v[30:31], v[40:41], v[10:11]
    v_pk_fma_f32 v[30:31], v[30:31], v[38:39], v[8:9] neg_lo:[0,0,1] neg_hi:[0,0,1]
    v_cvt_pk_bf16_f32 v146, v30, v31
    v_cvt_pk_bf16_f32 v147, -v32, -v33
    ds_write2_b64 v137, v[144:145], v[146:147] offset0:0 offset1:66
    v_pk_mul_f32 v[8:9], v[32:33], v[40:41]
    v_pk_mul_f32 v[10:11], v[32:33], v[38:39]
    v_pk_fma_f32 v[32:33], v[30:31], v[40:41], v[10:11]
    v_pk_fma_f32 v[30:31], v[30:31], v[38:39], v[8:9] neg_lo:[0,0,1] neg_hi:[0,0,1]
    v_cvt_pk_bf16_f32 v148, v30, v31
    v_cvt_pk_bf16_f32 v149, -v32, -v33
    v_pk_mul_f32 v[8:9], v[32:33], v[40:41]
    v_pk_mul_f32 v[10:11], v[32:33], v[38:39]
    v_pk_fma_f32 v[32:33], v[30:31], v[40:41], v[10:11]
    v_pk_fma_f32 v[30:31], v[30:31], v[38:39], v[8:9] neg_lo:[0,0,1] neg_hi:[0,0,1]
    v_cvt_pk_bf16_f32 v150, v30, v31
    v_cvt_pk_bf16_f32 v151, -v32, -v33
    ds_write2_b64 v137, v[148:149], v[150:151] offset0:132 offset1:198
    v_pk_mul_f32 v[8:9], v[32:33], v[40:41]
    v_pk_mul_f32 v[10:11], v[32:33], v[38:39]
    v_pk_fma_f32 v[32:33], v[30:31], v[40:41], v[10:11]
    v_pk_fma_f32 v[30:31], v[30:31], v[38:39], v[8:9] neg_lo:[0,0,1] neg_hi:[0,0,1]
    buffer_load_dwordx2 v[166:167], v141, s[36:39], s9 offen offset:3456
    v_cvt_pk_bf16_f32 v144, v30, v31
    v_cvt_pk_bf16_f32 v145, -v32, -v33
    v_pk_mul_f32 v[8:9], v[32:33], v[40:41]
    v_pk_mul_f32 v[10:11], v[32:33], v[38:39]
    v_pk_fma_f32 v[32:33], v[30:31], v[40:41], v[10:11]
    v_pk_fma_f32 v[30:31], v[30:31], v[38:39], v[8:9] neg_lo:[0,0,1] neg_hi:[0,0,1]
    v_cvt_pk_bf16_f32 v146, v30, v31
    v_cvt_pk_bf16_f32 v147, -v32, -v33
    ds_write2_b64 v138, v[144:145], v[146:147] offset0:0 offset1:66
    v_pk_mul_f32 v[8:9], v[32:33], v[40:41]
    v_pk_mul_f32 v[10:11], v[32:33], v[38:39]
    v_pk_fma_f32 v[32:33], v[30:31], v[40:41], v[10:11]
    v_pk_fma_f32 v[30:31], v[30:31], v[38:39], v[8:9] neg_lo:[0,0,1] neg_hi:[0,0,1]
    v_cvt_pk_bf16_f32 v148, v30, v31
    v_cvt_pk_bf16_f32 v149, -v32, -v33
    v_pk_mul_f32 v[8:9], v[32:33], v[40:41]
    v_pk_mul_f32 v[10:11], v[32:33], v[38:39]
    v_pk_fma_f32 v[32:33], v[30:31], v[40:41], v[10:11]
    v_pk_fma_f32 v[30:31], v[30:31], v[38:39], v[8:9] neg_lo:[0,0,1] neg_hi:[0,0,1]
    v_cvt_pk_bf16_f32 v150, v30, v31
    v_cvt_pk_bf16_f32 v151, -v32, -v33
    ds_write2_b64 v138, v[148:149], v[150:151] offset0:132 offset1:198
    v_pk_mul_f32 v[8:9], v[32:33], v[40:41]
    v_pk_mul_f32 v[10:11], v[32:33], v[38:39]
    v_pk_fma_f32 v[32:33], v[30:31], v[40:41], v[10:11]
    v_pk_fma_f32 v[30:31], v[30:31], v[38:39], v[8:9] neg_lo:[0,0,1] neg_hi:[0,0,1]
    v_cvt_pk_bf16_f32 v144, v30, v31
    v_cvt_pk_bf16_f32 v145, -v32, -v33
    v_pk_mul_f32 v[8:9], v[32:33], v[40:41]
    v_pk_mul_f32 v[10:11], v[32:33], v[38:39]
    v_pk_fma_f32 v[32:33], v[30:31], v[40:41], v[10:11]
    v_pk_fma_f32 v[30:31], v[30:31], v[38:39], v[8:9] neg_lo:[0,0,1] neg_hi:[0,0,1]
    v_cvt_pk_bf16_f32 v146, v30, v31
    v_cvt_pk_bf16_f32 v147, -v32, -v33
    ds_write2_b64 v139, v[144:145], v[146:147] offset0:0 offset1:66
    v_pk_mul_f32 v[8:9], v[32:33], v[40:41]
    v_pk_mul_f32 v[10:11], v[32:33], v[38:39]
    v_pk_fma_f32 v[32:33], v[30:31], v[40:41], v[10:11]
    v_pk_fma_f32 v[30:31], v[30:31], v[38:39], v[8:9] neg_lo:[0,0,1] neg_hi:[0,0,1]
    v_cvt_pk_bf16_f32 v148, v30, v31
    v_cvt_pk_bf16_f32 v149, -v32, -v33
    v_pk_mul_f32 v[8:9], v[32:33], v[40:41]
    v_pk_mul_f32 v[10:11], v[32:33], v[38:39]
    v_pk_fma_f32 v[32:33], v[30:31], v[40:41], v[10:11]
    v_pk_fma_f32 v[30:31], v[30:31], v[38:39], v[8:9] neg_lo:[0,0,1] neg_hi:[0,0,1]
    v_cvt_pk_bf16_f32 v150, v30, v31
    v_cvt_pk_bf16_f32 v151, -v32, -v33
    ds_write2_b64 v139, v[148:149], v[150:151] offset0:132 offset1:198
    ds_read_b128 v[56:59], v5 offset:0
    ds_read_b128 v[60:63], v5 offset:64
    ds_read_b128 v[64:67], v5 offset:128
    ds_read_b128 v[68:71], v5 offset:192
    ds_read_b128 v[72:75], v5 offset:256
    ds_read_b128 v[76:79], v5 offset:320
    ds_read_b128 v[80:83], v5 offset:384
    ds_read_b128 v[84:87], v5 offset:448
    v_mov_b32 v144, 0x3f803f80
    v_mov_b32 v145, 0
    buffer_load_dwordx2 v[168:169], v141, s[36:39], s10 offen offset:0
    v_cvt_pk_bf16_f32 v146, v34, v35
    v_cvt_pk_bf16_f32 v147, v36, v37
    ds_write2_b64 v136, v[144:145], v[146:147] offset0:0 offset1:66
    v_pk_mul_f32 v[8:9], v[36:37], v[36:37]
    v_pk_mul_f32 v[10:11], v[36:37], v[34:35]
    v_pk_fma_f32 v[24:25], v[34:35], v[36:37], v[10:11]
    v_pk_fma_f32 v[22:23], v[34:35], v[34:35], v[8:9] neg_lo:[0,0,1] neg_hi:[0,0,1]
    v_cvt_pk_bf16_f32 v148, v22, v23
    v_cvt_pk_bf16_f32 v149, v24, v25
    v_pk_mul_f32 v[8:9], v[24:25], v[36:37]
    v_pk_mul_f32 v[10:11], v[24:25], v[34:35]
    v_pk_fma_f32 v[48:49], v[22:23], v[36:37], v[10:11]
    v_pk_fma_f32 v[46:47], v[22:23], v[34:35], v[8:9] neg_lo:[0,0,1] neg_hi:[0,0,1]
    v_cvt_pk_bf16_f32 v150, v46, v47
    v_cvt_pk_bf16_f32 v151, v48, v49
    ds_write2_b64 v136, v[148:149], v[150:151] offset0:132 offset1:198
    v_pk_mul_f32 v[8:9], v[48:49], v[36:37]
    v_pk_mul_f32 v[10:11], v[48:49], v[34:35]
    v_pk_fma_f32 v[28:29], v[46:47], v[36:37], v[10:11]
    v_pk_fma_f32 v[26:27], v[46:47], v[34:35], v[8:9] neg_lo:[0,0,1] neg_hi:[0,0,1]
    v_cvt_pk_bf16_f32 v144, v26, v27
    v_cvt_pk_bf16_f32 v145, v28, v29
    v_pk_mul_f32 v[8:9], v[28:29], v[36:37]
    v_pk_mul_f32 v[10:11], v[28:29], v[34:35]
    v_pk_fma_f32 v[48:49], v[26:27], v[36:37], v[10:11]
    v_pk_fma_f32 v[46:47], v[26:27], v[34:35], v[8:9] neg_lo:[0,0,1] neg_hi:[0,0,1]
    v_cvt_pk_bf16_f32 v146, v46, v47
    v_cvt_pk_bf16_f32 v147, v48, v49
    ds_write2_b64 v137, v[144:145], v[146:147] offset0:0 offset1:66
    v_pk_mul_f32 v[8:9], v[48:49], v[36:37]
    v_pk_mul_f32 v[10:11], v[48:49], v[34:35]
    v_pk_fma_f32 v[48:49], v[46:47], v[36:37], v[10:11]
    v_pk_fma_f32 v[46:47], v[46:47], v[34:35], v[8:9] neg_lo:[0,0,1] neg_hi:[0,0,1]
    v_cvt_pk_bf16_f32 v148, v46, v47
    v_cvt_pk_bf16_f32 v149, v48, v49
    v_pk_mul_f32 v[8:9], v[48:49], v[36:37]
    v_pk_mul_f32 v[10:11], v[48:49], v[34:35]
    v_pk_fma_f32 v[48:49], v[46:47], v[36:37], v[10:11]
    v_pk_fma_f32 v[46:47], v[46:47], v[34:35], v[8:9] neg_lo:[0,0,1] neg_hi:[0,0,1]
    v_cvt_pk_bf16_f32 v150, v46, v47
    v_cvt_pk_bf16_f32 v151, v48, v49
    ds_write2_b64 v137, v[148:149], v[150:151] offset0:132 offset1:198
    v_cvt_pk_bf16_f32 v144, v42, v43
    v_cvt_pk_bf16_f32 v145, v44, v45
    v_pk_mul_f32 v[8:9], v[44:45], v[36:37]
    v_pk_mul_f32 v[10:11], v[44:45], v[34:35]
    v_pk_fma_f32 v[48:49], v[42:43], v[36:37], v[10:11]
    v_pk_fma_f32 v[46:47], v[42:43], v[34:35], v[8:9] neg_lo:[0,0,1] neg_hi:[0,0,1]
    v_cvt_pk_bf16_f32 v146, v46, v47
    v_cvt_pk_bf16_f32 v147, v48, v49
    ds_write2_b64 v138, v[144:145], v[146:147] offset0:0 offset1:66
    v_pk_mul_f32 v[8:9], v[48:49], v[36:37]
    v_pk_mul_f32 v[10:11], v[48:49], v[34:35]
    v_pk_fma_f32 v[48:49], v[46:47], v[36:37], v[10:11]
    v_pk_fma_f32 v[46:47], v[46:47], v[34:35], v[8:9] neg_lo:[0,0,1] neg_hi:[0,0,1]
    buffer_load_dwordx2 v[170:171], v141, s[36:39], s10 offen offset:1152
    v_cvt_pk_bf16_f32 v148, v46, v47
    v_cvt_pk_bf16_f32 v149, v48, v49
    v_pk_mul_f32 v[8:9], v[48:49], v[36:37]
    v_pk_mul_f32 v[10:11], v[48:49], v[34:35]
    v_pk_fma_f32 v[48:49], v[46:47], v[36:37], v[10:11]
    v_pk_fma_f32 v[46:47], v[46:47], v[34:35], v[8:9] neg_lo:[0,0,1] neg_hi:[0,0,1]
    v_cvt_pk_bf16_f32 v150, v46, v47
    v_cvt_pk_bf16_f32 v151, v48, v49
    ds_write2_b64 v138, v[148:149], v[150:151] offset0:132 offset1:198
    v_pk_mul_f32 v[8:9], v[48:49], v[36:37]
    v_pk_mul_f32 v[10:11], v[48:49], v[34:35]
    v_pk_fma_f32 v[48:49], v[46:47], v[36:37], v[10:11]
    v_pk_fma_f32 v[46:47], v[46:47], v[34:35], v[8:9] neg_lo:[0,0,1] neg_hi:[0,0,1]
    v_cvt_pk_bf16_f32 v144, v46, v47
    v_cvt_pk_bf16_f32 v145, v48, v49
    v_pk_mul_f32 v[8:9], v[48:49], v[36:37]
    v_pk_mul_f32 v[10:11], v[48:49], v[34:35]
    v_pk_fma_f32 v[48:49], v[46:47], v[36:37], v[10:11]
    v_pk_fma_f32 v[46:47], v[46:47], v[34:35], v[8:9] neg_lo:[0,0,1] neg_hi:[0,0,1]
    v_cvt_pk_bf16_f32 v146, v46, v47
    v_cvt_pk_bf16_f32 v147, v48, v49
    ds_write2_b64 v139, v[144:145], v[146:147] offset0:0 offset1:66
    v_pk_mul_f32 v[8:9], v[48:49], v[36:37]
    v_pk_mul_f32 v[10:11], v[48:49], v[34:35]
    v_pk_fma_f32 v[48:49], v[46:47], v[36:37], v[10:11]
    v_pk_fma_f32 v[46:47], v[46:47], v[34:35], v[8:9] neg_lo:[0,0,1] neg_hi:[0,0,1]
    v_cvt_pk_bf16_f32 v148, v46, v47
    v_cvt_pk_bf16_f32 v149, v48, v49
    v_pk_mul_f32 v[8:9], v[48:49], v[36:37]
    v_pk_mul_f32 v[10:11], v[48:49], v[34:35]
    v_pk_fma_f32 v[48:49], v[46:47], v[36:37], v[10:11]
    v_pk_fma_f32 v[46:47], v[46:47], v[34:35], v[8:9] neg_lo:[0,0,1] neg_hi:[0,0,1]
    v_cvt_pk_bf16_f32 v150, v46, v47
    v_cvt_pk_bf16_f32 v151, v48, v49
    ds_write2_b64 v139, v[148:149], v[150:151] offset0:132 offset1:198
    ds_read_b128 v[104:107], v5 offset:0
    ds_read_b128 v[108:111], v5 offset:64
    ds_read_b128 v[112:115], v5 offset:128
    ds_read_b128 v[116:119], v5 offset:192
    ds_read_b128 v[120:123], v5 offset:256
    ds_read_b128 v[124:127], v5 offset:320
    ds_read_b128 v[128:131], v5 offset:384
    ds_read_b128 v[132:135], v5 offset:448
    v_pk_mul_f32 v[8:9], v[44:45], v[44:45]
    v_pk_mul_f32 v[10:11], v[44:45], v[42:43]
    v_pk_fma_f32 v[52:53], v[42:43], v[44:45], v[10:11]
    v_pk_fma_f32 v[50:51], v[42:43], v[42:43], v[8:9] neg_lo:[0,0,1] neg_hi:[0,0,1]
    v_cvt_pk_bf16_f32 v144, v50, v51
    v_cvt_pk_bf16_f32 v145, v52, v53
    v_pk_mul_f32 v[8:9], v[52:53], v[24:25]
    v_pk_mul_f32 v[10:11], v[52:53], v[22:23]
    v_pk_fma_f32 v[48:49], v[50:51], v[24:25], v[10:11]
    v_pk_fma_f32 v[46:47], v[50:51], v[22:23], v[8:9] neg_lo:[0,0,1] neg_hi:[0,0,1]
    v_cvt_pk_bf16_f32 v146, v46, v47
    v_cvt_pk_bf16_f32 v147, v48, v49
    ds_write2_b64 v136, v[144:145], v[146:147] offset0:0 offset1:66
    v_pk_mul_f32 v[8:9], v[48:49], v[24:25]
    v_pk_mul_f32 v[10:11], v[48:49], v[22:23]
    v_pk_fma_f32 v[48:49], v[46:47], v[24:25], v[10:11]
    v_pk_fma_f32 v[46:47], v[46:47], v[22:23], v[8:9] neg_lo:[0,0,1] neg_hi:[0,0,1]
    v_cvt_pk_bf16_f32 v148, v46, v47
    v_cvt_pk_bf16_f32 v149, v48, v49
    v_pk_mul_f32 v[8:9], v[48:49], v[24:25]
    v_pk_mul_f32 v[10:11], v[48:49], v[22:23]
    v_pk_fma_f32 v[48:49], v[46:47], v[24:25], v[10:11]
    v_pk_fma_f32 v[46:47], v[46:47], v[22:23], v[8:9] neg_lo:[0,0,1] neg_hi:[0,0,1]
    buffer_load_dwordx2 v[172:173], v141, s[36:39], s10 offen offset:2304
    v_cvt_pk_bf16_f32 v150, v46, v47
    v_cvt_pk_bf16_f32 v151, v48, v49
    ds_write2_b64 v136, v[148:149], v[150:151] offset0:132 offset1:198
    v_pk_mul_f32 v[8:9], v[52:53], v[44:45]
    v_pk_mul_f32 v[10:11], v[52:53], v[42:43]
    v_pk_fma_f32 v[52:53], v[50:51], v[44:45], v[10:11]
    v_pk_fma_f32 v[50:51], v[50:51], v[42:43], v[8:9] neg_lo:[0,0,1] neg_hi:[0,0,1]
    s_waitcnt lgkmcnt(2)
    v_mfma_f32_16x16x32_bf16 v[88:91], v[104:107], v[56:59], v[88:91]
    v_cvt_pk_bf16_f32 v144, v50, v51
    v_cvt_pk_bf16_f32 v145, v52, v53
    v_pk_mul_f32 v[8:9], v[52:53], v[24:25]
    v_pk_mul_f32 v[10:11], v[52:53], v[22:23]
    v_pk_fma_f32 v[48:49], v[50:51], v[24:25], v[10:11]
    v_pk_fma_f32 v[46:47], v[50:51], v[22:23], v[8:9] neg_lo:[0,0,1] neg_hi:[0,0,1]
    v_mfma_f32_16x16x32_bf16 v[88:91], v[108:111], v[60:63], v[88:91]
    v_cvt_pk_bf16_f32 v146, v46, v47
    v_cvt_pk_bf16_f32 v147, v48, v49
    ds_write2_b64 v137, v[144:145], v[146:147] offset0:0 offset1:66
    v_pk_mul_f32 v[8:9], v[48:49], v[24:25]
    v_pk_mul_f32 v[10:11], v[48:49], v[22:23]
    v_pk_fma_f32 v[48:49], v[46:47], v[24:25], v[10:11]
    v_pk_fma_f32 v[46:47], v[46:47], v[22:23], v[8:9] neg_lo:[0,0,1] neg_hi:[0,0,1]
    v_mfma_f32_16x16x32_bf16 v[88:91], v[112:115], v[64:67], v[88:91]
    v_cvt_pk_bf16_f32 v148, v46, v47
    v_cvt_pk_bf16_f32 v149, v48, v49
    v_pk_mul_f32 v[8:9], v[48:49], v[24:25]
    v_pk_mul_f32 v[10:11], v[48:49], v[22:23]
    v_pk_fma_f32 v[48:49], v[46:47], v[24:25], v[10:11]
    v_pk_fma_f32 v[46:47], v[46:47], v[22:23], v[8:9] neg_lo:[0,0,1] neg_hi:[0,0,1]
    v_mfma_f32_16x16x32_bf16 v[88:91], v[116:119], v[68:71], v[88:91]
    v_cvt_pk_bf16_f32 v150, v46, v47
    v_cvt_pk_bf16_f32 v151, v48, v49
    ds_write2_b64 v137, v[148:149], v[150:151] offset0:132 offset1:198
    v_pk_mul_f32 v[8:9], v[52:53], v[44:45]
    v_pk_mul_f32 v[10:11], v[52:53], v[42:43]
    v_pk_fma_f32 v[52:53], v[50:51], v[44:45], v[10:11]
    v_pk_fma_f32 v[50:51], v[50:51], v[42:43], v[8:9] neg_lo:[0,0,1] neg_hi:[0,0,1]
    v_mfma_f32_16x16x32_bf16 v[88:91], v[120:123], v[72:75], v[88:91]
    v_cvt_pk_bf16_f32 v144, v50, v51
    v_cvt_pk_bf16_f32 v145, v52, v53
    v_pk_mul_f32 v[8:9], v[52:53], v[28:29]
    v_pk_mul_f32 v[10:11], v[52:53], v[26:27]
    v_pk_fma_f32 v[48:49], v[50:51], v[28:29], v[10:11]
    v_pk_fma_f32 v[46:47], v[50:51], v[26:27], v[8:9] neg_lo:[0,0,1] neg_hi:[0,0,1]
    v_mfma_f32_16x16x32_bf16 v[88:91], v[124:127], v[76:79], v[88:91]
    v_cvt_pk_bf16_f32 v146, v46, v47
    v_cvt_pk_bf16_f32 v147, v48, v49
    ds_write2_b64 v138, v[144:145], v[146:147] offset0:0 offset1:66
    v_pk_mul_f32 v[8:9], v[52:53], v[44:45]
    v_pk_mul_f32 v[10:11], v[52:53], v[42:43]
    v_pk_fma_f32 v[52:53], v[50:51], v[44:45], v[10:11]
    v_pk_fma_f32 v[50:51], v[50:51], v[42:43], v[8:9] neg_lo:[0,0,1] neg_hi:[0,0,1]
    v_mfma_f32_16x16x32_bf16 v[88:91], v[128:131], v[80:83], v[88:91]
    v_cvt_pk_bf16_f32 v148, v50, v51
    v_cvt_pk_bf16_f32 v149, v52, v53
    v_pk_mul_f32 v[8:9], v[52:53], v[28:29]
    v_pk_mul_f32 v[10:11], v[52:53], v[26:27]
    v_pk_fma_f32 v[48:49], v[50:51], v[28:29], v[10:11]
    v_pk_fma_f32 v[46:47], v[50:51], v[26:27], v[8:9] neg_lo:[0,0,1] neg_hi:[0,0,1]
    v_mfma_f32_16x16x32_bf16 v[88:91], v[132:135], v[84:87], v[88:91]
    v_cvt_pk_bf16_f32 v150, v46, v47
    v_cvt_pk_bf16_f32 v151, v48, v49
    ds_write2_b64 v138, v[148:149], v[150:151] offset0:132 offset1:198
    v_pk_mul_f32 v[8:9], v[52:53], v[44:45]
    v_pk_mul_f32 v[10:11], v[52:53], v[42:43]
    v_pk_fma_f32 v[52:53], v[50:51], v[44:45], v[10:11]
    v_pk_fma_f32 v[50:51], v[50:51], v[42:43], v[8:9] neg_lo:[0,0,1] neg_hi:[0,0,1]
    buffer_load_dwordx2 v[174:175], v141, s[36:39], s10 offen offset:3456
    v_cvt_pk_bf16_f32 v144, v50, v51
    v_cvt_pk_bf16_f32 v145, v52, v53
    v_pk_mul_f32 v[8:9], v[52:53], v[28:29]
    v_pk_mul_f32 v[10:11], v[52:53], v[26:27]
    v_pk_fma_f32 v[48:49], v[50:51], v[28:29], v[10:11]
    v_pk_fma_f32 v[46:47], v[50:51], v[26:27], v[8:9] neg_lo:[0,0,1] neg_hi:[0,0,1]
    v_cvt_pk_bf16_f32 v146, v46, v47
    v_cvt_pk_bf16_f32 v147, v48, v49
    ds_write2_b64 v139, v[144:145], v[146:147] offset0:0 offset1:66
    v_pk_mul_f32 v[8:9], v[52:53], v[44:45]
    v_pk_mul_f32 v[10:11], v[52:53], v[42:43]
    v_pk_fma_f32 v[52:53], v[50:51], v[44:45], v[10:11]
    v_pk_fma_f32 v[50:51], v[50:51], v[42:43], v[8:9] neg_lo:[0,0,1] neg_hi:[0,0,1]
    v_cvt_pk_bf16_f32 v148, v50, v51
    v_cvt_pk_bf16_f32 v149, v52, v53
    v_pk_mul_f32 v[8:9], v[52:53], v[28:29]
    v_pk_mul_f32 v[10:11], v[52:53], v[26:27]
    v_pk_fma_f32 v[48:49], v[50:51], v[28:29], v[10:11]
    v_pk_fma_f32 v[46:47], v[50:51], v[26:27], v[8:9] neg_lo:[0,0,1] neg_hi:[0,0,1]
    v_cvt_pk_bf16_f32 v150, v46, v47
    v_cvt_pk_bf16_f32 v151, v48, v49
    ds_write2_b64 v139, v[148:149], v[150:151] offset0:132 offset1:198
    v_pk_mul_f32 v[8:9], v[52:53], v[44:45]
    v_pk_mul_f32 v[10:11], v[52:53], v[42:43]
    v_pk_fma_f32 v[52:53], v[50:51], v[44:45], v[10:11]
    v_pk_fma_f32 v[50:51], v[50:51], v[42:43], v[8:9] neg_lo:[0,0,1] neg_hi:[0,0,1]
    ds_read_b128 v[104:107], v5 offset:0
    ds_read_b128 v[108:111], v5 offset:64
    ds_read_b128 v[112:115], v5 offset:128
    ds_read_b128 v[116:119], v5 offset:192
    ds_read_b128 v[120:123], v5 offset:256
    ds_read_b128 v[124:127], v5 offset:320
    ds_read_b128 v[128:131], v5 offset:384
    ds_read_b128 v[132:135], v5 offset:448
    v_cvt_pk_bf16_f32 v144, v50, v51
    v_cvt_pk_bf16_f32 v145, v52, v53
    v_pk_mul_f32 v[8:9], v[52:53], v[44:45]
    v_pk_mul_f32 v[10:11], v[52:53], v[42:43]
    v_pk_fma_f32 v[52:53], v[50:51], v[44:45], v[10:11]
    v_pk_fma_f32 v[50:51], v[50:51], v[42:43], v[8:9] neg_lo:[0,0,1] neg_hi:[0,0,1]
    v_cvt_pk_bf16_f32 v146, v50, v51
    v_cvt_pk_bf16_f32 v147, v52, v53
    ds_write2_b64 v136, v[144:145], v[146:147] offset0:0 offset1:66
    v_pk_mul_f32 v[8:9], v[52:53], v[44:45]
    v_pk_mul_f32 v[10:11], v[52:53], v[42:43]
    v_pk_fma_f32 v[52:53], v[50:51], v[44:45], v[10:11]
    v_pk_fma_f32 v[50:51], v[50:51], v[42:43], v[8:9] neg_lo:[0,0,1] neg_hi:[0,0,1]
    s_waitcnt lgkmcnt(1)
    v_mfma_f32_16x16x32_bf16 v[92:95], v[104:107], v[56:59], 0
    v_cvt_pk_bf16_f32 v148, v50, v51
    v_cvt_pk_bf16_f32 v149, v52, v53
    v_pk_mul_f32 v[8:9], v[52:53], v[44:45]
    v_pk_mul_f32 v[10:11], v[52:53], v[42:43]
    v_pk_fma_f32 v[52:53], v[50:51], v[44:45], v[10:11]
    v_pk_fma_f32 v[50:51], v[50:51], v[42:43], v[8:9] neg_lo:[0,0,1] neg_hi:[0,0,1]
    v_mfma_f32_16x16x32_bf16 v[92:95], v[108:111], v[60:63], v[92:95]
    v_cvt_pk_bf16_f32 v150, v50, v51
    v_cvt_pk_bf16_f32 v151, v52, v53
    ds_write2_b64 v136, v[148:149], v[150:151] offset0:132 offset1:198
    v_pk_mul_f32 v[8:9], v[52:53], v[44:45]
    v_pk_mul_f32 v[10:11], v[52:53], v[42:43]
    v_pk_fma_f32 v[52:53], v[50:51], v[44:45], v[10:11]
    v_pk_fma_f32 v[50:51], v[50:51], v[42:43], v[8:9] neg_lo:[0,0,1] neg_hi:[0,0,1]
    v_mfma_f32_16x16x32_bf16 v[92:95], v[112:115], v[64:67], v[92:95]
    v_cvt_pk_bf16_f32 v144, v50, v51
    v_cvt_pk_bf16_f32 v145, v52, v53
    v_pk_mul_f32 v[8:9], v[52:53], v[44:45]
    v_pk_mul_f32 v[10:11], v[52:53], v[42:43]
    v_pk_fma_f32 v[52:53], v[50:51], v[44:45], v[10:11]
    v_pk_fma_f32 v[50:51], v[50:51], v[42:43], v[8:9] neg_lo:[0,0,1] neg_hi:[0,0,1]
    v_mfma_f32_16x16x32_bf16 v[92:95], v[116:119], v[68:71], v[92:95]
    v_cvt_pk_bf16_f32 v146, v50, v51
    v_cvt_pk_bf16_f32 v147, v52, v53
    ds_write2_b64 v137, v[144:145], v[146:147] offset0:0 offset1:66
    v_pk_mul_f32 v[8:9], v[52:53], v[44:45]
    v_pk_mul_f32 v[10:11], v[52:53], v[42:43]
    v_pk_fma_f32 v[52:53], v[50:51], v[44:45], v[10:11]
    v_pk_fma_f32 v[50:51], v[50:51], v[42:43], v[8:9] neg_lo:[0,0,1] neg_hi:[0,0,1]
    v_mfma_f32_16x16x32_bf16 v[92:95], v[120:123], v[72:75], v[92:95]
    v_cvt_pk_bf16_f32 v148, v50, v51
    v_cvt_pk_bf16_f32 v149, v52, v53
    v_pk_mul_f32 v[8:9], v[52:53], v[44:45]
    v_pk_mul_f32 v[10:11], v[52:53], v[42:43]
    v_pk_fma_f32 v[52:53], v[50:51], v[44:45], v[10:11]
    v_pk_fma_f32 v[50:51], v[50:51], v[42:43], v[8:9] neg_lo:[0,0,1] neg_hi:[0,0,1]
    v_mfma_f32_16x16x32_bf16 v[92:95], v[124:127], v[76:79], v[92:95]
    v_cvt_pk_bf16_f32 v150, v50, v51
    v_cvt_pk_bf16_f32 v151, v52, v53
    ds_write2_b64 v137, v[148:149], v[150:151] offset0:132 offset1:198
    v_pk_mul_f32 v[8:9], v[52:53], v[44:45]
    v_pk_mul_f32 v[10:11], v[52:53], v[42:43]
    v_pk_fma_f32 v[52:53], v[50:51], v[44:45], v[10:11]
    v_pk_fma_f32 v[50:51], v[50:51], v[42:43], v[8:9] neg_lo:[0,0,1] neg_hi:[0,0,1]
    v_mfma_f32_16x16x32_bf16 v[92:95], v[128:131], v[80:83], v[92:95]
    v_cvt_pk_bf16_f32 v144, v50, v51
    v_cvt_pk_bf16_f32 v145, v52, v53
    ds_write_b64 v138, v[144:145] offset:0
    v_mfma_f32_16x16x32_bf16 v[92:95], v[132:135], v[84:87], v[92:95]
    ds_read_b128 v[104:107], v5 offset:0
    ds_read_b128 v[108:111], v5 offset:64
    ds_read_b128 v[112:115], v5 offset:128
    ds_read_b128 v[116:119], v5 offset:192
    ds_read_b128 v[120:123], v5 offset:256
    ds_read_b128 v[124:127], v5 offset:320
    ds_read_b128 v[128:131], v5 offset:384
    ds_read_b128 v[132:135], v5 offset:448
    buffer_load_dwordx4 v[176:179], v1, s[28:31], s18 offen offset:0 sc1
    buffer_load_dwordx4 v[180:183], v1, s[28:31], s18 offen offset:1024 sc1
    buffer_load_dwordx4 v[184:187], v1, s[28:31], s18 offen offset:2048 sc1
    buffer_load_dwordx4 v[188:191], v1, s[28:31], s18 offen offset:3072 sc1
    buffer_load_dwordx2 v[30:31], v249, s[28:31], 0 offen sc1
    v_cvt_pk_bf16_f32 v88, v88, v89
    v_cvt_pk_bf16_f32 v89, v90, v91
    ds_write_b64 v100, v[88:89]
    v_cvt_pk_bf16_f32 v92, v92, v93
    v_cvt_pk_bf16_f32 v93, v94, v95
    ds_write_b32 v102, v92 offset:512
    ds_write_b32 v101, v93 offset:516
    ds_read_b64 v[8:9], v224 offset:12928
    ds_read_b32 v18, v224 offset:12936
    ds_read2_b32 v[10:11], v225 offset0:0 offset1:1
    s_waitcnt lgkmcnt(6)
    v_mfma_f32_16x16x32_bf16 v[96:99], v[56:59], v[104:107], 0
    s_mov_b32 s41, 0x01000100
    s_mov_b32 s42, 0x03020302
    v_mfma_f32_16x16x32_bf16 v[96:99], v[60:63], v[108:111], v[96:99]
    v_cmp_eq_u32 vcc, 7, v0
    s_waitcnt lgkmcnt(0)
    v_mfma_f32_16x16x32_bf16 v[96:99], v[64:67], v[112:115], v[96:99]
    v_readfirstlane_b32 s16, v8
    v_alignbit_b32 v20, v9, v8, 16
    v_mfma_f32_16x16x32_bf16 v[96:99], v[68:71], v[116:119], v[96:99]
    v_alignbit_b32 v21, v18, v9, 16
    s_lshl_b32 s16, s16, 16
    v_mfma_f32_16x16x32_bf16 v[96:99], v[72:75], v[120:123], v[96:99]
    v_perm_b32 v16, v10, v10, s41
    v_alignbit_b32 v17, v11, v10, 16
    v_mfma_f32_16x16x32_bf16 v[96:99], v[76:79], v[124:127], v[96:99]
    v_perm_b32 v11, v11, v11, s41
    v_mov_b32 v19, s16
    v_mfma_f32_16x16x32_bf16 v[96:99], v[80:83], v[128:131], v[96:99]
    v_cndmask_b32 v153, 0, v19, vcc
    v_mfma_f32_16x16x32_bf16 v[96:99], v[84:87], v[132:135], v[96:99]
    ds_write_b64 v224, v[8:9] offset:4640
    ds_write_b64 v224, v[20:21] offset:8800
    s_nop 5
    v_cvt_pk_bf16_f32 v96, v96, v97
    v_cvt_pk_bf16_f32 v97, v98, v99
    ds_write_b64 v103, v[96:97] offset:1024
    ds_read2_b32 v[12:13], v225 offset0:64 offset1:65
    ds_read2_b32 v[14:15], v225 offset0:128 offset1:129
    ds_write_b64 v224, v[16:17] offset:5152
    ds_write_b64 v224, v[10:11] offset:9312
    s_mov_b64 exec, 0xff
    ds_write_b64 v248, v[152:153] offset:4608
    s_mov_b64 exec, -1
    s_waitcnt lgkmcnt(3)
    v_perm_b32 v64, v12, v12, s41
    v_mov_b32 v65, v12
    v_perm_b32 v66, v12, v12, s42
    v_perm_b32 v67, v13, v13, s41
    ds_write_b128 v226, v[64:67] offset:5664
    v_mov_b32 v68, v64
    v_mov_b32 v69, v66
    v_alignbit_b32 v70, v13, v12, 16
    v_mov_b32 v71, v67
    ds_write_b128 v226, v[68:71] offset:9824
    v_alignbit_b32 v76, v15, v14, 16
    v_perm_b32 v72, v14, v14, s41
    v_perm_b32 v73, v14, v14, s41
    v_and_b32 v74, 0xffff, v14
    ds_write_b32 v158, v76 offset:6944
    s_mov_b64 exec, 1
    ds_write_b96 v226, v[72:74] offset:6688
    ds_write_b64 v226, v[72:73] offset:10848
    s_mov_b64 exec, -1
    v_add_u32 v254, 1024, v253
    v_add_u32 v255, 2048, v253
    v_mov_b32 v26, v159
    v_mov_b32 v23, v252
    ds_read2_b32 v[96:97], v253 offset0:0 offset1:1
    ds_read2_b32 v[98:99], v253 offset0:2 offset1:3
    ds_read2_b32 v[100:101], v253 offset0:128 offset1:129
    ds_read2_b32 v[102:103], v253 offset0:130 offset1:131
    ds_read2_b32 v[104:105], v254 offset0:0 offset1:1
    ds_read2_b32 v[106:107], v254 offset0:2 offset1:3
    ds_read2_b32 v[108:109], v254 offset0:128 offset1:129
    ds_read2_b32 v[110:111], v254 offset0:130 offset1:131
    ds_read2_b32 v[112:113], v255 offset0:0 offset1:1
    ds_read2_b32 v[114:115], v255 offset0:2 offset1:3
    s_waitcnt vmcnt(5)
    v_readlane_b32 s8, v140, 0
    v_readlane_b32 s4, v140, 1
    s_mul_i32 s8, s8, 1664525
    s_mul_i32 s4, s4, 0x9e3779b0
    s_add_u32 s8, s8, s4
    s_add_u32 s8, s8, 1013904223
    v_lshlrev_b32 v192, 16, v160
    v_and_b32 v193, s43, v160
    v_lshlrev_b32 v194, 16, v161
    v_and_b32 v195, s43, v161
    v_lshlrev_b32 v196, 16, v162
    v_and_b32 v197, s43, v162
    v_lshlrev_b32 v198, 16, v163
    v_and_b32 v199, s43, v163
    v_lshlrev_b32 v200, 16, v164
    v_and_b32 v201, s43, v164
    v_lshlrev_b32 v202, 16, v165
    v_and_b32 v203, s43, v165
    v_lshlrev_b32 v204, 16, v166
    v_and_b32 v205, s43, v166
    v_lshlrev_b32 v206, 16, v167
    v_and_b32 v207, s43, v167
    v_lshlrev_b32 v208, 16, v168
    v_and_b32 v209, s43, v168
    v_lshlrev_b32 v210, 16, v169
    v_and_b32 v211, s43, v169
    v_lshlrev_b32 v212, 16, v170
    v_and_b32 v213, s43, v170
    v_lshlrev_b32 v214, 16, v171
    v_and_b32 v215, s43, v171
    v_lshlrev_b32 v216, 16, v172
    v_and_b32 v217, s43, v172
    v_lshlrev_b32 v218, 16, v173
    v_and_b32 v219, s43, v173
    v_lshlrev_b32 v220, 16, v174
    v_and_b32 v221, s43, v174
    v_lshlrev_b32 v222, 16, v175
    v_and_b32 v223, s43, v175
    s_mov_b32 s16, 0
    s_waitcnt vmcnt(1)
PA_CHK:
    v_xor_b32 v29, s8, v177
    v_xor_b32 v32, s8, v179
    v_or_b32 v29, v29, v32
    v_xor_b32 v32, s8, v181
    v_or_b32 v29, v29, v32
    v_xor_b32 v32, s8, v183
    v_or_b32 v29, v29, v32
    v_xor_b32 v32, s8, v185
    v_or_b32 v29, v29, v32
    v_xor_b32 v32, s8, v187
    v_or_b32 v29, v29, v32
    v_xor_b32 v32, s8, v189
    v_or_b32 v29, v29, v32
    v_xor_b32 v32, s8, v191
    v_or_b32 v29, v29, v32
    v_cmp_ne_u32 vcc, 0, v29
    s_add_u32 s16, s16, 1
    s_cmp_ge_u32 s16, 60000
    s_cbranch_scc1 PA_OK
    s_cbranch_vccz PA_OK
    s_sleep 8
    buffer_load_dwordx4 v[176:179], v1, s[28:31], s18 offen offset:0 sc1
    buffer_load_dwordx4 v[180:183], v1, s[28:31], s18 offen offset:1024 sc1
    buffer_load_dwordx4 v[184:187], v1, s[28:31], s18 offen offset:2048 sc1
    buffer_load_dwordx4 v[188:191], v1, s[28:31], s18 offen offset:3072 sc1
    s_waitcnt vmcnt(0)
    s_branch PA_CHK
PA_OK:
    v_and_b32 v177, s43, v176
    v_and_b32 v179, s43, v178
    v_and_b32 v181, s43, v180
    v_and_b32 v183, s43, v182
    v_and_b32 v185, s43, v184
    v_and_b32 v187, s43, v186
    v_and_b32 v189, s43, v188
    v_and_b32 v191, s43, v190
    v_rcp_f32 v177, v177
    v_rcp_f32 v179, v179
    v_rcp_f32 v181, v181
    v_rcp_f32 v183, v183
    v_rcp_f32 v185, v185
    v_rcp_f32 v187, v187
    v_rcp_f32 v189, v189
    v_rcp_f32 v191, v191
    v_lshlrev_b32 v176, 16, v176
    v_lshlrev_b32 v178, 16, v178
    v_lshlrev_b32 v180, 16, v180
    v_lshlrev_b32 v182, 16, v182
    v_lshlrev_b32 v184, 16, v184
    v_lshlrev_b32 v186, 16, v186
    v_lshlrev_b32 v188, 16, v188
    v_lshlrev_b32 v190, 16, v190
    v_mul_f32 v176, v176, v177
    v_mul_f32 v178, v178, v179
    v_mul_f32 v180, v180, v181
    v_mul_f32 v182, v182, v183
    v_mul_f32 v184, v184, v185
    v_mul_f32 v186, v186, v187
    v_mul_f32 v188, v188, v189
    v_mul_f32 v190, v190, v191
    v_pk_fma_f32 v[192:193], v[192:193], v[176:177], v[176:177] op_sel:[0,1,0] op_sel_hi:[1,1,0] neg_lo:[0,0,1] neg_hi:[0,0,1]
    v_pk_fma_f32 v[196:197], v[196:197], v[178:179], v[178:179] op_sel:[0,1,0] op_sel_hi:[1,1,0] neg_lo:[0,0,1] neg_hi:[0,0,1]
    v_pk_fma_f32 v[200:201], v[200:201], v[180:181], v[180:181] op_sel:[0,1,0] op_sel_hi:[1,1,0] neg_lo:[0,0,1] neg_hi:[0,0,1]
    v_pk_fma_f32 v[204:205], v[204:205], v[182:183], v[182:183] op_sel:[0,1,0] op_sel_hi:[1,1,0] neg_lo:[0,0,1] neg_hi:[0,0,1]
    v_pk_fma_f32 v[208:209], v[208:209], v[184:185], v[184:185] op_sel:[0,1,0] op_sel_hi:[1,1,0] neg_lo:[0,0,1] neg_hi:[0,0,1]
    v_pk_fma_f32 v[212:213], v[212:213], v[186:187], v[186:187] op_sel:[0,1,0] op_sel_hi:[1,1,0] neg_lo:[0,0,1] neg_hi:[0,0,1]
    v_pk_fma_f32 v[216:217], v[216:217], v[188:189], v[188:189] op_sel:[0,1,0] op_sel_hi:[1,1,0] neg_lo:[0,0,1] neg_hi:[0,0,1]
    v_pk_fma_f32 v[220:221], v[220:221], v[190:191], v[190:191] op_sel:[0,1,0] op_sel_hi:[1,1,0] neg_lo:[0,0,1] neg_hi:[0,0,1]
    v_pk_fma_f32 v[194:195], v[194:195], v[176:177], v[176:177] op_sel:[0,1,0] op_sel_hi:[1,1,0] neg_lo:[0,0,1] neg_hi:[0,0,1]
    v_pk_fma_f32 v[198:199], v[198:199], v[178:179], v[178:179] op_sel:[0,1,0] op_sel_hi:[1,1,0] neg_lo:[0,0,1] neg_hi:[0,0,1]
    v_pk_fma_f32 v[202:203], v[202:203], v[180:181], v[180:181] op_sel:[0,1,0] op_sel_hi:[1,1,0] neg_lo:[0,0,1] neg_hi:[0,0,1]
    v_pk_fma_f32 v[206:207], v[206:207], v[182:183], v[182:183] op_sel:[0,1,0] op_sel_hi:[1,1,0] neg_lo:[0,0,1] neg_hi:[0,0,1]
    v_pk_fma_f32 v[210:211], v[210:211], v[184:185], v[184:185] op_sel:[0,1,0] op_sel_hi:[1,1,0] neg_lo:[0,0,1] neg_hi:[0,0,1]
    v_pk_fma_f32 v[214:215], v[214:215], v[186:187], v[186:187] op_sel:[0,1,0] op_sel_hi:[1,1,0] neg_lo:[0,0,1] neg_hi:[0,0,1]
    v_pk_fma_f32 v[218:219], v[218:219], v[188:189], v[188:189] op_sel:[0,1,0] op_sel_hi:[1,1,0] neg_lo:[0,0,1] neg_hi:[0,0,1]
    v_pk_fma_f32 v[222:223], v[222:223], v[190:191], v[190:191] op_sel:[0,1,0] op_sel_hi:[1,1,0] neg_lo:[0,0,1] neg_hi:[0,0,1]
    s_waitcnt vmcnt(0)
    v_cmp_ne_u32 vcc, s8, v31
    s_nop 1
    s_cbranch_vccz PM_OK
    s_mov_b32 s16, 0
PM_POLL:
    buffer_load_dwordx2 v[30:31], v249, s[28:31], 0 offen sc1
    s_add_u32 s16, s16, 1
    s_waitcnt vmcnt(0)
    v_cmp_ne_u32 vcc, s8, v31
    s_cmp_ge_u32 s16, 60000
    s_cbranch_scc1 PM_POLL_X
    s_and_b64 vcc, vcc, exec
    s_cbranch_scc0 PM_POLL_X
    s_mov_b64 exec, vcc
    s_sleep 4
    s_branch PM_POLL
PM_POLL_X:
    s_mov_b64 exec, -1
PM_OK:
    v_add_f32_dpp v30, v30, v30 row_ror:8 row_mask:0xf bank_mask:0xf
    v_mov_b32 v31, v30
    s_nop 1
    v_permlane16_swap_b32 v30, v31
    v_add_f32 v30, v30, v31
    v_mov_b32 v31, v30
    s_nop 1
    v_permlane32_swap_b32 v30, v31
    v_add_f32 v30, v30, v31
    v_cvt_pk_bf16_f32 v30, v30, v30
    v_lshlrev_b32 v30, 16, v30
    v_add_f32 v30, v30, v250
    v_cvt_pk_bf16_f32 v30, v30, v30
    v_lshlrev_b32 v30, 16, v30
    s_nop 1
    v_mov_b32_dpp v32, v30 row_newbcast:0 row_mask:0xf bank_mask:0xf
    v_mov_b32_dpp v33, v30 row_newbcast:1 row_mask:0xf bank_mask:0xf
    v_mov_b32_dpp v34, v30 row_newbcast:2 row_mask:0xf bank_mask:0xf
    v_mov_b32_dpp v35, v30 row_newbcast:3 row_mask:0xf bank_mask:0xf
    v_mov_b32_dpp v36, v30 row_newbcast:4 row_mask:0xf bank_mask:0xf
    v_mov_b32_dpp v37, v30 row_newbcast:5 row_mask:0xf bank_mask:0xf
    v_mov_b32_dpp v38, v30 row_newbcast:6 row_mask:0xf bank_mask:0xf
    v_mov_b32_dpp v39, v30 row_newbcast:7 row_mask:0xf bank_mask:0xf
    v_pk_fma_f32 v[192:193], v[192:193], v[36:37], v[32:33]
    v_pk_fma_f32 v[196:197], v[196:197], v[36:37], v[32:33]
    v_pk_fma_f32 v[200:201], v[200:201], v[36:37], v[32:33]
    v_pk_fma_f32 v[204:205], v[204:205], v[36:37], v[32:33]
    v_pk_fma_f32 v[208:209], v[208:209], v[36:37], v[32:33]
    v_pk_fma_f32 v[212:213], v[212:213], v[36:37], v[32:33]
    v_pk_fma_f32 v[216:217], v[216:217], v[36:37], v[32:33]
    v_pk_fma_f32 v[220:221], v[220:221], v[36:37], v[32:33]
    v_cvt_pk_bf16_f32 v40, v220, v216
    v_cvt_pk_bf16_f32 v41, v212, v208
    v_cvt_pk_bf16_f32 v42, v204, v200
    v_cvt_pk_bf16_f32 v43, v196, v192
    ds_write_b128 v251, v[40:43] offset:0
    v_cvt_pk_bf16_f32 v44, v221, v217
    v_cvt_pk_bf16_f32 v45, v213, v209
    v_cvt_pk_bf16_f32 v46, v205, v201
    v_cvt_pk_bf16_f32 v47, v197, v193
    ds_write_b128 v251, v[44:47] offset:21376
    v_pk_fma_f32 v[194:195], v[194:195], v[38:39], v[34:35]
    v_pk_fma_f32 v[198:199], v[198:199], v[38:39], v[34:35]
    v_pk_fma_f32 v[202:203], v[202:203], v[38:39], v[34:35]
    v_pk_fma_f32 v[206:207], v[206:207], v[38:39], v[34:35]
    v_pk_fma_f32 v[210:211], v[210:211], v[38:39], v[34:35]
    v_pk_fma_f32 v[214:215], v[214:215], v[38:39], v[34:35]
    v_pk_fma_f32 v[218:219], v[218:219], v[38:39], v[34:35]
    v_pk_fma_f32 v[222:223], v[222:223], v[38:39], v[34:35]
    v_cvt_pk_bf16_f32 v48, v222, v218
    v_cvt_pk_bf16_f32 v49, v214, v210
    v_cvt_pk_bf16_f32 v50, v206, v202
    v_cvt_pk_bf16_f32 v51, v198, v194
    ds_write_b128 v251, v[48:51] offset:42752
    v_cvt_pk_bf16_f32 v52, v223, v219
    v_cvt_pk_bf16_f32 v53, v215, v211
    v_cvt_pk_bf16_f32 v54, v207, v203
    v_cvt_pk_bf16_f32 v55, v199, v195
    ds_write_b128 v251, v[52:55] offset:64128
    s_waitcnt lgkmcnt(0)
    s_barrier
    ds_read_b128 v[128:131], v23 offset:3584
    ds_read_b128 v[132:135], v23 offset:3072
    ds_read_b128 v[136:139], v23 offset:2560
    ds_read_b128 v[140:143], v23 offset:2048
    ds_read_b128 v[144:147], v23 offset:1536
    ds_read_b128 v[148:151], v23 offset:1024
    ds_read_b128 v[152:155], v23 offset:512
    ds_read_b128 v[156:159], v23 offset:0
    s_waitcnt lgkmcnt(0)
    v_mfma_f32_16x16x32_bf16 v[64:67], v[96:99], v[128:131], 0
    ds_read_b128 v[192:195], v23 offset:3648
    v_lshrrev_b32 v29, 3, v0
    v_mfma_f32_16x16x32_bf16 v[68:71], v[96:99], v[132:135], 0
    ds_read2_b32 v[160:161], v253 offset0:16 offset1:17
    v_mul_u32_u24 v29, 18432, v29
    v_mfma_f32_16x16x32_bf16 v[68:71], v[100:103], v[128:131], v[68:71]
    ds_read_b128 v[196:199], v23 offset:3136
    v_and_b32 v31, 7, v0
    v_mfma_f32_16x16x32_bf16 v[72:75], v[96:99], v[136:139], 0
    ds_read2_b32 v[162:163], v253 offset0:18 offset1:19
    v_lshl_add_u32 v29, v31, 4, v29
    v_mfma_f32_16x16x32_bf16 v[72:75], v[100:103], v[132:135], v[72:75]
    ds_read_b128 v[200:203], v23 offset:2624
    s_mul_i32 s17, s3, 589824
    v_mfma_f32_16x16x32_bf16 v[72:75], v[104:107], v[128:131], v[72:75]
    ds_read2_b32 v[164:165], v253 offset0:144 offset1:145
    s_lshl_b32 s16, s14, 7
    v_mfma_f32_16x16x32_bf16 v[76:79], v[96:99], v[140:143], 0
    ds_read_b128 v[204:207], v23 offset:2112
    s_add_u32 s17, s17, s16
    v_mfma_f32_16x16x32_bf16 v[76:79], v[100:103], v[136:139], v[76:79]
    ds_read2_b32 v[166:167], v253 offset0:146 offset1:147
    s_add_u32 s17, s17, 6291456
    v_mfma_f32_16x16x32_bf16 v[76:79], v[104:107], v[132:135], v[76:79]
    ds_read_b128 v[208:211], v23 offset:1600
    s_mul_i32 s45, s3, 5
    v_mfma_f32_16x16x32_bf16 v[76:79], v[108:111], v[128:131], v[76:79]
    ds_read2_b32 v[168:169], v254 offset0:16 offset1:17
    s_min_u32 s45, s45, 14
    v_mfma_f32_16x16x32_bf16 v[80:83], v[96:99], v[144:147], 0
    ds_read_b128 v[212:215], v23 offset:1088
    v_mov_b32 v56, -1
    v_mfma_f32_16x16x32_bf16 v[80:83], v[100:103], v[140:143], v[80:83]
    ds_read2_b32 v[170:171], v254 offset0:18 offset1:19
    v_mov_b32 v57, -1
    v_mfma_f32_16x16x32_bf16 v[80:83], v[104:107], v[136:139], v[80:83]
    ds_read_b128 v[216:219], v23 offset:576
    v_mov_b32 v58, -1
    v_mfma_f32_16x16x32_bf16 v[80:83], v[108:111], v[132:135], v[80:83]
    ds_read2_b32 v[172:173], v254 offset0:144 offset1:145
    v_mov_b32 v59, -1
    v_mfma_f32_16x16x32_bf16 v[80:83], v[112:115], v[128:131], v[80:83]
    ds_read_b128 v[220:223], v23 offset:64
    s_lshl_b32 s50, s45, 10
    v_mfma_f32_16x16x32_bf16 v[84:87], v[96:99], v[148:151], 0
    ds_read2_b32 v[174:175], v254 offset0:146 offset1:147
    s_mul_i32 s51, s2, 18432
    v_mfma_f32_16x16x32_bf16 v[84:87], v[100:103], v[144:147], v[84:87]
    s_add_u32 s51, s51, s50
    s_add_u32 s52, s51, 9437184
    v_mfma_f32_16x16x32_bf16 v[84:87], v[104:107], v[140:143], v[84:87]
    s_cmp_eq_u32 s3, 0
    s_cselect_b32 s52, s52, s30
    v_mul_u32_u24 v32, 1152, v3
    v_mfma_f32_16x16x32_bf16 v[84:87], v[108:111], v[136:139], v[84:87]
    v_lshl_add_u32 v32, v4, 3, v32
    s_mul_i32 s47, s2, 18432
    v_mfma_f32_16x16x32_bf16 v[84:87], v[112:115], v[132:135], v[84:87]
    s_lshl_b32 s16, s45, 6
    s_add_u32 s47, s47, s16
    v_mfma_f32_16x16x32_bf16 v[88:91], v[96:99], v[152:155], 0
    s_add_u32 s16, s17, 0
    buffer_store_dwordx4 v[56:59], v29, s[28:31], s16 offen sc1
    v_mfma_f32_16x16x32_bf16 v[88:91], v[100:103], v[148:151], v[88:91]
    v_mfma_f32_16x16x32_bf16 v[88:91], v[104:107], v[144:147], v[88:91]
    v_mfma_f32_16x16x32_bf16 v[88:91], v[108:111], v[140:143], v[88:91]
    v_mfma_f32_16x16x32_bf16 v[88:91], v[112:115], v[136:139], v[88:91]
    v_mfma_f32_16x16x32_bf16 v[92:95], v[96:99], v[156:159], 0
    s_add_u32 s16, s17, 147456
    buffer_store_dwordx4 v[56:59], v29, s[28:31], s16 offen sc1
    v_mfma_f32_16x16x32_bf16 v[92:95], v[100:103], v[152:155], v[92:95]
    v_mfma_f32_16x16x32_bf16 v[92:95], v[104:107], v[148:151], v[92:95]
    v_mfma_f32_16x16x32_bf16 v[92:95], v[108:111], v[144:147], v[92:95]
    v_mfma_f32_16x16x32_bf16 v[92:95], v[112:115], v[140:143], v[92:95]
    v_mfma_f32_16x16x32_bf16 v[36:39], v[128:131], a[0:3], 0
    s_add_u32 s16, s17, 294912
    buffer_store_dwordx4 v[56:59], v29, s[28:31], s16 offen sc1
    v_mfma_f32_16x16x32_bf16 v[40:43], v[132:135], a[0:3], 0
    v_mfma_f32_16x16x32_bf16 v[44:47], v[136:139], a[0:3], 0
    v_mfma_f32_16x16x32_bf16 v[48:51], v[140:143], a[0:3], 0
    v_mfma_f32_16x16x32_bf16 v[176:179], v[128:131], a[4:7], 0
    v_mfma_f32_16x16x32_bf16 v[180:183], v[132:135], a[4:7], 0
    s_add_u32 s16, s17, 442368
    buffer_store_dwordx4 v[56:59], v29, s[28:31], s16 offen sc1
    v_mfma_f32_16x16x32_bf16 v[184:187], v[136:139], a[4:7], 0
    v_mfma_f32_16x16x32_bf16 v[188:191], v[140:143], a[4:7], 0
    s_waitcnt lgkmcnt(0)
    v_mfma_f32_16x16x32_bf16 v[176:179], v[192:195], a[8:11], v[176:179]
    ds_read_b128 v[128:131], v23 offset:3712
    v_mfma_f32_16x16x32_bf16 v[180:183], v[196:199], a[8:11], v[180:183]
    ds_read2_b32 v[96:97], v253 offset0:32 offset1:33
    v_mfma_f32_16x16x32_bf16 v[184:187], v[200:203], a[8:11], v[184:187]
    buffer_store_dwordx4 v[56:59], v1, s[28:31], s52 offen offset:0 sc1
    v_mfma_f32_16x16x32_bf16 v[188:191], v[204:207], a[8:11], v[188:191]
    ds_read_b128 v[132:135], v23 offset:3200
    v_mfma_f32_16x16x32_bf16 v[64:67], v[160:163], v[192:195], v[64:67]
    ds_read2_b32 v[98:99], v253 offset0:34 offset1:35
    v_mfma_f32_16x16x32_bf16 v[68:71], v[160:163], v[196:199], v[68:71]
    ds_read_b128 v[136:139], v23 offset:2688
    v_mfma_f32_16x16x32_bf16 v[68:71], v[164:167], v[192:195], v[68:71]
    ds_read2_b32 v[100:101], v253 offset0:160 offset1:161
    v_mfma_f32_16x16x32_bf16 v[72:75], v[160:163], v[200:203], v[72:75]
    buffer_store_dwordx4 v[56:59], v1, s[28:31], s52 offen offset:1024 sc1
    v_mfma_f32_16x16x32_bf16 v[72:75], v[164:167], v[196:199], v[72:75]
    ds_read_b128 v[140:143], v23 offset:2176
    v_mfma_f32_16x16x32_bf16 v[72:75], v[168:171], v[192:195], v[72:75]
    ds_read2_b32 v[102:103], v253 offset0:162 offset1:163
    v_mfma_f32_16x16x32_bf16 v[76:79], v[160:163], v[204:207], v[76:79]
    ds_read_b128 v[144:147], v23 offset:1664
    v_mfma_f32_16x16x32_bf16 v[76:79], v[164:167], v[200:203], v[76:79]
    ds_read2_b32 v[104:105], v254 offset0:32 offset1:33
    v_mfma_f32_16x16x32_bf16 v[76:79], v[168:171], v[196:199], v[76:79]
    buffer_store_dwordx4 v[56:59], v1, s[28:31], s52 offen offset:2048 sc1
    v_mfma_f32_16x16x32_bf16 v[76:79], v[172:175], v[192:195], v[76:79]
    ds_read_b128 v[148:151], v23 offset:1152
    v_mfma_f32_16x16x32_bf16 v[80:83], v[160:163], v[208:211], v[80:83]
    ds_read2_b32 v[106:107], v254 offset0:34 offset1:35
    v_mfma_f32_16x16x32_bf16 v[80:83], v[164:167], v[204:207], v[80:83]
    ds_read_b128 v[152:155], v23 offset:640
    v_mfma_f32_16x16x32_bf16 v[80:83], v[168:171], v[200:203], v[80:83]
    ds_read2_b32 v[108:109], v254 offset0:160 offset1:161
    v_mfma_f32_16x16x32_bf16 v[80:83], v[172:175], v[196:199], v[80:83]
    buffer_store_dwordx4 v[56:59], v1, s[28:31], s52 offen offset:3072 sc1
    v_mfma_f32_16x16x32_bf16 v[84:87], v[160:163], v[212:215], v[84:87]
    ds_read_b128 v[156:159], v23 offset:128
    v_mfma_f32_16x16x32_bf16 v[84:87], v[164:167], v[208:211], v[84:87]
    ds_read2_b32 v[110:111], v254 offset0:162 offset1:163
    v_mfma_f32_16x16x32_bf16 v[84:87], v[168:171], v[204:207], v[84:87]
    v_mfma_f32_16x16x32_bf16 v[84:87], v[172:175], v[200:203], v[84:87]
    v_mfma_f32_16x16x32_bf16 v[88:91], v[160:163], v[216:219], v[88:91]
    s_add_u32 s16, s52, 4096
    buffer_store_dwordx4 v[56:59], v1, s[28:31], s16 offen sc1
    v_mfma_f32_16x16x32_bf16 v[88:91], v[164:167], v[212:215], v[88:91]
    v_lshlrev_b32 v5, 5, v3
    v_lshl_add_u32 v5, v4, 3, v5
    v_mfma_f32_16x16x32_bf16 v[88:91], v[168:171], v[208:211], v[88:91]
    v_add_u32 v5, s5, v5
    v_bfe_u32 v27, v0, 1, 2
    v_mfma_f32_16x16x32_bf16 v[88:91], v[172:175], v[204:207], v[88:91]
    v_mul_u32_u24 v27, 21376, v27
    v_lshrrev_b32 v30, 3, v0
    v_mfma_f32_16x16x32_bf16 v[92:95], v[160:163], v[220:223], v[92:95]
    v_lshl_add_u32 v27, v30, 5, v27
    v_and_b32 v31, 1, v0
    v_mfma_f32_16x16x32_bf16 v[92:95], v[164:167], v[216:219], v[92:95]
    v_lshl_add_u32 v27, v31, 4, v27
    s_lshl_b32 s16, s3, 10
    v_mfma_f32_16x16x32_bf16 v[92:95], v[168:171], v[212:215], v[92:95]
    v_add_u32 v27, s16, v27
    s_lshl_b32 s16, s13, 3
    v_mfma_f32_16x16x32_bf16 v[92:95], v[172:175], v[208:211], v[92:95]
    s_add_u32 s16, s16, 25600
    v_mov_b32 v33, s16
    s_waitcnt lgkmcnt(0)
    v_mfma_f32_16x16x32_bf16 v[64:67], v[96:99], v[128:131], v[64:67]
    ds_read_b128 v[192:195], v23 offset:3776
    v_cvt_pk_bf16_f32 v36, v36, v176
    v_mfma_f32_16x16x32_bf16 v[68:71], v[96:99], v[132:135], v[68:71]
    ds_read2_b32 v[160:161], v253 offset0:48 offset1:49
    v_cvt_pk_bf16_f32 v37, v37, v177
    v_mfma_f32_16x16x32_bf16 v[68:71], v[100:103], v[128:131], v[68:71]
    ds_read_b128 v[196:199], v23 offset:3264
    v_cvt_pk_bf16_f32 v38, v38, v178
    v_mfma_f32_16x16x32_bf16 v[72:75], v[96:99], v[136:139], v[72:75]
    ds_read2_b32 v[162:163], v253 offset0:50 offset1:51
    v_cvt_pk_bf16_f32 v39, v39, v179
    v_mfma_f32_16x16x32_bf16 v[72:75], v[100:103], v[132:135], v[72:75]
    ds_read_b128 v[200:203], v23 offset:2752
    v_cvt_pk_bf16_f32 v40, v40, v180
    v_mfma_f32_16x16x32_bf16 v[72:75], v[104:107], v[128:131], v[72:75]
    ds_read2_b32 v[164:165], v253 offset0:176 offset1:177
    v_cvt_pk_bf16_f32 v41, v41, v181
    v_mfma_f32_16x16x32_bf16 v[76:79], v[96:99], v[140:143], v[76:79]
    ds_read_b128 v[204:207], v23 offset:2240
    v_cvt_pk_bf16_f32 v42, v42, v182
    v_mfma_f32_16x16x32_bf16 v[76:79], v[100:103], v[136:139], v[76:79]
    ds_read2_b32 v[166:167], v253 offset0:178 offset1:179
    v_cvt_pk_bf16_f32 v43, v43, v183
    v_mfma_f32_16x16x32_bf16 v[76:79], v[104:107], v[132:135], v[76:79]
    ds_read_b128 v[208:211], v23 offset:1728
    v_cvt_pk_bf16_f32 v44, v44, v184
    v_mfma_f32_16x16x32_bf16 v[76:79], v[108:111], v[128:131], v[76:79]
    ds_read2_b32 v[168:169], v254 offset0:48 offset1:49
    v_cvt_pk_bf16_f32 v45, v45, v185
    v_mfma_f32_16x16x32_bf16 v[80:83], v[96:99], v[144:147], v[80:83]
    ds_read_b128 v[212:215], v23 offset:1216
    v_cvt_pk_bf16_f32 v46, v46, v186
    v_mfma_f32_16x16x32_bf16 v[80:83], v[100:103], v[140:143], v[80:83]
    ds_read2_b32 v[170:171], v254 offset0:50 offset1:51
    v_cvt_pk_bf16_f32 v47, v47, v187
    v_mfma_f32_16x16x32_bf16 v[80:83], v[104:107], v[136:139], v[80:83]
    ds_read_b128 v[216:219], v23 offset:704
    v_cvt_pk_bf16_f32 v48, v48, v188
    v_mfma_f32_16x16x32_bf16 v[80:83], v[108:111], v[132:135], v[80:83]
    ds_read2_b32 v[172:173], v254 offset0:176 offset1:177
    v_cvt_pk_bf16_f32 v49, v49, v189
    v_mfma_f32_16x16x32_bf16 v[84:87], v[96:99], v[148:151], v[84:87]
    ds_read_b128 v[220:223], v23 offset:192
    v_cvt_pk_bf16_f32 v50, v50, v190
    v_mfma_f32_16x16x32_bf16 v[84:87], v[100:103], v[144:147], v[84:87]
    ds_read2_b32 v[174:175], v254 offset0:178 offset1:179
    v_cvt_pk_bf16_f32 v51, v51, v191
    v_mfma_f32_16x16x32_bf16 v[84:87], v[104:107], v[140:143], v[84:87]
    ds_read2_b32 v[112:113], v26 offset0:3 offset1:2
    s_lshl_b32 s16, s3, 8
    v_mfma_f32_16x16x32_bf16 v[84:87], v[108:111], v[136:139], v[84:87]
    ds_read2_b32 v[114:115], v26 offset0:1 offset1:0
    s_add_u32 s16, s16, s14
    v_mfma_f32_16x16x32_bf16 v[88:91], v[96:99], v[152:155], v[88:91]
    ds_read2_b32 v[116:117], v26 offset0:19 offset1:18
    s_lshl_b32 s16, s16, 7
    v_mfma_f32_16x16x32_bf16 v[88:91], v[100:103], v[148:151], v[88:91]
    ds_read2_b32 v[118:119], v26 offset0:17 offset1:16
    s_add_u32 s49, s16, 51412992
    v_mfma_f32_16x16x32_bf16 v[88:91], v[104:107], v[144:147], v[88:91]
    ds_read2_b32 v[120:121], v26 offset0:35 offset1:34
    v_lshlrev_b32 v10, 2, v0
    v_mfma_f32_16x16x32_bf16 v[88:91], v[108:111], v[140:143], v[88:91]
    ds_read2_b32 v[122:123], v26 offset0:33 offset1:32
    v_and_b32 v10, 124, v10
    v_mfma_f32_16x16x32_bf16 v[92:95], v[96:99], v[156:159], v[92:95]
    ds_read2_b32 v[124:125], v26 offset0:51 offset1:50
    v_mov_b32 v11, s8
    v_mfma_f32_16x16x32_bf16 v[92:95], v[100:103], v[152:155], v[92:95]
    ds_read2_b32 v[126:127], v26 offset0:49 offset1:48
    v_mfma_f32_16x16x32_bf16 v[92:95], v[104:107], v[148:151], v[92:95]
    buffer_load_dwordx2 v[34:35], v33, s[28:31], 0 offen sc1
    v_mfma_f32_16x16x32_bf16 v[92:95], v[108:111], v[144:147], v[92:95]
    s_waitcnt lgkmcnt(0)
    v_mfma_f32_16x16x32_bf16 v[80:83], v[36:39], v[112:115], v[80:83]
    ds_read_b128 v[128:131], v23 offset:3840
    v_mfma_f32_16x16x32_bf16 v[84:87], v[36:39], v[116:119], v[84:87]
    ds_read2_b32 v[96:97], v253 offset0:64 offset1:65
    v_mfma_f32_16x16x32_bf16 v[84:87], v[40:43], v[112:115], v[84:87]
    ds_read_b128 v[132:135], v23 offset:3328
    v_mfma_f32_16x16x32_bf16 v[88:91], v[36:39], v[120:123], v[88:91]
    buffer_load_dwordx2 v[228:229], v32, s[36:39], s47 offen offset:0
    v_mfma_f32_16x16x32_bf16 v[88:91], v[40:43], v[116:119], v[88:91]
    ds_read2_b32 v[98:99], v253 offset0:66 offset1:67
    v_mfma_f32_16x16x32_bf16 v[88:91], v[44:47], v[112:115], v[88:91]
    ds_read_b128 v[136:139], v23 offset:2816
    v_mfma_f32_16x16x32_bf16 v[92:95], v[36:39], v[124:127], v[92:95]
    ds_read2_b32 v[100:101], v253 offset0:192 offset1:193
    v_mfma_f32_16x16x32_bf16 v[92:95], v[40:43], v[120:123], v[92:95]
    ds_read_b128 v[140:143], v23 offset:2304
    v_mfma_f32_16x16x32_bf16 v[92:95], v[44:47], v[116:119], v[92:95]
    buffer_load_dwordx2 v[230:231], v32, s[36:39], s47 offen offset:32
    v_mfma_f32_16x16x32_bf16 v[92:95], v[48:51], v[112:115], v[92:95]
    ds_read2_b32 v[102:103], v253 offset0:194 offset1:195
    v_mfma_f32_16x16x32_bf16 v[64:67], v[160:163], v[192:195], v[64:67]
    ds_read_b128 v[144:147], v23 offset:1792
    v_mfma_f32_16x16x32_bf16 v[68:71], v[160:163], v[196:199], v[68:71]
    ds_read2_b32 v[104:105], v254 offset0:64 offset1:65
    v_mfma_f32_16x16x32_bf16 v[68:71], v[164:167], v[192:195], v[68:71]
    ds_read_b128 v[148:151], v23 offset:1280
    v_mfma_f32_16x16x32_bf16 v[72:75], v[160:163], v[200:203], v[72:75]
    buffer_load_dwordx2 v[232:233], v32, s[36:39], s47 offen offset:64
    v_mfma_f32_16x16x32_bf16 v[72:75], v[164:167], v[196:199], v[72:75]
    ds_read2_b32 v[106:107], v254 offset0:66 offset1:67
    v_mfma_f32_16x16x32_bf16 v[72:75], v[168:171], v[192:195], v[72:75]
    ds_read_b128 v[152:155], v23 offset:768
    v_mfma_f32_16x16x32_bf16 v[76:79], v[160:163], v[204:207], v[76:79]
    ds_read2_b32 v[108:109], v254 offset0:192 offset1:193
    v_mfma_f32_16x16x32_bf16 v[76:79], v[164:167], v[200:203], v[76:79]
    ds_read_b128 v[156:159], v23 offset:256
    v_mfma_f32_16x16x32_bf16 v[76:79], v[168:171], v[196:199], v[76:79]
    buffer_load_dwordx2 v[234:235], v32, s[36:39], s47 offen offset:96
    v_mfma_f32_16x16x32_bf16 v[76:79], v[172:175], v[192:195], v[76:79]
    ds_read2_b32 v[110:111], v254 offset0:194 offset1:195
    v_mfma_f32_16x16x32_bf16 v[80:83], v[160:163], v[208:211], v[80:83]
    v_mfma_f32_16x16x32_bf16 v[80:83], v[164:167], v[204:207], v[80:83]
    v_mfma_f32_16x16x32_bf16 v[80:83], v[168:171], v[200:203], v[80:83]
    v_mfma_f32_16x16x32_bf16 v[80:83], v[172:175], v[196:199], v[80:83]
    buffer_load_dwordx2 v[236:237], v32, s[36:39], s47 offen offset:128
    v_mfma_f32_16x16x32_bf16 v[84:87], v[160:163], v[212:215], v[84:87]
    v_and_b32 v9, 7, v0
    v_add_u32 v9, s45, v9
    v_mfma_f32_16x16x32_bf16 v[84:87], v[164:167], v[208:211], v[84:87]
    v_min_u32 v9, 17, v9
    v_lshrrev_b32 v9, 1, v9
    v_mfma_f32_16x16x32_bf16 v[84:87], v[168:171], v[204:207], v[84:87]
    v_lshrrev_b32 v30, 3, v0
    v_min_u32 v30, 6, v30
    v_mfma_f32_16x16x32_bf16 v[84:87], v[172:175], v[200:203], v[84:87]
    v_mul_u32_u24 v30, 9, v30
    v_add_u32 v9, v9, v30
    v_mfma_f32_16x16x32_bf16 v[88:91], v[160:163], v[216:219], v[88:91]
    v_lshlrev_b32 v9, 7, v9
    v_add_u32 v9, 51214084, v9
    v_mfma_f32_16x16x32_bf16 v[88:91], v[164:167], v[212:215], v[88:91]
    s_lshl_b32 s16, s45, 3
    v_add_u32 v30, s16, v0
    v_mfma_f32_16x16x32_bf16 v[88:91], v[168:171], v[208:211], v[88:91]
    v_min_u32 v30, 143, v30
    s_bfe_u32 s16, s2, 0x20005
    v_mfma_f32_16x16x32_bf16 v[88:91], v[172:175], v[204:207], v[88:91]
    s_lshl_b32 s16, s16, 15
    s_add_u32 s16, s16, 51412992
    v_mfma_f32_16x16x32_bf16 v[92:95], v[160:163], v[220:223], v[92:95]
    v_lshl_add_u32 v30, v30, 7, s16
    v_cmp_gt_u32 vcc, 40, v0
    v_mfma_f32_16x16x32_bf16 v[92:95], v[164:167], v[216:219], v[92:95]
    s_nop 0
    v_cndmask_b32 v9, v9, v30, vcc
    v_mfma_f32_16x16x32_bf16 v[92:95], v[168:171], v[212:215], v[92:95]
    s_waitcnt vmcnt(6)
    v_mfma_f32_16x16x32_bf16 v[92:95], v[172:175], v[208:211], v[92:95]
    buffer_store_dword v11, v10, s[28:31], s49 offen sc1
    s_waitcnt lgkmcnt(0)
    v_mfma_f32_16x16x32_bf16 v[64:67], v[96:99], v[128:131], v[64:67]
    ds_read_b128 v[192:195], v23 offset:3904
    v_mfma_f32_16x16x32_bf16 v[68:71], v[96:99], v[132:135], v[68:71]
    ds_read2_b32 v[160:161], v253 offset0:80 offset1:81
    v_mfma_f32_16x16x32_bf16 v[68:71], v[100:103], v[128:131], v[68:71]
    ds_read_b128 v[196:199], v23 offset:3392
    v_mfma_f32_16x16x32_bf16 v[72:75], v[96:99], v[136:139], v[72:75]
    ds_read2_b32 v[162:163], v253 offset0:82 offset1:83
    v_mfma_f32_16x16x32_bf16 v[72:75], v[100:103], v[132:135], v[72:75]
    buffer_load_dwordx2 v[238:239], v32, s[36:39], s47 offen offset:160
    v_mfma_f32_16x16x32_bf16 v[72:75], v[104:107], v[128:131], v[72:75]
    ds_read_b128 v[200:203], v23 offset:2880
    v_mfma_f32_16x16x32_bf16 v[76:79], v[96:99], v[140:143], v[76:79]
    ds_read2_b32 v[164:165], v253 offset0:208 offset1:209
    v_mfma_f32_16x16x32_bf16 v[76:79], v[100:103], v[136:139], v[76:79]
    ds_read_b128 v[204:207], v23 offset:2368
    v_mfma_f32_16x16x32_bf16 v[76:79], v[104:107], v[132:135], v[76:79]
    ds_read2_b32 v[166:167], v253 offset0:210 offset1:211
    v_mfma_f32_16x16x32_bf16 v[76:79], v[108:111], v[128:131], v[76:79]
    buffer_load_dwordx2 v[240:241], v32, s[36:39], s47 offen offset:192
    v_mfma_f32_16x16x32_bf16 v[80:83], v[96:99], v[144:147], v[80:83]
    ds_read_b128 v[208:211], v23 offset:1856
    v_mfma_f32_16x16x32_bf16 v[80:83], v[100:103], v[140:143], v[80:83]
    ds_read2_b32 v[168:169], v254 offset0:80 offset1:81
    v_mfma_f32_16x16x32_bf16 v[80:83], v[104:107], v[136:139], v[80:83]
    ds_read_b128 v[212:215], v23 offset:1344
    v_mfma_f32_16x16x32_bf16 v[80:83], v[108:111], v[132:135], v[80:83]
    ds_read2_b32 v[170:171], v254 offset0:82 offset1:83
    v_mfma_f32_16x16x32_bf16 v[84:87], v[96:99], v[148:151], v[84:87]
    buffer_load_dwordx2 v[242:243], v32, s[36:39], s47 offen offset:224
    v_mfma_f32_16x16x32_bf16 v[84:87], v[100:103], v[144:147], v[84:87]
    ds_read_b128 v[216:219], v23 offset:832
    v_mfma_f32_16x16x32_bf16 v[84:87], v[104:107], v[140:143], v[84:87]
    ds_read2_b32 v[172:173], v254 offset0:208 offset1:209
    v_mfma_f32_16x16x32_bf16 v[84:87], v[108:111], v[136:139], v[84:87]
    ds_read_b128 v[220:223], v23 offset:320
    v_mfma_f32_16x16x32_bf16 v[88:91], v[96:99], v[152:155], v[88:91]
    ds_read2_b32 v[174:175], v254 offset0:210 offset1:211
    v_mfma_f32_16x16x32_bf16 v[88:91], v[100:103], v[148:151], v[88:91]
    buffer_load_dwordx2 v[244:245], v32, s[36:39], s47 offen offset:256
    v_mfma_f32_16x16x32_bf16 v[88:91], v[104:107], v[144:147], v[88:91]
    v_mfma_f32_16x16x32_bf16 v[88:91], v[108:111], v[140:143], v[88:91]
    v_mfma_f32_16x16x32_bf16 v[92:95], v[96:99], v[156:159], v[92:95]
    v_mfma_f32_16x16x32_bf16 v[92:95], v[100:103], v[152:155], v[92:95]
    v_mfma_f32_16x16x32_bf16 v[92:95], v[104:107], v[148:151], v[92:95]
    buffer_load_dwordx2 v[246:247], v32, s[36:39], s47 offen offset:288
    v_mfma_f32_16x16x32_bf16 v[92:95], v[108:111], v[144:147], v[92:95]
    s_waitcnt lgkmcnt(0)
    v_mfma_f32_16x16x32_bf16 v[64:67], v[160:163], v[192:195], v[64:67]
    ds_read_b128 v[128:131], v23 offset:3968
    v_mfma_f32_16x16x32_bf16 v[68:71], v[160:163], v[196:199], v[68:71]
    ds_read2_b32 v[96:97], v253 offset0:96 offset1:97
    v_mfma_f32_16x16x32_bf16 v[68:71], v[164:167], v[192:195], v[68:71]
    ds_read_b128 v[132:135], v23 offset:3456
    v_mfma_f32_16x16x32_bf16 v[72:75], v[160:163], v[200:203], v[72:75]
    ds_read2_b32 v[98:99], v253 offset0:98 offset1:99
    v_mfma_f32_16x16x32_bf16 v[72:75], v[164:167], v[196:199], v[72:75]
    ds_read_b128 v[136:139], v23 offset:2944
    v_mfma_f32_16x16x32_bf16 v[72:75], v[168:171], v[192:195], v[72:75]
    ds_read2_b32 v[100:101], v253 offset0:224 offset1:225
    v_mfma_f32_16x16x32_bf16 v[76:79], v[160:163], v[204:207], v[76:79]
    ds_read_b128 v[140:143], v23 offset:2432
    v_mfma_f32_16x16x32_bf16 v[76:79], v[164:167], v[200:203], v[76:79]
    ds_read2_b32 v[102:103], v253 offset0:226 offset1:227
    v_mfma_f32_16x16x32_bf16 v[76:79], v[168:171], v[196:199], v[76:79]
    ds_read_b128 v[144:147], v23 offset:1920
    v_mfma_f32_16x16x32_bf16 v[76:79], v[172:175], v[192:195], v[76:79]
    ds_read2_b32 v[104:105], v254 offset0:96 offset1:97
    v_mfma_f32_16x16x32_bf16 v[80:83], v[160:163], v[208:211], v[80:83]
    ds_read_b128 v[148:151], v23 offset:1408
    v_mfma_f32_16x16x32_bf16 v[80:83], v[164:167], v[204:207], v[80:83]
    ds_read2_b32 v[106:107], v254 offset0:98 offset1:99
    v_mfma_f32_16x16x32_bf16 v[80:83], v[168:171], v[200:203], v[80:83]
    ds_read_b128 v[152:155], v23 offset:896
    v_mfma_f32_16x16x32_bf16 v[80:83], v[172:175], v[196:199], v[80:83]
    ds_read2_b32 v[108:109], v254 offset0:224 offset1:225
    v_mfma_f32_16x16x32_bf16 v[84:87], v[160:163], v[212:215], v[84:87]
    ds_read_b128 v[156:159], v23 offset:384
    v_mfma_f32_16x16x32_bf16 v[84:87], v[164:167], v[208:211], v[84:87]
    ds_read2_b32 v[110:111], v254 offset0:226 offset1:227
    v_mfma_f32_16x16x32_bf16 v[84:87], v[168:171], v[204:207], v[84:87]
    v_mfma_f32_16x16x32_bf16 v[84:87], v[172:175], v[200:203], v[84:87]
    v_mfma_f32_16x16x32_bf16 v[88:91], v[160:163], v[216:219], v[88:91]
    v_mfma_f32_16x16x32_bf16 v[88:91], v[164:167], v[212:215], v[88:91]
    v_mfma_f32_16x16x32_bf16 v[88:91], v[168:171], v[208:211], v[88:91]
    v_mfma_f32_16x16x32_bf16 v[88:91], v[172:175], v[204:207], v[88:91]
    v_mfma_f32_16x16x32_bf16 v[92:95], v[160:163], v[220:223], v[92:95]
    v_mfma_f32_16x16x32_bf16 v[92:95], v[164:167], v[216:219], v[92:95]
    v_mfma_f32_16x16x32_bf16 v[92:95], v[168:171], v[212:215], v[92:95]
    v_mfma_f32_16x16x32_bf16 v[92:95], v[172:175], v[208:211], v[92:95]
    s_waitcnt lgkmcnt(0)
    v_mfma_f32_16x16x32_bf16 v[64:67], v[96:99], v[128:131], v[64:67]
    ds_read_b128 v[192:195], v23 offset:4032
    v_mfma_f32_16x16x32_bf16 v[68:71], v[96:99], v[132:135], v[68:71]
    ds_read2_b32 v[160:161], v253 offset0:112 offset1:113
    v_mfma_f32_16x16x32_bf16 v[68:71], v[100:103], v[128:131], v[68:71]
    ds_read_b128 v[196:199], v23 offset:3520
    v_mfma_f32_16x16x32_bf16 v[72:75], v[96:99], v[136:139], v[72:75]
    ds_read2_b32 v[162:163], v253 offset0:114 offset1:115
    s_waitcnt vmcnt(11)
    v_mfma_f32_16x16x32_bf16 v[72:75], v[100:103], v[132:135], v[72:75]
    ds_read_b128 v[200:203], v23 offset:3008
    v_mfma_f32_16x16x32_bf16 v[72:75], v[104:107], v[128:131], v[72:75]
    ds_read2_b32 v[164:165], v253 offset0:240 offset1:241
    v_mfma_f32_16x16x32_bf16 v[76:79], v[96:99], v[140:143], v[76:79]
    ds_read_b128 v[204:207], v23 offset:2496
    v_mfma_f32_16x16x32_bf16 v[76:79], v[100:103], v[136:139], v[76:79]
    ds_read2_b32 v[166:167], v253 offset0:242 offset1:243
    v_cmp_ne_u32 vcc, s8, v35
    s_nop 0
    s_cbranch_vccnz PB_SLOW
PB_RET:
    v_mfma_f32_16x16x32_bf16 v[76:79], v[104:107], v[132:135], v[76:79]
    ds_read_b128 v[208:211], v23 offset:1984
    v_readfirstlane_b32 s40, v34
    v_mfma_f32_16x16x32_bf16 v[76:79], v[108:111], v[128:131], v[76:79]
    ds_read2_b32 v[168:169], v254 offset0:112 offset1:113
    v_mfma_f32_16x16x32_bf16 v[80:83], v[96:99], v[144:147], v[80:83]
    ds_read_b128 v[212:215], v23 offset:1472
    v_mfma_f32_16x16x32_bf16 v[80:83], v[100:103], v[140:143], v[80:83]
    ds_read2_b32 v[170:171], v254 offset0:114 offset1:115
    v_mfma_f32_16x16x32_bf16 v[80:83], v[104:107], v[136:139], v[80:83]
    ds_read_b128 v[216:219], v23 offset:960
    v_mfma_f32_16x16x32_bf16 v[80:83], v[108:111], v[132:135], v[80:83]
    ds_read2_b32 v[172:173], v254 offset0:240 offset1:241
    v_mfma_f32_16x16x32_bf16 v[84:87], v[96:99], v[148:151], v[84:87]
    ds_read_b128 v[220:223], v23 offset:448
    v_mfma_f32_16x16x32_bf16 v[84:87], v[100:103], v[144:147], v[84:87]
    ds_read2_b32 v[174:175], v254 offset0:242 offset1:243
    v_mfma_f32_16x16x32_bf16 v[84:87], v[104:107], v[140:143], v[84:87]
    v_mfma_f32_16x16x32_bf16 v[84:87], v[108:111], v[136:139], v[84:87]
    v_mfma_f32_16x16x32_bf16 v[88:91], v[96:99], v[152:155], v[88:91]
    v_mfma_f32_16x16x32_bf16 v[88:91], v[100:103], v[148:151], v[88:91]
    v_mfma_f32_16x16x32_bf16 v[88:91], v[104:107], v[144:147], v[88:91]
    v_mfma_f32_16x16x32_bf16 v[88:91], v[108:111], v[140:143], v[88:91]
    v_mfma_f32_16x16x32_bf16 v[92:95], v[96:99], v[156:159], v[92:95]
    v_mfma_f32_16x16x32_bf16 v[92:95], v[100:103], v[152:155], v[92:95]
    v_mfma_f32_16x16x32_bf16 v[92:95], v[104:107], v[148:151], v[92:95]
    v_mfma_f32_16x16x32_bf16 v[92:95], v[108:111], v[144:147], v[92:95]
    s_waitcnt lgkmcnt(0)
    v_mfma_f32_16x16x32_bf16 v[64:67], v[160:163], v[192:195], v[64:67]
    v_mfma_f32_16x16x32_bf16 v[68:71], v[160:163], v[196:199], v[68:71]
    v_mfma_f32_16x16x32_bf16 v[68:71], v[164:167], v[192:195], v[68:71]
    v_mfma_f32_16x16x32_bf16 v[72:75], v[160:163], v[200:203], v[72:75]
    v_mfma_f32_16x16x32_bf16 v[72:75], v[164:167], v[196:199], v[72:75]
    v_mfma_f32_16x16x32_bf16 v[72:75], v[168:171], v[192:195], v[72:75]
    v_mfma_f32_16x16x32_bf16 v[76:79], v[160:163], v[204:207], v[76:79]
    s_nop 1
    v_mul_f32 v64, s40, v64
    v_mul_f32 v65, s40, v65
    v_mfma_f32_16x16x32_bf16 v[76:79], v[164:167], v[200:203], v[76:79]
    v_mul_f32 v66, s40, v66
    v_mul_f32 v67, s40, v67
    v_mfma_f32_16x16x32_bf16 v[76:79], v[168:171], v[196:199], v[76:79]
    v_cvt_pk_bf16_f32 v64, v64, v65
    v_cvt_pk_bf16_f32 v65, v66, v67
    v_mfma_f32_16x16x32_bf16 v[76:79], v[172:175], v[192:195], v[76:79]
    ds_write_b64 v5, v[64:65] offset:0
    v_mfma_f32_16x16x32_bf16 v[80:83], v[160:163], v[208:211], v[80:83]
    v_mul_f32 v68, s40, v68
    v_mul_f32 v69, s40, v69
    v_mfma_f32_16x16x32_bf16 v[80:83], v[164:167], v[204:207], v[80:83]
    v_mul_f32 v70, s40, v70
    v_mul_f32 v71, s40, v71
    v_mfma_f32_16x16x32_bf16 v[80:83], v[168:171], v[200:203], v[80:83]
    v_cvt_pk_bf16_f32 v68, v68, v69
    v_cvt_pk_bf16_f32 v69, v70, v71
    v_mfma_f32_16x16x32_bf16 v[80:83], v[172:175], v[196:199], v[80:83]
    ds_write_b64 v5, v[68:69] offset:512
    v_mfma_f32_16x16x32_bf16 v[84:87], v[160:163], v[212:215], v[84:87]
    v_mul_f32 v72, s40, v72
    v_mul_f32 v73, s40, v73
    v_mfma_f32_16x16x32_bf16 v[84:87], v[164:167], v[208:211], v[84:87]
    v_mul_f32 v74, s40, v74
    v_mul_f32 v75, s40, v75
    v_mfma_f32_16x16x32_bf16 v[84:87], v[168:171], v[204:207], v[84:87]
    v_cvt_pk_bf16_f32 v72, v72, v73
    v_cvt_pk_bf16_f32 v73, v74, v75
    v_mfma_f32_16x16x32_bf16 v[84:87], v[172:175], v[200:203], v[84:87]
    ds_write_b64 v5, v[72:73] offset:1024
    v_mfma_f32_16x16x32_bf16 v[88:91], v[160:163], v[216:219], v[88:91]
    v_mul_f32 v76, s40, v76
    v_mul_f32 v77, s40, v77
    v_mfma_f32_16x16x32_bf16 v[88:91], v[164:167], v[212:215], v[88:91]
    v_mul_f32 v78, s40, v78
    v_mul_f32 v79, s40, v79
    v_mfma_f32_16x16x32_bf16 v[88:91], v[168:171], v[208:211], v[88:91]
    v_cvt_pk_bf16_f32 v76, v76, v77
    v_cvt_pk_bf16_f32 v77, v78, v79
    v_mfma_f32_16x16x32_bf16 v[88:91], v[172:175], v[204:207], v[88:91]
    ds_write_b64 v5, v[76:77] offset:1536
    v_mfma_f32_16x16x32_bf16 v[92:95], v[160:163], v[220:223], v[92:95]
    v_mul_f32 v80, s40, v80
    v_mul_f32 v81, s40, v81
    v_mfma_f32_16x16x32_bf16 v[92:95], v[164:167], v[216:219], v[92:95]
    v_mul_f32 v82, s40, v82
    v_mul_f32 v83, s40, v83
    v_mfma_f32_16x16x32_bf16 v[92:95], v[168:171], v[212:215], v[92:95]
    v_cvt_pk_bf16_f32 v80, v80, v81
    v_cvt_pk_bf16_f32 v81, v82, v83
    v_mfma_f32_16x16x32_bf16 v[92:95], v[172:175], v[208:211], v[92:95]
    ds_write_b64 v5, v[80:81] offset:2048
    v_mul_f32 v84, s40, v84
    v_mul_f32 v85, s40, v85
    v_mul_f32 v86, s40, v86
    v_mul_f32 v87, s40, v87
    v_cvt_pk_bf16_f32 v84, v84, v85
    v_cvt_pk_bf16_f32 v85, v86, v87
    ds_write_b64 v5, v[84:85] offset:2560
    v_mul_f32 v88, s40, v88
    v_mul_f32 v89, s40, v89
    v_mul_f32 v90, s40, v90
    v_mul_f32 v91, s40, v91
    v_cvt_pk_bf16_f32 v88, v88, v89
    v_cvt_pk_bf16_f32 v89, v90, v91
    ds_write_b64 v5, v[88:89] offset:3072
    v_mul_f32 v92, s40, v92
    v_mul_f32 v93, s40, v93
    v_mul_f32 v94, s40, v94
    v_mul_f32 v95, s40, v95
    v_cvt_pk_bf16_f32 v92, v92, v93
    v_cvt_pk_bf16_f32 v93, v94, v95
    ds_write_b64 v5, v[92:93] offset:3584
    s_waitcnt lgkmcnt(0)
    s_barrier
    ds_read_b128 v[64:67], v27 offset:0
    ds_read_b128 v[68:71], v27 offset:256
    ds_read_b128 v[72:75], v27 offset:512
    ds_read_b128 v[76:79], v27 offset:768
    s_waitcnt lgkmcnt(3)
    buffer_store_dwordx4 v[64:67], v29, s[28:31], s17 offen sc1
    s_add_u32 s17, s17, 147456
    s_waitcnt lgkmcnt(2)
    buffer_store_dwordx4 v[68:71], v29, s[28:31], s17 offen sc1
    s_add_u32 s17, s17, 147456
    s_waitcnt lgkmcnt(1)
    buffer_store_dwordx4 v[72:75], v29, s[28:31], s17 offen sc1
    s_add_u32 s17, s17, 147456
    s_waitcnt lgkmcnt(0)
    buffer_store_dwordx4 v[76:79], v29, s[28:31], s17 offen sc1
    buffer_load_dword v15, v9, s[28:31], 0 offen sc1
    v_lshrrev_b32 v28, 3, v0
    v_and_b32 v29, 6, v28
    v_and_b32 v30, 7, v0
    v_xor_b32 v29, v29, v30
    v_lshlrev_b32 v29, 4, v29
    s_lshl_b32 s16, s3, 3
    v_add_u32 v28, s16, v28
    v_mul_u32_u24 v28, 9216, v28
    v_add_u32 v28, v28, v29
    s_waitcnt vmcnt(5)
    s_cmp_ge_u32 s2, 128
    s_cbranch_scc1 CV_T
    s_lshl_b32 s18, s45, 7
    s_add_u32 s18, s18, 6912
    s_mul_i32 s19, s3, 3072
    s_add_u32 s19, s19, 28672
    s_lshl_b32 s48, s2, 7
    s_add_u32 s54, s48, 51642368
    v_lshlrev_b32 v10, 2, v0
    v_and_b32 v10, 124, v10
    v_mov_b32 v52, s8
    v_mov_b32 v53, s8
    v_mov_b32 v54, s8
    v_mov_b32 v55, s8
    s_cmp_lt_u32 s3, 2
    s_cbranch_scc1 LN2_Z
    v_mov_b32 v244, 0
    v_mov_b32 v245, 0
    v_mov_b32 v246, 0
    v_mov_b32 v247, 0
LN2_Z:
    v_mov_b64 v[176:177], v[228:229]
    v_mov_b64 v[178:179], v[230:231]
    v_mov_b64 v[180:181], v[232:233]
    v_mov_b64 v[182:183], v[234:235]
    v_mov_b64 v[184:185], v[236:237]
    v_mov_b64 v[186:187], v[238:239]
    v_mov_b64 v[188:189], v[240:241]
    v_mov_b64 v[190:191], v[242:243]
    v_mov_b64 v[192:193], v[244:245]
    v_mov_b64 v[194:195], v[246:247]
    v_lshlrev_b32 v216, 16, v176
    v_and_b32 v217, s43, v176
    v_lshlrev_b32 v218, 16, v177
    v_and_b32 v219, s43, v177
    v_lshlrev_b32 v220, 16, v178
    v_and_b32 v221, s43, v178
    v_lshlrev_b32 v222, 16, v179
    v_and_b32 v223, s43, v179
    v_lshlrev_b32 v224, 16, v180
    v_and_b32 v225, s43, v180
    v_lshlrev_b32 v226, 16, v181
    v_and_b32 v227, s43, v181
    v_lshlrev_b32 v228, 16, v182
    v_and_b32 v229, s43, v182
    v_lshlrev_b32 v230, 16, v183
    v_and_b32 v231, s43, v183
    v_lshlrev_b32 v232, 16, v184
    v_and_b32 v233, s43, v184
    v_lshlrev_b32 v234, 16, v185
    v_and_b32 v235, s43, v185
    v_lshlrev_b32 v236, 16, v186
    v_and_b32 v237, s43, v186
    v_lshlrev_b32 v238, 16, v187
    v_and_b32 v239, s43, v187
    v_lshlrev_b32 v240, 16, v188
    v_and_b32 v241, s43, v188
    v_lshlrev_b32 v242, 16, v189
    v_and_b32 v243, s43, v189
    v_lshlrev_b32 v244, 16, v190
    v_and_b32 v245, s43, v190
    v_lshlrev_b32 v246, 16, v191
    v_and_b32 v247, s43, v191
    v_lshlrev_b32 v248, 16, v192
    v_and_b32 v249, s43, v192
    v_lshlrev_b32 v250, 16, v193
    v_and_b32 v251, s43, v193
    v_lshlrev_b32 v252, 16, v194
    v_and_b32 v253, s43, v194
    v_lshlrev_b32 v254, 16, v195
    v_and_b32 v255, s43, v195
    s_add_u32 s51, s51, 6291456
    s_add_u32 s55, s51, 4096
    s_add_u32 s50, s50, 86016
    s_cmp_eq_u32 s3, 0
    s_cselect_b32 s52, s52, s51
    v_lshl_add_u32 v12, v0, 3, s50
    v_lshl_add_u32 v8, v4, 4, s19
    v_lshlrev_b32 v13, 2, v3
    v_add_u32 v13, 104448, v13
    v_bfe_u32 v14, v0, 5, 1
    v_lshl_add_u32 v14, v14, 6, v13
    s_lshl_b32 s16, s3, 7
    v_add_u32 v14, s16, v14
    v_mov_b32 v48, 0
    v_mov_b32 v49, 0
    v_mov_b32 v50, 0
    v_mov_b32 v51, 0
    v_mov_b32 v26, 0x3f80
    v_mov_b32 v27, 0x3f800000
    s_waitcnt vmcnt(0)
    v_cmp_ne_u32 vcc, s8, v15
    s_mov_b32 s56, 0
    s_mov_b32 s59, 0
    s_lshr_b32 s58, vcc_hi, 8
    s_and_b32 vcc_hi, vcc_hi, 0xff
    s_cmp_eq_u64 vcc, 0
    s_cbranch_scc1 LN2_PMOK
    s_mov_b64 exec, vcc
    s_mov_b32 s16, 0
LN2_PM:
    buffer_load_dword v15, v9, s[28:31], 0 offen sc1
    s_add_u32 s16, s16, 1
    s_waitcnt vmcnt(0)
    v_cmp_ne_u32 vcc, s8, v15
    s_cmp_ge_u32 s16, 60000
    s_cbranch_scc1 LN2_PM_X
    s_and_b64 vcc, vcc, exec
    s_cbranch_scc0 LN2_PM_X
    s_mov_b64 exec, vcc
    s_sleep 2
    s_branch LN2_PM
LN2_PM_X:
    s_mov_b64 exec, -1
LN2_PMOK:
    s_cmp_lg_u32 s58, 0
    s_cbranch_scc1 LN2_RT
    s_mov_b32 m0, s19
    s_add_u32 s17, s18, 2304
    buffer_load_dwordx4 v1, s[28:31], s18 offen sc1 lds
    s_add_u32 m0, s19, 1024
    s_nop 0
    buffer_load_dwordx4 v1, s[28:31], s17 offen sc1 lds
LN2_RT:
    s_mov_b32 m0, s50
    s_add_u32 s56, s56, 1
    buffer_load_dwordx4 v1, s[28:31], s51 offen offset:0 sc1 lds
    buffer_load_dwordx4 v1, s[28:31], s51 offen offset:1024 sc1 lds
    buffer_load_dwordx4 v1, s[28:31], s51 offen offset:2048 sc1 lds
    buffer_load_dwordx4 v1, s[28:31], s51 offen offset:3072 sc1 lds
    s_add_u32 m0, s50, 4096
    s_cmp_ge_u32 s3, 2
    s_cbranch_scc1 LN2_A
    buffer_load_dwordx4 v1, s[28:31], s55 offen sc1 lds
LN2_A:
    s_cmp_eq_u32 s58, 0
    s_cbranch_scc1 LN2_A1
    s_mov_b32 exec_lo, 0
    s_mov_b32 exec_hi, 0xffffff00
    buffer_load_dword v15, v9, s[28:31], 0 offen sc1
    s_mov_b64 exec, -1
    s_waitcnt vmcnt(0)
    v_cmp_ne_u32 vcc, s8, v15
    s_nop 1
    s_cbranch_vccnz LN2_A2
    s_mov_b32 s58, 0
    s_mov_b32 s59, 1
    s_mov_b32 m0, s19
    s_add_u32 s17, s18, 2304
    buffer_load_dwordx4 v1, s[28:31], s18 offen sc1 lds
    s_add_u32 m0, s19, 1024
    s_nop 0
    buffer_load_dwordx4 v1, s[28:31], s17 offen sc1 lds
    s_branch LN2_A2
LN2_A1:
    s_waitcnt vmcnt(0)
    s_mov_b32 s59, 0
LN2_A2:
    s_cmp_ge_u32 s3, 2
    ds_read_b64_tr_b16 v[32:33], v12 offset:0
    ds_read_b64_tr_b16 v[34:35], v12 offset:512
    ds_read_b64_tr_b16 v[36:37], v12 offset:1024
    ds_read_b64_tr_b16 v[38:39], v12 offset:1536
    ds_read_b64_tr_b16 v[40:41], v12 offset:2048
    ds_read_b64_tr_b16 v[42:43], v12 offset:2560
    ds_read_b64_tr_b16 v[44:45], v12 offset:3072
    ds_read_b64_tr_b16 v[46:47], v12 offset:3584
    s_cbranch_scc1 LN2_B
    ds_read_b64_tr_b16 v[48:49], v12 offset:4096
    ds_read_b64_tr_b16 v[50:51], v12 offset:4608
LN2_B:
    s_waitcnt lgkmcnt(0)
    v_pk_max_u16 v16, v32, v33
    v_pk_max_u16 v17, v34, v35
    v_pk_max_u16 v16, v16, v36
    v_pk_max_u16 v17, v17, v37
    v_pk_max_u16 v16, v16, v38
    v_pk_max_u16 v17, v17, v39
    v_pk_max_u16 v16, v16, v40
    v_pk_max_u16 v17, v17, v41
    v_pk_max_u16 v16, v16, v42
    v_pk_max_u16 v17, v17, v43
    v_pk_max_u16 v16, v16, v44
    v_pk_max_u16 v17, v17, v45
    v_pk_max_u16 v16, v16, v46
    v_pk_max_u16 v17, v17, v47
    v_pk_max_u16 v16, v16, v48
    v_pk_max_u16 v17, v17, v49
    v_pk_max_u16 v16, v16, v50
    v_pk_max_u16 v17, v17, v51
    v_pk_max_u16 v16, v16, v17
    v_pk_max_u16 v16, v16, v16 op_sel:[0,1] op_sel_hi:[1,0]
    v_cmp_eq_u32 vcc, -1, v16
    s_cmp_lt_u32 s56, 60000
    s_cselect_b64 s[16:17], -1, 0
    s_and_b64 vcc, vcc, s[16:17]
    s_cbranch_scc1 LN2_RT
    v_dot2_f32_bf16 v56, v32, v26, v216
    v_dot2_f32_bf16 v57, v32, v27, v217
    ds_read_b128 v[96:99], v8 offset:0
    v_dot2_f32_bf16 v58, v33, v26, v218
    v_dot2_f32_bf16 v59, v33, v27, v219
    v_dot2_f32_bf16 v60, v34, v26, v220
    v_dot2_f32_bf16 v61, v34, v27, v221
    ds_read_b128 v[100:103], v8 offset:64
    v_dot2_f32_bf16 v62, v35, v26, v222
    v_dot2_f32_bf16 v63, v35, v27, v223
    v_dot2_f32_bf16 v64, v36, v26, v224
    v_dot2_f32_bf16 v65, v36, v27, v225
    ds_read_b128 v[104:107], v8 offset:128
    v_dot2_f32_bf16 v66, v37, v26, v226
    v_dot2_f32_bf16 v67, v37, v27, v227
    v_dot2_f32_bf16 v68, v38, v26, v228
    v_dot2_f32_bf16 v69, v38, v27, v229
    ds_read_b128 v[108:111], v8 offset:192
    v_dot2_f32_bf16 v70, v39, v26, v230
    v_dot2_f32_bf16 v71, v39, v27, v231
    v_dot2_f32_bf16 v72, v40, v26, v232
    v_dot2_f32_bf16 v73, v40, v27, v233
    ds_read_b128 v[112:115], v8 offset:256
    v_dot2_f32_bf16 v74, v41, v26, v234
    v_dot2_f32_bf16 v75, v41, v27, v235
    v_dot2_f32_bf16 v76, v42, v26, v236
    v_dot2_f32_bf16 v77, v42, v27, v237
    ds_read_b128 v[116:119], v8 offset:320
    v_dot2_f32_bf16 v78, v43, v26, v238
    v_dot2_f32_bf16 v79, v43, v27, v239
    v_dot2_f32_bf16 v80, v44, v26, v240
    v_dot2_f32_bf16 v81, v44, v27, v241
    ds_read_b128 v[120:123], v8 offset:384
    v_dot2_f32_bf16 v82, v45, v26, v242
    v_dot2_f32_bf16 v83, v45, v27, v243
    v_dot2_f32_bf16 v84, v46, v26, v244
    v_dot2_f32_bf16 v85, v46, v27, v245
    ds_read_b128 v[124:127], v8 offset:448
    v_dot2_f32_bf16 v86, v47, v26, v246
    v_dot2_f32_bf16 v87, v47, v27, v247
    v_dot2_f32_bf16 v88, v48, v26, v248
    v_dot2_f32_bf16 v89, v48, v27, v249
    ds_read_b128 v[128:131], v8 offset:512
    v_dot2_f32_bf16 v90, v49, v26, v250
    v_dot2_f32_bf16 v91, v49, v27, v251
    v_dot2_f32_bf16 v92, v50, v26, v252
    v_dot2_f32_bf16 v93, v50, v27, v253
    ds_read_b128 v[132:135], v8 offset:576
    v_dot2_f32_bf16 v94, v51, v26, v254
    v_dot2_f32_bf16 v95, v51, v27, v255
    ds_read_b128 v[136:139], v8 offset:1024
    v_pk_mul_f32 v[16:17], v[56:57], v[56:57]
    v_pk_add_f32 v[6:7], v[56:57], v[58:59]
    v_pk_fma_f32 v[16:17], v[58:59], v[58:59], v[16:17]
    ds_read_b128 v[140:143], v8 offset:1088
    v_pk_add_f32 v[6:7], v[6:7], v[60:61]
    v_pk_fma_f32 v[16:17], v[60:61], v[60:61], v[16:17]
    v_pk_add_f32 v[6:7], v[6:7], v[62:63]
    v_pk_fma_f32 v[16:17], v[62:63], v[62:63], v[16:17]
    ds_read_b128 v[144:147], v8 offset:1152
    v_pk_add_f32 v[6:7], v[6:7], v[64:65]
    v_pk_fma_f32 v[16:17], v[64:65], v[64:65], v[16:17]
    v_pk_add_f32 v[6:7], v[6:7], v[66:67]
    v_pk_fma_f32 v[16:17], v[66:67], v[66:67], v[16:17]
    ds_read_b128 v[148:151], v8 offset:1216
    v_pk_add_f32 v[6:7], v[6:7], v[68:69]
    v_pk_fma_f32 v[16:17], v[68:69], v[68:69], v[16:17]
    v_pk_add_f32 v[6:7], v[6:7], v[70:71]
    v_pk_fma_f32 v[16:17], v[70:71], v[70:71], v[16:17]
    ds_read_b128 v[152:155], v8 offset:1280
    v_pk_add_f32 v[6:7], v[6:7], v[72:73]
    v_pk_fma_f32 v[16:17], v[72:73], v[72:73], v[16:17]
    v_pk_add_f32 v[6:7], v[6:7], v[74:75]
    v_pk_fma_f32 v[16:17], v[74:75], v[74:75], v[16:17]
    ds_read_b128 v[156:159], v8 offset:1344
    v_pk_add_f32 v[6:7], v[6:7], v[76:77]
    v_pk_fma_f32 v[16:17], v[76:77], v[76:77], v[16:17]
    v_pk_add_f32 v[6:7], v[6:7], v[78:79]
    v_pk_fma_f32 v[16:17], v[78:79], v[78:79], v[16:17]
    ds_read_b128 v[160:163], v8 offset:1408
    v_pk_add_f32 v[6:7], v[6:7], v[80:81]
    v_pk_fma_f32 v[16:17], v[80:81], v[80:81], v[16:17]
    v_pk_add_f32 v[6:7], v[6:7], v[82:83]
    v_pk_fma_f32 v[16:17], v[82:83], v[82:83], v[16:17]
    ds_read_b128 v[164:167], v8 offset:1472
    v_pk_add_f32 v[6:7], v[6:7], v[84:85]
    v_pk_fma_f32 v[16:17], v[84:85], v[84:85], v[16:17]
    v_pk_add_f32 v[6:7], v[6:7], v[86:87]
    v_pk_fma_f32 v[16:17], v[86:87], v[86:87], v[16:17]
    ds_read_b128 v[168:171], v8 offset:1536
    v_pk_add_f32 v[6:7], v[6:7], v[88:89]
    v_pk_fma_f32 v[16:17], v[88:89], v[88:89], v[16:17]
    v_pk_add_f32 v[6:7], v[6:7], v[90:91]
    v_pk_fma_f32 v[16:17], v[90:91], v[90:91], v[16:17]
    ds_read_b128 v[172:175], v8 offset:1600
    v_pk_add_f32 v[6:7], v[6:7], v[92:93]
    v_pk_fma_f32 v[16:17], v[92:93], v[92:93], v[16:17]
    v_pk_add_f32 v[6:7], v[6:7], v[94:95]
    v_pk_fma_f32 v[16:17], v[94:95], v[94:95], v[16:17]
    v_add_f32 v16, v16, v17
    v_add_f32 v6, v6, v7
    s_nop 1
    v_permlane32_swap_b32 v6, v16
    v_add_f32 v6, v6, v16
    v_mov_b32 v7, v6
    s_nop 1
    v_permlane16_swap_b32 v6, v7
    v_add_f32 v6, v6, v7
    ds_write_b32 v14, v6
    s_or_b32 s16, s58, s59
    s_cbranch_scc0 LN2_POK
    s_cmp_eq_u32 s58, 0
    s_cbranch_scc1 LN2_PW
    s_mov_b32 s16, 0
LN2_PL:
    buffer_load_dword v15, v9, s[28:31], 0 offen sc1
    s_add_u32 s16, s16, 1
    s_waitcnt vmcnt(0)
    v_cmp_ne_u32 vcc, s8, v15
    s_cmp_ge_u32 s16, 60000
    s_cbranch_scc1 LN2_PL_X
    s_and_b64 vcc, vcc, exec
    s_cbranch_scc0 LN2_PL_X
    s_mov_b64 exec, vcc
    s_sleep 2
    s_branch LN2_PL
LN2_PL_X:
    s_mov_b64 exec, -1
    s_mov_b32 m0, s19
    s_add_u32 s17, s18, 2304
    buffer_load_dwordx4 v1, s[28:31], s18 offen sc1 lds
    s_add_u32 m0, s19, 1024
    s_nop 0
    buffer_load_dwordx4 v1, s[28:31], s17 offen sc1 lds
LN2_PW:
    s_waitcnt vmcnt(0)
    ds_read_b128 v[96:99], v8 offset:0
    ds_read_b128 v[136:139], v8 offset:1024
    ds_read_b128 v[100:103], v8 offset:64
    ds_read_b128 v[140:143], v8 offset:1088
    ds_read_b128 v[104:107], v8 offset:128
    ds_read_b128 v[144:147], v8 offset:1152
    ds_read_b128 v[108:111], v8 offset:192
    ds_read_b128 v[148:151], v8 offset:1216
    ds_read_b128 v[112:115], v8 offset:256
    ds_read_b128 v[152:155], v8 offset:1280
    ds_read_b128 v[116:119], v8 offset:320
    ds_read_b128 v[156:159], v8 offset:1344
    ds_read_b128 v[120:123], v8 offset:384
    ds_read_b128 v[160:163], v8 offset:1408
    ds_read_b128 v[124:127], v8 offset:448
    ds_read_b128 v[164:167], v8 offset:1472
    ds_read_b128 v[128:131], v8 offset:512
    ds_read_b128 v[168:171], v8 offset:1536
    ds_read_b128 v[132:135], v8 offset:576
    ds_read_b128 v[172:175], v8 offset:1600
LN2_POK:
    v_cvt_pk_bf16_f32 v200, v56, v57
    v_cvt_pk_bf16_f32 v201, v58, v59
    v_cvt_pk_bf16_f32 v202, v60, v61
    v_cvt_pk_bf16_f32 v203, v62, v63
    v_cvt_pk_bf16_f32 v204, v64, v65
    v_cvt_pk_bf16_f32 v205, v66, v67
    v_cvt_pk_bf16_f32 v206, v68, v69
    v_cvt_pk_bf16_f32 v207, v70, v71
    s_waitcnt lgkmcnt(0)
    s_barrier
    s_cmp_lg_u32 s3, 3
    s_cbranch_scc1 LN2_E
    buffer_store_dword v52, v10, s[28:31], s54 offen sc1
LN2_E:
    ds_read2_b32 v[18:19], v13 offset0:0 offset1:16
    ds_read2_b32 v[20:21], v13 offset0:32 offset1:48
    ds_read2_b32 v[22:23], v13 offset0:64 offset1:80
    ds_read2_b32 v[24:25], v13 offset0:96 offset1:112
    v_cvt_pk_bf16_f32 v208, v72, v73
    v_cvt_pk_bf16_f32 v209, v74, v75
    v_cvt_pk_bf16_f32 v210, v76, v77
    v_cvt_pk_bf16_f32 v211, v78, v79
    v_cvt_pk_bf16_f32 v212, v80, v81
    v_cvt_pk_bf16_f32 v213, v82, v83
    v_cvt_pk_bf16_f32 v214, v84, v85
    v_cvt_pk_bf16_f32 v215, v86, v87
    v_cvt_pk_bf16_f32 v216, v88, v89
    v_cvt_pk_bf16_f32 v217, v90, v91
    v_cvt_pk_bf16_f32 v218, v92, v93
    v_cvt_pk_bf16_f32 v219, v94, v95
    s_waitcnt lgkmcnt(0)
    v_pk_add_f32 v[18:19], v[18:19], v[20:21]
    v_pk_add_f32 v[22:23], v[22:23], v[24:25]
    v_pk_add_f32 v[6:7], v[18:19], v[22:23]
    v_mul_f32 v6, 987991609, v6
    v_mul_f32 v7, 987991609, v7
    v_fma_f32 v7, -v6, v6, v7
    v_max_f32 v7, 0, v7
    v_cvt_pk_bf16_f32 v7, v7, v7
    v_lshlrev_b32 v7, 16, v7
    v_add_f32 v7, 925353388, v7
    v_cvt_pk_bf16_f32 v7, v7, v7
    v_lshlrev_b32 v7, 16, v7
    v_sqrt_f32 v7, v7
    v_cvt_pk_bf16_f32 v6, v6, v6
    v_lshlrev_b32 v6, 16, v6
    v_cvt_pk_bf16_f32 v7, v7, v7
    v_lshlrev_b32 v7, 16, v7
    v_rcp_f32 v7, v7
    s_nop 0
    v_mul_f32 v6, v6, v7
    v_pk_fma_f32 v[56:57], v[56:57], v[6:7], v[6:7] op_sel:[0,1,0] op_sel_hi:[1,1,0] neg_lo:[0,0,1] neg_hi:[0,0,1]
    v_pk_fma_f32 v[58:59], v[58:59], v[6:7], v[6:7] op_sel:[0,1,0] op_sel_hi:[1,1,0] neg_lo:[0,0,1] neg_hi:[0,0,1]
    v_pk_fma_f32 v[60:61], v[60:61], v[6:7], v[6:7] op_sel:[0,1,0] op_sel_hi:[1,1,0] neg_lo:[0,0,1] neg_hi:[0,0,1]
    v_pk_fma_f32 v[62:63], v[62:63], v[6:7], v[6:7] op_sel:[0,1,0] op_sel_hi:[1,1,0] neg_lo:[0,0,1] neg_hi:[0,0,1]
    v_pk_fma_f32 v[56:57], v[56:57], v[136:137], v[96:97]
    v_pk_fma_f32 v[58:59], v[58:59], v[138:139], v[98:99]
    v_pk_fma_f32 v[60:61], v[60:61], v[140:141], v[100:101]
    v_pk_fma_f32 v[62:63], v[62:63], v[142:143], v[102:103]
    v_cvt_pk_bf16_f32 v32, v56, v57
    v_cvt_pk_bf16_f32 v33, v58, v59
    v_cvt_pk_bf16_f32 v34, v60, v61
    v_cvt_pk_bf16_f32 v35, v62, v63
    buffer_store_dwordx4 v[32:35], v1, s[28:31], s52 offen offset:0 sc1
    v_pk_fma_f32 v[64:65], v[64:65], v[6:7], v[6:7] op_sel:[0,1,0] op_sel_hi:[1,1,0] neg_lo:[0,0,1] neg_hi:[0,0,1]
    v_pk_fma_f32 v[66:67], v[66:67], v[6:7], v[6:7] op_sel:[0,1,0] op_sel_hi:[1,1,0] neg_lo:[0,0,1] neg_hi:[0,0,1]
    v_pk_fma_f32 v[68:69], v[68:69], v[6:7], v[6:7] op_sel:[0,1,0] op_sel_hi:[1,1,0] neg_lo:[0,0,1] neg_hi:[0,0,1]
    v_pk_fma_f32 v[70:71], v[70:71], v[6:7], v[6:7] op_sel:[0,1,0] op_sel_hi:[1,1,0] neg_lo:[0,0,1] neg_hi:[0,0,1]
    v_pk_fma_f32 v[64:65], v[64:65], v[144:145], v[104:105]
    v_pk_fma_f32 v[66:67], v[66:67], v[146:147], v[106:107]
    v_pk_fma_f32 v[68:69], v[68:69], v[148:149], v[108:109]
    v_pk_fma_f32 v[70:71], v[70:71], v[150:151], v[110:111]
    v_cvt_pk_bf16_f32 v36, v64, v65
    v_cvt_pk_bf16_f32 v37, v66, v67
    v_cvt_pk_bf16_f32 v38, v68, v69
    v_cvt_pk_bf16_f32 v39, v70, v71
    buffer_store_dwordx4 v[36:39], v1, s[28:31], s52 offen offset:1024 sc1
    v_pk_fma_f32 v[72:73], v[72:73], v[6:7], v[6:7] op_sel:[0,1,0] op_sel_hi:[1,1,0] neg_lo:[0,0,1] neg_hi:[0,0,1]
    v_pk_fma_f32 v[74:75], v[74:75], v[6:7], v[6:7] op_sel:[0,1,0] op_sel_hi:[1,1,0] neg_lo:[0,0,1] neg_hi:[0,0,1]
    v_pk_fma_f32 v[76:77], v[76:77], v[6:7], v[6:7] op_sel:[0,1,0] op_sel_hi:[1,1,0] neg_lo:[0,0,1] neg_hi:[0,0,1]
    v_pk_fma_f32 v[78:79], v[78:79], v[6:7], v[6:7] op_sel:[0,1,0] op_sel_hi:[1,1,0] neg_lo:[0,0,1] neg_hi:[0,0,1]
    v_pk_fma_f32 v[72:73], v[72:73], v[152:153], v[112:113]
    v_pk_fma_f32 v[74:75], v[74:75], v[154:155], v[114:115]
    v_pk_fma_f32 v[76:77], v[76:77], v[156:157], v[116:117]
    v_pk_fma_f32 v[78:79], v[78:79], v[158:159], v[118:119]
    v_cvt_pk_bf16_f32 v40, v72, v73
    v_cvt_pk_bf16_f32 v41, v74, v75
    v_cvt_pk_bf16_f32 v42, v76, v77
    v_cvt_pk_bf16_f32 v43, v78, v79
    buffer_store_dwordx4 v[40:43], v1, s[28:31], s52 offen offset:2048 sc1
    v_pk_fma_f32 v[80:81], v[80:81], v[6:7], v[6:7] op_sel:[0,1,0] op_sel_hi:[1,1,0] neg_lo:[0,0,1] neg_hi:[0,0,1]
    v_pk_fma_f32 v[82:83], v[82:83], v[6:7], v[6:7] op_sel:[0,1,0] op_sel_hi:[1,1,0] neg_lo:[0,0,1] neg_hi:[0,0,1]
    v_pk_fma_f32 v[84:85], v[84:85], v[6:7], v[6:7] op_sel:[0,1,0] op_sel_hi:[1,1,0] neg_lo:[0,0,1] neg_hi:[0,0,1]
    v_pk_fma_f32 v[86:87], v[86:87], v[6:7], v[6:7] op_sel:[0,1,0] op_sel_hi:[1,1,0] neg_lo:[0,0,1] neg_hi:[0,0,1]
    v_pk_fma_f32 v[80:81], v[80:81], v[160:161], v[120:121]
    v_pk_fma_f32 v[82:83], v[82:83], v[162:163], v[122:123]
    v_pk_fma_f32 v[84:85], v[84:85], v[164:165], v[124:125]
    v_pk_fma_f32 v[86:87], v[86:87], v[166:167], v[126:127]
    v_cvt_pk_bf16_f32 v44, v80, v81
    v_cvt_pk_bf16_f32 v45, v82, v83
    v_cvt_pk_bf16_f32 v46, v84, v85
    v_cvt_pk_bf16_f32 v47, v86, v87
    buffer_store_dwordx4 v[44:47], v1, s[28:31], s52 offen offset:3072 sc1
    s_cmp_ge_u32 s3, 2
    s_cbranch_scc1 LN2_C
    s_add_u32 s52, s52, 4096
    v_pk_fma_f32 v[88:89], v[88:89], v[6:7], v[6:7] op_sel:[0,1,0] op_sel_hi:[1,1,0] neg_lo:[0,0,1] neg_hi:[0,0,1]
    v_pk_fma_f32 v[90:91], v[90:91], v[6:7], v[6:7] op_sel:[0,1,0] op_sel_hi:[1,1,0] neg_lo:[0,0,1] neg_hi:[0,0,1]
    v_pk_fma_f32 v[92:93], v[92:93], v[6:7], v[6:7] op_sel:[0,1,0] op_sel_hi:[1,1,0] neg_lo:[0,0,1] neg_hi:[0,0,1]
    v_pk_fma_f32 v[94:95], v[94:95], v[6:7], v[6:7] op_sel:[0,1,0] op_sel_hi:[1,1,0] neg_lo:[0,0,1] neg_hi:[0,0,1]
    v_pk_fma_f32 v[88:89], v[88:89], v[168:169], v[128:129]
    v_pk_fma_f32 v[90:91], v[90:91], v[170:171], v[130:131]
    v_pk_fma_f32 v[92:93], v[92:93], v[172:173], v[132:133]
    v_pk_fma_f32 v[94:95], v[94:95], v[174:175], v[134:135]
    v_cvt_pk_bf16_f32 v48, v88, v89
    v_cvt_pk_bf16_f32 v49, v90, v91
    v_cvt_pk_bf16_f32 v50, v92, v93
    v_cvt_pk_bf16_f32 v51, v94, v95
    buffer_store_dwordx4 v[48:51], v1, s[28:31], s52 offen offset:0 sc1
LN2_C:
    s_add_u32 s57, s44, 0
    s_add_u32 m0, s46, 106496
    s_nop 0
    buffer_load_dwordx4 v28, s[20:23], s57 offen lds
    buffer_load_dwordx4 v28, s[24:27], s57 offen offset:1024 lds
    s_add_u32 s57, s44, 294912
    s_add_u32 m0, s46, 114688
    s_nop 0
    buffer_load_dwordx4 v28, s[20:23], s57 offen lds
    buffer_load_dwordx4 v28, s[24:27], s57 offen offset:1024 lds
    s_add_u32 s57, s44, 589824
    s_add_u32 m0, s46, 122880
    s_nop 0
    buffer_load_dwordx4 v28, s[20:23], s57 offen lds
    buffer_load_dwordx4 v28, s[24:27], s57 offen offset:1024 lds
    s_branch GEMM_START
KB_EXIT:
    s_endpgm
KB_SIDE:
    s_sub_u32 s9, s2, 144
    s_sub_u32 s16, s9, 64
    s_lshr_b32 s10, s16, 1
    s_and_b32 s11, s16, 1
    s_mov_b32 s14, 1
    s_cmp_lt_u32 s16, 36
    s_cbranch_scc1 SA_U
    s_sub_u32 s10, s9, 82
    s_add_u32 s17, s9, 30
    s_cmp_lt_u32 s9, 64
    s_cselect_b32 s10, s17, s10
    s_mov_b32 s11, 0
    s_mov_b32 s14, 2
SA_U:
    v_lshrrev_b32 v3, 3, v0
    v_and_b32 v6, 7, v0
    v_lshrrev_b32 v2, 4, v0
    v_lshlrev_b32 v2, 3, v2
    v_and_or_b32 v2, v3, 1, v2
    v_mul_u32_u24 v2, 1152, v2
    v_lshl_add_u32 v2, v6, 4, v2
    s_mul_i32 s16, s9, 36864
    s_mul_i32 s17, s3, 2304
    s_add_u32 s16, s16, s17
    v_add_u32 v2, s16, v2
    s_mul_i32 s16, s3, 72
    s_mul_i32 s17, s11, 288
    s_add_u32 s16, s16, s17
    v_mad_u32_u24 v4, v3, 9, s16
    v_lshlrev_b32 v5, 1, v4
    v_mul_u32_u24 v4, 6912, v4
    v_lshl_add_u32 v4, v6, 4, v4
    s_lshl_b32 s12, s10, 7
    s_mov_b32 s43, 0xffff0000
    v_mov_b32 v192, 0
    v_mov_b32 v193, 0
    v_mov_b32 v194, 0
    v_mov_b32 v195, 0
    v_mov_b32 v196, 0
    v_mov_b32 v197, 0
    v_mov_b32 v198, 0
    v_mov_b32 v199, 0
    s_waitcnt lgkmcnt(0)
    s_mov_b32 s56, s66
    s_mov_b32 s57, s67
    s_mov_b32 s58, 3981312
    s_mov_b32 s59, 0x00020000
    s_sub_u32 s24, s24, 1024
    s_subb_u32 s25, s25, 0
    s_cmp_ge_u32 s9, 64
    s_cbranch_scc1 SA_M
    global_load_dwordx4 v[8:11], v2, s[36:37] offset:0
    global_load_dwordx4 v[12:15], v2, s[36:37] offset:128
    global_load_dwordx4 v[16:19], v2, s[36:37] offset:256
    global_load_dwordx4 v[20:23], v2, s[36:37] offset:384
    global_load_dwordx4 v[24:27], v2, s[36:37] offset:512
    global_load_dwordx4 v[28:31], v2, s[36:37] offset:640
    global_load_dwordx4 v[32:35], v2, s[36:37] offset:768
    global_load_dwordx4 v[36:39], v2, s[36:37] offset:896
    global_load_dwordx4 v[40:43], v2, s[36:37] offset:1024
    v_and_b32 v7, 1, v0
    v_mul_u32_u24 v7, 201728, v7
    v_lshlrev_b32 v7, 8, v7
    v_add_u32 v7, 524288, v7
    global_load_dword v7, v7, s[28:29]
    s_lshr_b32 s16, s9, 4
    s_lshl_b32 s16, s16, 12
    s_lshl_b32 s17, s3, 10
    s_add_u32 s16, s16, s17
    s_and_b32 s17, s9, 15
    s_lshl_b32 s17, s17, 6
    s_add_u32 s16, s16, s17
    s_add_u32 s13, s16, 589824
    v_lshlrev_b32 v3, 3, v3
    s_waitcnt vmcnt(9)
    v_lshlrev_b32 v48, 16, v8
    v_and_b32 v49, s43, v8
    v_lshlrev_b32 v50, 16, v9
    v_and_b32 v51, s43, v9
    v_lshlrev_b32 v52, 16, v10
    v_and_b32 v53, s43, v10
    v_lshlrev_b32 v54, 16, v11
    v_and_b32 v55, s43, v11
    v_pk_add_f32 v[120:121], v[48:49], v[52:53]
    v_pk_add_f32 v[122:123], v[50:51], v[54:55]
    s_waitcnt vmcnt(8)
    v_lshlrev_b32 v56, 16, v12
    v_and_b32 v57, s43, v12
    v_lshlrev_b32 v58, 16, v13
    v_and_b32 v59, s43, v13
    v_lshlrev_b32 v60, 16, v14
    v_and_b32 v61, s43, v14
    v_lshlrev_b32 v62, 16, v15
    v_and_b32 v63, s43, v15
    v_pk_add_f32 v[120:121], v[120:121], v[56:57]
    v_pk_add_f32 v[122:123], v[122:123], v[58:59]
    v_pk_add_f32 v[120:121], v[120:121], v[60:61]
    v_pk_add_f32 v[122:123], v[122:123], v[62:63]
    s_waitcnt vmcnt(7)
    v_lshlrev_b32 v64, 16, v16
    v_and_b32 v65, s43, v16
    v_lshlrev_b32 v66, 16, v17
    v_and_b32 v67, s43, v17
    v_lshlrev_b32 v68, 16, v18
    v_and_b32 v69, s43, v18
    v_lshlrev_b32 v70, 16, v19
    v_and_b32 v71, s43, v19
    v_pk_add_f32 v[120:121], v[120:121], v[64:65]
    v_pk_add_f32 v[122:123], v[122:123], v[66:67]
    v_pk_add_f32 v[120:121], v[120:121], v[68:69]
    v_pk_add_f32 v[122:123], v[122:123], v[70:71]
    s_waitcnt vmcnt(6)
    v_lshlrev_b32 v72, 16, v20
    v_and_b32 v73, s43, v20
    v_lshlrev_b32 v74, 16, v21
    v_and_b32 v75, s43, v21
    v_lshlrev_b32 v76, 16, v22
    v_and_b32 v77, s43, v22
    v_lshlrev_b32 v78, 16, v23
    v_and_b32 v79, s43, v23
    v_pk_add_f32 v[120:121], v[120:121], v[72:73]
    v_pk_add_f32 v[122:123], v[122:123], v[74:75]
    v_pk_add_f32 v[120:121], v[120:121], v[76:77]
    v_pk_add_f32 v[122:123], v[122:123], v[78:79]
    s_waitcnt vmcnt(5)
    v_lshlrev_b32 v80, 16, v24
    v_and_b32 v81, s43, v24
    v_lshlrev_b32 v82, 16, v25
    v_and_b32 v83, s43, v25
    v_lshlrev_b32 v84, 16, v26
    v_and_b32 v85, s43, v26
    v_lshlrev_b32 v86, 16, v27
    v_and_b32 v87, s43, v27
    v_pk_add_f32 v[120:121], v[120:121], v[80:81]
    v_pk_add_f32 v[122:123], v[122:123], v[82:83]
    v_pk_add_f32 v[120:121], v[120:121], v[84:85]
    v_pk_add_f32 v[122:123], v[122:123], v[86:87]
    s_waitcnt vmcnt(4)
    v_lshlrev_b32 v88, 16, v28
    v_and_b32 v89, s43, v28
    v_lshlrev_b32 v90, 16, v29
    v_and_b32 v91, s43, v29
    v_lshlrev_b32 v92, 16, v30
    v_and_b32 v93, s43, v30
    v_lshlrev_b32 v94, 16, v31
    v_and_b32 v95, s43, v31
    v_pk_add_f32 v[120:121], v[120:121], v[88:89]
    v_pk_add_f32 v[122:123], v[122:123], v[90:91]
    v_pk_add_f32 v[120:121], v[120:121], v[92:93]
    v_pk_add_f32 v[122:123], v[122:123], v[94:95]
    s_waitcnt vmcnt(3)
    v_lshlrev_b32 v96, 16, v32
    v_and_b32 v97, s43, v32
    v_lshlrev_b32 v98, 16, v33
    v_and_b32 v99, s43, v33
    v_lshlrev_b32 v100, 16, v34
    v_and_b32 v101, s43, v34
    v_lshlrev_b32 v102, 16, v35
    v_and_b32 v103, s43, v35
    v_pk_add_f32 v[120:121], v[120:121], v[96:97]
    v_pk_add_f32 v[122:123], v[122:123], v[98:99]
    v_pk_add_f32 v[120:121], v[120:121], v[100:101]
    v_pk_add_f32 v[122:123], v[122:123], v[102:103]
    s_waitcnt vmcnt(2)
    v_lshlrev_b32 v104, 16, v36
    v_and_b32 v105, s43, v36
    v_lshlrev_b32 v106, 16, v37
    v_and_b32 v107, s43, v37
    v_lshlrev_b32 v108, 16, v38
    v_and_b32 v109, s43, v38
    v_lshlrev_b32 v110, 16, v39
    v_and_b32 v111, s43, v39
    v_pk_add_f32 v[120:121], v[120:121], v[104:105]
    v_pk_add_f32 v[122:123], v[122:123], v[106:107]
    v_pk_add_f32 v[120:121], v[120:121], v[108:109]
    v_pk_add_f32 v[122:123], v[122:123], v[110:111]
    s_waitcnt vmcnt(1)
    v_lshlrev_b32 v112, 16, v40
    v_and_b32 v113, s43, v40
    v_lshlrev_b32 v114, 16, v41
    v_and_b32 v115, s43, v41
    v_lshlrev_b32 v116, 16, v42
    v_and_b32 v117, s43, v42
    v_lshlrev_b32 v118, 16, v43
    v_and_b32 v119, s43, v43
    v_pk_add_f32 v[120:121], v[120:121], v[112:113]
    v_pk_add_f32 v[122:123], v[122:123], v[114:115]
    v_pk_add_f32 v[120:121], v[120:121], v[116:117]
    v_pk_add_f32 v[122:123], v[122:123], v[118:119]
    v_pk_add_f32 v[120:121], v[120:121], v[122:123]
    v_add_f32 v120, v120, v121
    s_nop 1
    v_add_f32_dpp v120, v120, v120 quad_perm:[1,0,3,2] row_mask:0xf bank_mask:0xf
    s_nop 1
    v_add_f32_dpp v120, v120, v120 quad_perm:[2,3,0,1] row_mask:0xf bank_mask:0xf
    s_nop 1
    v_add_f32_dpp v120, v120, v120 row_half_mirror row_mask:0xf bank_mask:0xf
    v_mul_f32 v120, 987991609, v120
    v_pk_add_f32 v[48:49], v[48:49], v[120:121] op_sel_hi:[1,0] neg_lo:[0,1] neg_hi:[0,1]
    v_pk_mul_f32 v[124:125], v[48:49], v[48:49]
    v_pk_add_f32 v[50:51], v[50:51], v[120:121] op_sel_hi:[1,0] neg_lo:[0,1] neg_hi:[0,1]
    v_pk_mul_f32 v[126:127], v[50:51], v[50:51]
    v_pk_add_f32 v[52:53], v[52:53], v[120:121] op_sel_hi:[1,0] neg_lo:[0,1] neg_hi:[0,1]
    v_pk_fma_f32 v[124:125], v[52:53], v[52:53], v[124:125]
    v_pk_add_f32 v[54:55], v[54:55], v[120:121] op_sel_hi:[1,0] neg_lo:[0,1] neg_hi:[0,1]
    v_pk_fma_f32 v[126:127], v[54:55], v[54:55], v[126:127]
    v_pk_add_f32 v[56:57], v[56:57], v[120:121] op_sel_hi:[1,0] neg_lo:[0,1] neg_hi:[0,1]
    v_pk_fma_f32 v[124:125], v[56:57], v[56:57], v[124:125]
    v_pk_add_f32 v[58:59], v[58:59], v[120:121] op_sel_hi:[1,0] neg_lo:[0,1] neg_hi:[0,1]
    v_pk_fma_f32 v[126:127], v[58:59], v[58:59], v[126:127]
    v_pk_add_f32 v[60:61], v[60:61], v[120:121] op_sel_hi:[1,0] neg_lo:[0,1] neg_hi:[0,1]
    v_pk_fma_f32 v[124:125], v[60:61], v[60:61], v[124:125]
    v_pk_add_f32 v[62:63], v[62:63], v[120:121] op_sel_hi:[1,0] neg_lo:[0,1] neg_hi:[0,1]
    v_pk_fma_f32 v[126:127], v[62:63], v[62:63], v[126:127]
    v_pk_add_f32 v[64:65], v[64:65], v[120:121] op_sel_hi:[1,0] neg_lo:[0,1] neg_hi:[0,1]
    v_pk_fma_f32 v[124:125], v[64:65], v[64:65], v[124:125]
    v_pk_add_f32 v[66:67], v[66:67], v[120:121] op_sel_hi:[1,0] neg_lo:[0,1] neg_hi:[0,1]
    v_pk_fma_f32 v[126:127], v[66:67], v[66:67], v[126:127]
    v_pk_add_f32 v[68:69], v[68:69], v[120:121] op_sel_hi:[1,0] neg_lo:[0,1] neg_hi:[0,1]
    v_pk_fma_f32 v[124:125], v[68:69], v[68:69], v[124:125]
    v_pk_add_f32 v[70:71], v[70:71], v[120:121] op_sel_hi:[1,0] neg_lo:[0,1] neg_hi:[0,1]
    v_pk_fma_f32 v[126:127], v[70:71], v[70:71], v[126:127]
    v_pk_add_f32 v[72:73], v[72:73], v[120:121] op_sel_hi:[1,0] neg_lo:[0,1] neg_hi:[0,1]
    v_pk_fma_f32 v[124:125], v[72:73], v[72:73], v[124:125]
    v_pk_add_f32 v[74:75], v[74:75], v[120:121] op_sel_hi:[1,0] neg_lo:[0,1] neg_hi:[0,1]
    v_pk_fma_f32 v[126:127], v[74:75], v[74:75], v[126:127]
    v_pk_add_f32 v[76:77], v[76:77], v[120:121] op_sel_hi:[1,0] neg_lo:[0,1] neg_hi:[0,1]
    v_pk_fma_f32 v[124:125], v[76:77], v[76:77], v[124:125]
    v_pk_add_f32 v[78:79], v[78:79], v[120:121] op_sel_hi:[1,0] neg_lo:[0,1] neg_hi:[0,1]
    v_pk_fma_f32 v[126:127], v[78:79], v[78:79], v[126:127]
    v_pk_add_f32 v[80:81], v[80:81], v[120:121] op_sel_hi:[1,0] neg_lo:[0,1] neg_hi:[0,1]
    v_pk_fma_f32 v[124:125], v[80:81], v[80:81], v[124:125]
    v_pk_add_f32 v[82:83], v[82:83], v[120:121] op_sel_hi:[1,0] neg_lo:[0,1] neg_hi:[0,1]
    v_pk_fma_f32 v[126:127], v[82:83], v[82:83], v[126:127]
    v_pk_add_f32 v[84:85], v[84:85], v[120:121] op_sel_hi:[1,0] neg_lo:[0,1] neg_hi:[0,1]
    v_pk_fma_f32 v[124:125], v[84:85], v[84:85], v[124:125]
    v_pk_add_f32 v[86:87], v[86:87], v[120:121] op_sel_hi:[1,0] neg_lo:[0,1] neg_hi:[0,1]
    v_pk_fma_f32 v[126:127], v[86:87], v[86:87], v[126:127]
    v_pk_add_f32 v[88:89], v[88:89], v[120:121] op_sel_hi:[1,0] neg_lo:[0,1] neg_hi:[0,1]
    v_pk_fma_f32 v[124:125], v[88:89], v[88:89], v[124:125]
    v_pk_add_f32 v[90:91], v[90:91], v[120:121] op_sel_hi:[1,0] neg_lo:[0,1] neg_hi:[0,1]
    v_pk_fma_f32 v[126:127], v[90:91], v[90:91], v[126:127]
    v_pk_add_f32 v[92:93], v[92:93], v[120:121] op_sel_hi:[1,0] neg_lo:[0,1] neg_hi:[0,1]
    v_pk_fma_f32 v[124:125], v[92:93], v[92:93], v[124:125]
    v_pk_add_f32 v[94:95], v[94:95], v[120:121] op_sel_hi:[1,0] neg_lo:[0,1] neg_hi:[0,1]
    v_pk_fma_f32 v[126:127], v[94:95], v[94:95], v[126:127]
    v_pk_add_f32 v[96:97], v[96:97], v[120:121] op_sel_hi:[1,0] neg_lo:[0,1] neg_hi:[0,1]
    v_pk_fma_f32 v[124:125], v[96:97], v[96:97], v[124:125]
    v_pk_add_f32 v[98:99], v[98:99], v[120:121] op_sel_hi:[1,0] neg_lo:[0,1] neg_hi:[0,1]
    v_pk_fma_f32 v[126:127], v[98:99], v[98:99], v[126:127]
    v_pk_add_f32 v[100:101], v[100:101], v[120:121] op_sel_hi:[1,0] neg_lo:[0,1] neg_hi:[0,1]
    v_pk_fma_f32 v[124:125], v[100:101], v[100:101], v[124:125]
    v_pk_add_f32 v[102:103], v[102:103], v[120:121] op_sel_hi:[1,0] neg_lo:[0,1] neg_hi:[0,1]
    v_pk_fma_f32 v[126:127], v[102:103], v[102:103], v[126:127]
    v_pk_add_f32 v[104:105], v[104:105], v[120:121] op_sel_hi:[1,0] neg_lo:[0,1] neg_hi:[0,1]
    v_pk_fma_f32 v[124:125], v[104:105], v[104:105], v[124:125]
    v_pk_add_f32 v[106:107], v[106:107], v[120:121] op_sel_hi:[1,0] neg_lo:[0,1] neg_hi:[0,1]
    v_pk_fma_f32 v[126:127], v[106:107], v[106:107], v[126:127]
    v_pk_add_f32 v[108:109], v[108:109], v[120:121] op_sel_hi:[1,0] neg_lo:[0,1] neg_hi:[0,1]
    v_pk_fma_f32 v[124:125], v[108:109], v[108:109], v[124:125]
    v_pk_add_f32 v[110:111], v[110:111], v[120:121] op_sel_hi:[1,0] neg_lo:[0,1] neg_hi:[0,1]
    v_pk_fma_f32 v[126:127], v[110:111], v[110:111], v[126:127]
    v_pk_add_f32 v[112:113], v[112:113], v[120:121] op_sel_hi:[1,0] neg_lo:[0,1] neg_hi:[0,1]
    v_pk_fma_f32 v[124:125], v[112:113], v[112:113], v[124:125]
    v_pk_add_f32 v[114:115], v[114:115], v[120:121] op_sel_hi:[1,0] neg_lo:[0,1] neg_hi:[0,1]
    v_pk_fma_f32 v[126:127], v[114:115], v[114:115], v[126:127]
    v_pk_add_f32 v[116:117], v[116:117], v[120:121] op_sel_hi:[1,0] neg_lo:[0,1] neg_hi:[0,1]
    v_pk_fma_f32 v[124:125], v[116:117], v[116:117], v[124:125]
    v_pk_add_f32 v[118:119], v[118:119], v[120:121] op_sel_hi:[1,0] neg_lo:[0,1] neg_hi:[0,1]
    v_pk_fma_f32 v[126:127], v[118:119], v[118:119], v[126:127]
    v_pk_add_f32 v[124:125], v[124:125], v[126:127]
    v_add_f32 v124, v124, v125
    s_nop 1
    v_add_f32_dpp v124, v124, v124 quad_perm:[1,0,3,2] row_mask:0xf bank_mask:0xf
    s_nop 1
    v_add_f32_dpp v124, v124, v124 quad_perm:[2,3,0,1] row_mask:0xf bank_mask:0xf
    s_nop 1
    v_add_f32_dpp v124, v124, v124 row_half_mirror row_mask:0xf bank_mask:0xf
    v_mul_f32 v124, 987991609, v124
    v_cvt_pk_bf16_f32 v124, v124, v124
    v_lshlrev_b32 v124, 16, v124
    v_add_f32 v124, 925353388, v124
    v_cvt_pk_bf16_f32 v124, v124, v124
    v_lshlrev_b32 v124, 16, v124
    s_waitcnt vmcnt(0)
    v_readlane_b32 s8, v7, 0
    v_readlane_b32 s4, v7, 1
    s_mul_i32 s8, s8, 1664525
    s_mul_i32 s4, s4, 0x9e3779b0
    s_add_u32 s8, s8, s4
    s_add_u32 s8, s8, 1013904223
    v_sqrt_f32 v124, v124
    v_mov_b32 v121, s8
    v_cvt_pk_bf16_f32 v120, v120, v124
    buffer_store_dwordx2 v[120:121], v3, s[28:31], s13 offen sc1
    s_cmp_ge_u32 s9, 24
    s_cbranch_scc1 SA_END
    s_barrier
SA_M:
    s_mov_b32 s16, 3216550459
    global_load_dwordx4 v[200:203], v5, s[64:65] offset:0
    global_load_ushort v204, v5, s[64:65] offset:16
    v_and_b32 v7, 1, v0
    v_mul_u32_u24 v7, 201728, v7
    v_lshlrev_b32 v7, 8, v7
    v_add_u32 v7, 524288, v7
    global_load_dword v7, v7, s[28:29]
    s_cmp_eq_u32 s14, 1
    s_cbranch_scc0 SA_LZ
    buffer_load_dwordx4 v[140:143], v4, s[56:59], s12 offen nt
    s_add_u32 s12, s12, 6912
    buffer_load_dwordx4 v[144:147], v4, s[56:59], s12 offen nt
    s_add_u32 s12, s12, 6912
    buffer_load_dwordx4 v[148:151], v4, s[56:59], s12 offen nt
    s_add_u32 s12, s12, 6912
    buffer_load_dwordx4 v[152:155], v4, s[56:59], s12 offen nt
    s_add_u32 s12, s12, 6912
    buffer_load_dwordx4 v[156:159], v4, s[56:59], s12 offen nt
    s_add_u32 s12, s12, 6912
    buffer_load_dwordx4 v[160:163], v4, s[56:59], s12 offen nt
    s_add_u32 s12, s12, 6912
    buffer_load_dwordx4 v[164:167], v4, s[56:59], s12 offen nt
    s_add_u32 s12, s12, 6912
    buffer_load_dwordx4 v[168:171], v4, s[56:59], s12 offen nt
    s_add_u32 s12, s12, 6912
    buffer_load_dwordx4 v[172:175], v4, s[56:59], s12 offen nt
    s_add_u32 s12, s12, 1935360
    s_lshl_b32 s18, s10, 9
    s_lshl_b32 s19, s11, 2
    s_add_u32 s19, s19, s3
    s_mul_i32 s19, s19, 16384
    s_add_u32 s18, s18, s19
    s_add_u32 s18, s18, 131072
    v_lshlrev_b32 v44, 3, v6
    v_bfe_u32 v45, v0, 3, 1
    v_lshl_add_u32 v44, v45, 2, v44
    v_bfe_u32 v46, v0, 4, 1
    v_lshl_add_u32 v44, v46, 1, v44
    v_lshrrev_b32 v46, 5, v0
    v_add_lshl_u32 v44, v44, v46, 2
    v_cmp_eq_u32 vcc, 1, v45
    v_lshlrev_b32 v45, 3, v0
    s_waitcnt vmcnt(9)
    v_readlane_b32 s8, v7, 0
    v_readlane_b32 s4, v7, 1
    s_mul_i32 s8, s8, 1664525
    s_mul_i32 s4, s4, 0x9e3779b0
    s_add_u32 s8, s8, s4
    s_add_u32 s8, s8, 1013904223
    v_lshlrev_b32 v128, 16, v200
    v_and_b32 v129, s43, v200
    v_lshlrev_b32 v130, 16, v201
    v_and_b32 v131, s43, v201
    v_lshlrev_b32 v132, 16, v202
    v_and_b32 v133, s43, v202
    v_lshlrev_b32 v134, 16, v203
    v_and_b32 v135, s43, v203
    v_lshlrev_b32 v136, 16, v204
    v_mul_f32 v180, s16, v128
    v_mul_f32 v181, s16, v129
    v_mul_f32 v182, s16, v130
    v_mul_f32 v183, s16, v131
    v_mul_f32 v184, s16, v132
    v_mul_f32 v185, s16, v133
    v_mul_f32 v186, s16, v134
    v_mul_f32 v187, s16, v135
    v_mul_f32 v188, s16, v136
    v_exp_f32 v180, v180
    v_exp_f32 v181, v181
    v_exp_f32 v182, v182
    v_exp_f32 v183, v183
    v_exp_f32 v184, v184
    v_exp_f32 v185, v185
    v_exp_f32 v186, v186
    v_exp_f32 v187, v187
    v_exp_f32 v188, v188
    v_add_f32 v180, 1.0, v180
    v_add_f32 v181, 1.0, v181
    v_add_f32 v182, 1.0, v182
    v_add_f32 v183, 1.0, v183
    v_add_f32 v184, 1.0, v184
    v_add_f32 v185, 1.0, v185
    v_add_f32 v186, 1.0, v186
    v_add_f32 v187, 1.0, v187
    v_add_f32 v188, 1.0, v188
    v_rcp_f32 v180, v180
    v_rcp_f32 v181, v181
    v_rcp_f32 v182, v182
    v_rcp_f32 v183, v183
    v_rcp_f32 v184, v184
    v_rcp_f32 v185, v185
    v_rcp_f32 v186, v186
    v_rcp_f32 v187, v187
    v_rcp_f32 v188, v188
    v_mul_f32 v128, v128, v180
    v_mul_f32 v129, v129, v181
    v_mul_f32 v130, v130, v182
    v_mul_f32 v131, v131, v183
    v_mul_f32 v132, v132, v184
    v_mul_f32 v133, v133, v185
    v_mul_f32 v134, v134, v186
    v_mul_f32 v135, v135, v187
    v_mul_f32 v136, v136, v188
    v_cvt_pk_bf16_f32 v128, v128, v128
    v_cvt_pk_bf16_f32 v129, v129, v129
    v_cvt_pk_bf16_f32 v130, v130, v130
    v_cvt_pk_bf16_f32 v131, v131, v131
    v_cvt_pk_bf16_f32 v132, v132, v132
    v_cvt_pk_bf16_f32 v133, v133, v133
    v_cvt_pk_bf16_f32 v134, v134, v134
    v_cvt_pk_bf16_f32 v135, v135, v135
    v_cvt_pk_bf16_f32 v136, v136, v136
    v_lshrrev_b32 v180, 16, v128
    v_and_b32 v128, s43, v128
    v_lshrrev_b32 v181, 16, v129
    v_and_b32 v129, s43, v129
    v_lshrrev_b32 v182, 16, v130
    v_and_b32 v130, s43, v130
    v_lshrrev_b32 v183, 16, v131
    v_and_b32 v131, s43, v131
    v_lshrrev_b32 v184, 16, v132
    v_and_b32 v132, s43, v132
    v_lshrrev_b32 v185, 16, v133
    v_and_b32 v133, s43, v133
    v_lshrrev_b32 v186, 16, v134
    v_and_b32 v134, s43, v134
    v_lshrrev_b32 v187, 16, v135
    v_and_b32 v135, s43, v135
    v_lshrrev_b32 v188, 16, v136
    v_and_b32 v136, s43, v136
    s_waitcnt vmcnt(8)
    v_dot2c_f32_bf16 v192, v140, v180
    v_dot2c_f32_bf16 v193, v140, v128
    v_dot2c_f32_bf16 v194, v141, v180
    v_dot2c_f32_bf16 v195, v141, v128
    v_dot2c_f32_bf16 v196, v142, v180
    v_dot2c_f32_bf16 v197, v142, v128
    v_dot2c_f32_bf16 v198, v143, v180
    v_dot2c_f32_bf16 v199, v143, v128
    s_waitcnt vmcnt(7)
    v_dot2c_f32_bf16 v192, v144, v181
    v_dot2c_f32_bf16 v193, v144, v129
    v_dot2c_f32_bf16 v194, v145, v181
    v_dot2c_f32_bf16 v195, v145, v129
    v_dot2c_f32_bf16 v196, v146, v181
    v_dot2c_f32_bf16 v197, v146, v129
    v_dot2c_f32_bf16 v198, v147, v181
    v_dot2c_f32_bf16 v199, v147, v129
    s_waitcnt vmcnt(6)
    v_dot2c_f32_bf16 v192, v148, v182
    v_dot2c_f32_bf16 v193, v148, v130
    v_dot2c_f32_bf16 v194, v149, v182
    v_dot2c_f32_bf16 v195, v149, v130
    v_dot2c_f32_bf16 v196, v150, v182
    v_dot2c_f32_bf16 v197, v150, v130
    v_dot2c_f32_bf16 v198, v151, v182
    v_dot2c_f32_bf16 v199, v151, v130
    s_waitcnt vmcnt(5)
    v_dot2c_f32_bf16 v192, v152, v183
    v_dot2c_f32_bf16 v193, v152, v131
    v_dot2c_f32_bf16 v194, v153, v183
    v_dot2c_f32_bf16 v195, v153, v131
    v_dot2c_f32_bf16 v196, v154, v183
    v_dot2c_f32_bf16 v197, v154, v131
    v_dot2c_f32_bf16 v198, v155, v183
    v_dot2c_f32_bf16 v199, v155, v131
    s_waitcnt vmcnt(4)
    v_dot2c_f32_bf16 v192, v156, v184
    v_dot2c_f32_bf16 v193, v156, v132
    v_dot2c_f32_bf16 v194, v157, v184
    v_dot2c_f32_bf16 v195, v157, v132
    v_dot2c_f32_bf16 v196, v158, v184
    v_dot2c_f32_bf16 v197, v158, v132
    v_dot2c_f32_bf16 v198, v159, v184
    v_dot2c_f32_bf16 v199, v159, v132
    s_waitcnt vmcnt(3)
    v_dot2c_f32_bf16 v192, v160, v185
    v_dot2c_f32_bf16 v193, v160, v133
    v_dot2c_f32_bf16 v194, v161, v185
    v_dot2c_f32_bf16 v195, v161, v133
    v_dot2c_f32_bf16 v196, v162, v185
    v_dot2c_f32_bf16 v197, v162, v133
    v_dot2c_f32_bf16 v198, v163, v185
    v_dot2c_f32_bf16 v199, v163, v133
    s_waitcnt vmcnt(2)
    v_dot2c_f32_bf16 v192, v164, v186
    v_dot2c_f32_bf16 v193, v164, v134
    v_dot2c_f32_bf16 v194, v165, v186
    v_dot2c_f32_bf16 v195, v165, v134
    v_dot2c_f32_bf16 v196, v166, v186
    v_dot2c_f32_bf16 v197, v166, v134
    v_dot2c_f32_bf16 v198, v167, v186
    v_dot2c_f32_bf16 v199, v167, v134
    s_waitcnt vmcnt(1)
    v_dot2c_f32_bf16 v192, v168, v187
    v_dot2c_f32_bf16 v193, v168, v135
    v_dot2c_f32_bf16 v194, v169, v187
    v_dot2c_f32_bf16 v195, v169, v135
    v_dot2c_f32_bf16 v196, v170, v187
    v_dot2c_f32_bf16 v197, v170, v135
    v_dot2c_f32_bf16 v198, v171, v187
    v_dot2c_f32_bf16 v199, v171, v135
    s_waitcnt vmcnt(0)
    v_dot2c_f32_bf16 v192, v172, v188
    v_dot2c_f32_bf16 v193, v172, v136
    v_dot2c_f32_bf16 v194, v173, v188
    v_dot2c_f32_bf16 v195, v173, v136
    v_dot2c_f32_bf16 v196, v174, v188
    v_dot2c_f32_bf16 v197, v174, v136
    v_dot2c_f32_bf16 v198, v175, v188
    v_dot2c_f32_bf16 v199, v175, v136
    s_nop 2
    v_permlane32_swap_b32 v192, v193
    v_permlane32_swap_b32 v194, v195
    v_permlane32_swap_b32 v196, v197
    v_permlane32_swap_b32 v198, v199
    v_add_f32 v192, v192, v193
    v_add_f32 v194, v194, v195
    v_add_f32 v196, v196, v197
    v_add_f32 v198, v198, v199
    v_permlane16_swap_b32 v192, v194
    s_nop 0
    v_permlane16_swap_b32 v196, v198
    v_add_f32 v192, v192, v194
    v_add_f32 v196, v196, v198
    s_nop 0
    v_add_f32_dpp v192, v192, v192 row_ror:8 row_mask:0xf bank_mask:0xf
    v_add_f32_dpp v196, v196, v196 row_ror:8 row_mask:0xf bank_mask:0xf
    v_cndmask_b32 v192, v192, v196, vcc
    v_mov_b32 v193, s8
    ds_permute_b32 v192, v44, v192
    s_waitcnt lgkmcnt(0)
    buffer_store_dwordx2 v[192:193], v45, s[28:31], s18 offen sc1
    s_branch SA_END
SA_LZ:
    global_load_dwordx4 v[206:209], v5, s[64:65] offset:576
    global_load_ushort v210, v5, s[64:65] offset:592
    buffer_load_dwordx4 v[20:23], v4, s[56:59], s12 offen nt
    s_add_u32 s12, s12, 6912
    buffer_load_dwordx4 v[24:27], v4, s[56:59], s12 offen nt
    s_add_u32 s12, s12, 6912
    buffer_load_dwordx4 v[28:31], v4, s[56:59], s12 offen nt
    s_add_u32 s12, s12, 6912
    buffer_load_dwordx4 v[32:35], v4, s[56:59], s12 offen nt
    s_add_u32 s12, s12, 6912
    buffer_load_dwordx4 v[36:39], v4, s[56:59], s12 offen nt
    s_add_u32 s12, s12, 6912
    buffer_load_dwordx4 v[40:43], v4, s[56:59], s12 offen nt
    s_add_u32 s12, s12, 6912
    buffer_load_dwordx4 v[44:47], v4, s[56:59], s12 offen nt
    s_add_u32 s12, s12, 6912
    buffer_load_dwordx4 v[48:51], v4, s[56:59], s12 offen nt
    s_add_u32 s12, s12, 6912
    buffer_load_dwordx4 v[52:55], v4, s[56:59], s12 offen nt
    s_add_u32 s12, s12, 1935360
    buffer_load_dwordx4 v[140:143], v4, s[56:59], s12 offen nt
    s_add_u32 s12, s12, 6912
    buffer_load_dwordx4 v[144:147], v4, s[56:59], s12 offen nt
    s_add_u32 s12, s12, 6912
    buffer_load_dwordx4 v[148:151], v4, s[56:59], s12 offen nt
    s_add_u32 s12, s12, 6912
    buffer_load_dwordx4 v[152:155], v4, s[56:59], s12 offen nt
    s_add_u32 s12, s12, 6912
    buffer_load_dwordx4 v[156:159], v4, s[56:59], s12 offen nt
    s_add_u32 s12, s12, 6912
    buffer_load_dwordx4 v[160:163], v4, s[56:59], s12 offen nt
    s_add_u32 s12, s12, 6912
    buffer_load_dwordx4 v[164:167], v4, s[56:59], s12 offen nt
    s_add_u32 s12, s12, 6912
    buffer_load_dwordx4 v[168:171], v4, s[56:59], s12 offen nt
    s_add_u32 s12, s12, 6912
    buffer_load_dwordx4 v[172:175], v4, s[56:59], s12 offen nt
    s_add_u32 s12, s12, 1935360
    s_waitcnt vmcnt(18)
    v_lshlrev_b32 v8, 16, v200
    v_and_b32 v9, s43, v200
    v_lshlrev_b32 v10, 16, v201
    v_and_b32 v11, s43, v201
    v_lshlrev_b32 v12, 16, v202
    v_and_b32 v13, s43, v202
    v_lshlrev_b32 v14, 16, v203
    v_and_b32 v15, s43, v203
    v_lshlrev_b32 v16, 16, v204
    v_mul_f32 v60, s16, v8
    v_mul_f32 v61, s16, v9
    v_mul_f32 v62, s16, v10
    v_mul_f32 v63, s16, v11
    v_mul_f32 v64, s16, v12
    v_mul_f32 v65, s16, v13
    v_mul_f32 v66, s16, v14
    v_mul_f32 v67, s16, v15
    v_mul_f32 v68, s16, v16
    v_exp_f32 v60, v60
    v_exp_f32 v61, v61
    v_exp_f32 v62, v62
    v_exp_f32 v63, v63
    v_exp_f32 v64, v64
    v_exp_f32 v65, v65
    v_exp_f32 v66, v66
    v_exp_f32 v67, v67
    v_exp_f32 v68, v68
    v_add_f32 v60, 1.0, v60
    v_add_f32 v61, 1.0, v61
    v_add_f32 v62, 1.0, v62
    v_add_f32 v63, 1.0, v63
    v_add_f32 v64, 1.0, v64
    v_add_f32 v65, 1.0, v65
    v_add_f32 v66, 1.0, v66
    v_add_f32 v67, 1.0, v67
    v_add_f32 v68, 1.0, v68
    v_rcp_f32 v60, v60
    v_rcp_f32 v61, v61
    v_rcp_f32 v62, v62
    v_rcp_f32 v63, v63
    v_rcp_f32 v64, v64
    v_rcp_f32 v65, v65
    v_rcp_f32 v66, v66
    v_rcp_f32 v67, v67
    v_rcp_f32 v68, v68
    v_mul_f32 v8, v8, v60
    v_mul_f32 v9, v9, v61
    v_mul_f32 v10, v10, v62
    v_mul_f32 v11, v11, v63
    v_mul_f32 v12, v12, v64
    v_mul_f32 v13, v13, v65
    v_mul_f32 v14, v14, v66
    v_mul_f32 v15, v15, v67
    v_mul_f32 v16, v16, v68
    v_cvt_pk_bf16_f32 v8, v8, v8
    v_cvt_pk_bf16_f32 v9, v9, v9
    v_cvt_pk_bf16_f32 v10, v10, v10
    v_cvt_pk_bf16_f32 v11, v11, v11
    v_cvt_pk_bf16_f32 v12, v12, v12
    v_cvt_pk_bf16_f32 v13, v13, v13
    v_cvt_pk_bf16_f32 v14, v14, v14
    v_cvt_pk_bf16_f32 v15, v15, v15
    v_cvt_pk_bf16_f32 v16, v16, v16
    v_lshrrev_b32 v60, 16, v8
    v_and_b32 v8, s43, v8
    v_lshrrev_b32 v61, 16, v9
    v_and_b32 v9, s43, v9
    v_lshrrev_b32 v62, 16, v10
    v_and_b32 v10, s43, v10
    v_lshrrev_b32 v63, 16, v11
    v_and_b32 v11, s43, v11
    v_lshrrev_b32 v64, 16, v12
    v_and_b32 v12, s43, v12
    v_lshrrev_b32 v65, 16, v13
    v_and_b32 v13, s43, v13
    v_lshrrev_b32 v66, 16, v14
    v_and_b32 v14, s43, v14
    v_lshrrev_b32 v67, 16, v15
    v_and_b32 v15, s43, v15
    v_lshrrev_b32 v68, 16, v16
    v_and_b32 v16, s43, v16
    v_lshlrev_b32 v128, 16, v206
    v_and_b32 v129, s43, v206
    v_lshlrev_b32 v130, 16, v207
    v_and_b32 v131, s43, v207
    v_lshlrev_b32 v132, 16, v208
    v_and_b32 v133, s43, v208
    v_lshlrev_b32 v134, 16, v209
    v_and_b32 v135, s43, v209
    v_lshlrev_b32 v136, 16, v210
    v_mul_f32 v180, s16, v128
    v_mul_f32 v181, s16, v129
    v_mul_f32 v182, s16, v130
    v_mul_f32 v183, s16, v131
    v_mul_f32 v184, s16, v132
    v_mul_f32 v185, s16, v133
    v_mul_f32 v186, s16, v134
    v_mul_f32 v187, s16, v135
    v_mul_f32 v188, s16, v136
    v_exp_f32 v180, v180
    v_exp_f32 v181, v181
    v_exp_f32 v182, v182
    v_exp_f32 v183, v183
    v_exp_f32 v184, v184
    v_exp_f32 v185, v185
    v_exp_f32 v186, v186
    v_exp_f32 v187, v187
    v_exp_f32 v188, v188
    v_add_f32 v180, 1.0, v180
    v_add_f32 v181, 1.0, v181
    v_add_f32 v182, 1.0, v182
    v_add_f32 v183, 1.0, v183
    v_add_f32 v184, 1.0, v184
    v_add_f32 v185, 1.0, v185
    v_add_f32 v186, 1.0, v186
    v_add_f32 v187, 1.0, v187
    v_add_f32 v188, 1.0, v188
    v_rcp_f32 v180, v180
    v_rcp_f32 v181, v181
    v_rcp_f32 v182, v182
    v_rcp_f32 v183, v183
    v_rcp_f32 v184, v184
    v_rcp_f32 v185, v185
    v_rcp_f32 v186, v186
    v_rcp_f32 v187, v187
    v_rcp_f32 v188, v188
    v_mul_f32 v128, v128, v180
    v_mul_f32 v129, v129, v181
    v_mul_f32 v130, v130, v182
    v_mul_f32 v131, v131, v183
    v_mul_f32 v132, v132, v184
    v_mul_f32 v133, v133, v185
    v_mul_f32 v134, v134, v186
    v_mul_f32 v135, v135, v187
    v_mul_f32 v136, v136, v188
    v_cvt_pk_bf16_f32 v128, v128, v128
    v_cvt_pk_bf16_f32 v129, v129, v129
    v_cvt_pk_bf16_f32 v130, v130, v130
    v_cvt_pk_bf16_f32 v131, v131, v131
    v_cvt_pk_bf16_f32 v132, v132, v132
    v_cvt_pk_bf16_f32 v133, v133, v133
    v_cvt_pk_bf16_f32 v134, v134, v134
    v_cvt_pk_bf16_f32 v135, v135, v135
    v_cvt_pk_bf16_f32 v136, v136, v136
    v_lshrrev_b32 v180, 16, v128
    v_and_b32 v128, s43, v128
    v_lshrrev_b32 v181, 16, v129
    v_and_b32 v129, s43, v129
    v_lshrrev_b32 v182, 16, v130
    v_and_b32 v130, s43, v130
    v_lshrrev_b32 v183, 16, v131
    v_and_b32 v131, s43, v131
    v_lshrrev_b32 v184, 16, v132
    v_and_b32 v132, s43, v132
    v_lshrrev_b32 v185, 16, v133
    v_and_b32 v133, s43, v133
    v_lshrrev_b32 v186, 16, v134
    v_and_b32 v134, s43, v134
    v_lshrrev_b32 v187, 16, v135
    v_and_b32 v135, s43, v135
    v_lshrrev_b32 v188, 16, v136
    v_and_b32 v136, s43, v136
    s_waitcnt vmcnt(17)
    v_dot2c_f32_bf16 v192, v20, v60
    v_dot2c_f32_bf16 v193, v20, v8
    v_dot2c_f32_bf16 v194, v21, v60
    v_dot2c_f32_bf16 v195, v21, v8
    v_dot2c_f32_bf16 v196, v22, v60
    v_dot2c_f32_bf16 v197, v22, v8
    v_dot2c_f32_bf16 v198, v23, v60
    v_dot2c_f32_bf16 v199, v23, v8
    s_waitcnt vmcnt(16)
    v_dot2c_f32_bf16 v192, v24, v61
    v_dot2c_f32_bf16 v193, v24, v9
    v_dot2c_f32_bf16 v194, v25, v61
    v_dot2c_f32_bf16 v195, v25, v9
    v_dot2c_f32_bf16 v196, v26, v61
    v_dot2c_f32_bf16 v197, v26, v9
    v_dot2c_f32_bf16 v198, v27, v61
    v_dot2c_f32_bf16 v199, v27, v9
    s_waitcnt vmcnt(15)
    v_dot2c_f32_bf16 v192, v28, v62
    v_dot2c_f32_bf16 v193, v28, v10
    v_dot2c_f32_bf16 v194, v29, v62
    v_dot2c_f32_bf16 v195, v29, v10
    v_dot2c_f32_bf16 v196, v30, v62
    v_dot2c_f32_bf16 v197, v30, v10
    v_dot2c_f32_bf16 v198, v31, v62
    v_dot2c_f32_bf16 v199, v31, v10
    s_waitcnt vmcnt(14)
    v_dot2c_f32_bf16 v192, v32, v63
    v_dot2c_f32_bf16 v193, v32, v11
    v_dot2c_f32_bf16 v194, v33, v63
    v_dot2c_f32_bf16 v195, v33, v11
    v_dot2c_f32_bf16 v196, v34, v63
    v_dot2c_f32_bf16 v197, v34, v11
    v_dot2c_f32_bf16 v198, v35, v63
    v_dot2c_f32_bf16 v199, v35, v11
    s_waitcnt vmcnt(13)
    v_dot2c_f32_bf16 v192, v36, v64
    v_dot2c_f32_bf16 v193, v36, v12
    v_dot2c_f32_bf16 v194, v37, v64
    v_dot2c_f32_bf16 v195, v37, v12
    v_dot2c_f32_bf16 v196, v38, v64
    v_dot2c_f32_bf16 v197, v38, v12
    v_dot2c_f32_bf16 v198, v39, v64
    v_dot2c_f32_bf16 v199, v39, v12
    s_waitcnt vmcnt(12)
    v_dot2c_f32_bf16 v192, v40, v65
    v_dot2c_f32_bf16 v193, v40, v13
    v_dot2c_f32_bf16 v194, v41, v65
    v_dot2c_f32_bf16 v195, v41, v13
    v_dot2c_f32_bf16 v196, v42, v65
    v_dot2c_f32_bf16 v197, v42, v13
    v_dot2c_f32_bf16 v198, v43, v65
    v_dot2c_f32_bf16 v199, v43, v13
    s_waitcnt vmcnt(11)
    v_dot2c_f32_bf16 v192, v44, v66
    v_dot2c_f32_bf16 v193, v44, v14
    v_dot2c_f32_bf16 v194, v45, v66
    v_dot2c_f32_bf16 v195, v45, v14
    v_dot2c_f32_bf16 v196, v46, v66
    v_dot2c_f32_bf16 v197, v46, v14
    v_dot2c_f32_bf16 v198, v47, v66
    v_dot2c_f32_bf16 v199, v47, v14
    s_waitcnt vmcnt(10)
    v_dot2c_f32_bf16 v192, v48, v67
    v_dot2c_f32_bf16 v193, v48, v15
    v_dot2c_f32_bf16 v194, v49, v67
    v_dot2c_f32_bf16 v195, v49, v15
    v_dot2c_f32_bf16 v196, v50, v67
    v_dot2c_f32_bf16 v197, v50, v15
    v_dot2c_f32_bf16 v198, v51, v67
    v_dot2c_f32_bf16 v199, v51, v15
    s_waitcnt vmcnt(9)
    v_dot2c_f32_bf16 v192, v52, v68
    v_dot2c_f32_bf16 v193, v52, v16
    v_dot2c_f32_bf16 v194, v53, v68
    v_dot2c_f32_bf16 v195, v53, v16
    v_dot2c_f32_bf16 v196, v54, v68
    v_dot2c_f32_bf16 v197, v54, v16
    v_dot2c_f32_bf16 v198, v55, v68
    v_dot2c_f32_bf16 v199, v55, v16
    s_waitcnt vmcnt(8)
    v_dot2c_f32_bf16 v192, v140, v180
    v_dot2c_f32_bf16 v193, v140, v128
    v_dot2c_f32_bf16 v194, v141, v180
    v_dot2c_f32_bf16 v195, v141, v128
    v_dot2c_f32_bf16 v196, v142, v180
    v_dot2c_f32_bf16 v197, v142, v128
    v_dot2c_f32_bf16 v198, v143, v180
    v_dot2c_f32_bf16 v199, v143, v128
    s_waitcnt vmcnt(7)
    v_dot2c_f32_bf16 v192, v144, v181
    v_dot2c_f32_bf16 v193, v144, v129
    v_dot2c_f32_bf16 v194, v145, v181
    v_dot2c_f32_bf16 v195, v145, v129
    v_dot2c_f32_bf16 v196, v146, v181
    v_dot2c_f32_bf16 v197, v146, v129
    v_dot2c_f32_bf16 v198, v147, v181
    v_dot2c_f32_bf16 v199, v147, v129
    s_waitcnt vmcnt(6)
    v_dot2c_f32_bf16 v192, v148, v182
    v_dot2c_f32_bf16 v193, v148, v130
    v_dot2c_f32_bf16 v194, v149, v182
    v_dot2c_f32_bf16 v195, v149, v130
    v_dot2c_f32_bf16 v196, v150, v182
    v_dot2c_f32_bf16 v197, v150, v130
    v_dot2c_f32_bf16 v198, v151, v182
    v_dot2c_f32_bf16 v199, v151, v130
    s_waitcnt vmcnt(5)
    v_dot2c_f32_bf16 v192, v152, v183
    v_dot2c_f32_bf16 v193, v152, v131
    v_dot2c_f32_bf16 v194, v153, v183
    v_dot2c_f32_bf16 v195, v153, v131
    v_dot2c_f32_bf16 v196, v154, v183
    v_dot2c_f32_bf16 v197, v154, v131
    v_dot2c_f32_bf16 v198, v155, v183
    v_dot2c_f32_bf16 v199, v155, v131
    s_waitcnt vmcnt(4)
    v_dot2c_f32_bf16 v192, v156, v184
    v_dot2c_f32_bf16 v193, v156, v132
    v_dot2c_f32_bf16 v194, v157, v184
    v_dot2c_f32_bf16 v195, v157, v132
    v_dot2c_f32_bf16 v196, v158, v184
    v_dot2c_f32_bf16 v197, v158, v132
    v_dot2c_f32_bf16 v198, v159, v184
    v_dot2c_f32_bf16 v199, v159, v132
    s_waitcnt vmcnt(3)
    v_dot2c_f32_bf16 v192, v160, v185
    v_dot2c_f32_bf16 v193, v160, v133
    v_dot2c_f32_bf16 v194, v161, v185
    v_dot2c_f32_bf16 v195, v161, v133
    v_dot2c_f32_bf16 v196, v162, v185
    v_dot2c_f32_bf16 v197, v162, v133
    v_dot2c_f32_bf16 v198, v163, v185
    v_dot2c_f32_bf16 v199, v163, v133
    s_waitcnt vmcnt(2)
    v_dot2c_f32_bf16 v192, v164, v186
    v_dot2c_f32_bf16 v193, v164, v134
    v_dot2c_f32_bf16 v194, v165, v186
    v_dot2c_f32_bf16 v195, v165, v134
    v_dot2c_f32_bf16 v196, v166, v186
    v_dot2c_f32_bf16 v197, v166, v134
    v_dot2c_f32_bf16 v198, v167, v186
    v_dot2c_f32_bf16 v199, v167, v134
    s_waitcnt vmcnt(1)
    v_dot2c_f32_bf16 v192, v168, v187
    v_dot2c_f32_bf16 v193, v168, v135
    v_dot2c_f32_bf16 v194, v169, v187
    v_dot2c_f32_bf16 v195, v169, v135
    v_dot2c_f32_bf16 v196, v170, v187
    v_dot2c_f32_bf16 v197, v170, v135
    v_dot2c_f32_bf16 v198, v171, v187
    v_dot2c_f32_bf16 v199, v171, v135
    s_waitcnt vmcnt(0)
    v_dot2c_f32_bf16 v192, v172, v188
    v_dot2c_f32_bf16 v193, v172, v136
    v_dot2c_f32_bf16 v194, v173, v188
    v_dot2c_f32_bf16 v195, v173, v136
    v_dot2c_f32_bf16 v196, v174, v188
    v_dot2c_f32_bf16 v197, v174, v136
    v_dot2c_f32_bf16 v198, v175, v188
    v_dot2c_f32_bf16 v199, v175, v136
    s_nop 2
    v_add_f32_dpp v192, v192, v192 row_ror:8 row_mask:0xf bank_mask:0xf
    v_add_f32_dpp v193, v193, v193 row_ror:8 row_mask:0xf bank_mask:0xf
    v_add_f32_dpp v194, v194, v194 row_ror:8 row_mask:0xf bank_mask:0xf
    v_add_f32_dpp v195, v195, v195 row_ror:8 row_mask:0xf bank_mask:0xf
    v_add_f32_dpp v196, v196, v196 row_ror:8 row_mask:0xf bank_mask:0xf
    v_add_f32_dpp v197, v197, v197 row_ror:8 row_mask:0xf bank_mask:0xf
    v_add_f32_dpp v198, v198, v198 row_ror:8 row_mask:0xf bank_mask:0xf
    v_add_f32_dpp v199, v199, v199 row_ror:8 row_mask:0xf bank_mask:0xf
    v_lshrrev_b32 v4, 4, v0
    v_lshlrev_b32 v4, 8, v4
    v_lshl_add_u32 v4, v6, 5, v4
    s_lshl_b32 s16, s3, 10
    s_add_u32 s16, s16, 81920
    v_add_u32 v4, s16, v4
    ds_write_b128 v4, v[192:195]
    ds_write_b128 v4, v[196:199] offset:16
    v_readlane_b32 s8, v7, 0
    v_readlane_b32 s4, v7, 1
    s_mul_i32 s8, s8, 1664525
    s_mul_i32 s4, s4, 0x9e3779b0
    s_add_u32 s8, s8, s4
    s_add_u32 s8, s8, 1013904223
    v_lshlrev_b32 v4, 2, v0
    v_add_u32 v5, 81920, v4
    s_waitcnt lgkmcnt(0)
    s_barrier
    s_cmp_lg_u32 s3, 0
    s_cbranch_scc1 SA_END
    ds_read2st64_b32 v[20:21], v5 offset0:0 offset1:1
    ds_read2st64_b32 v[22:23], v5 offset0:2 offset1:3
    ds_read2st64_b32 v[24:25], v5 offset0:4 offset1:5
    ds_read2st64_b32 v[26:27], v5 offset0:6 offset1:7
    ds_read2st64_b32 v[28:29], v5 offset0:8 offset1:9
    ds_read2st64_b32 v[30:31], v5 offset0:10 offset1:11
    ds_read2st64_b32 v[32:33], v5 offset0:12 offset1:13
    ds_read2st64_b32 v[34:35], v5 offset0:14 offset1:15
    s_lshl_b32 s17, s10, 8
    s_lshl_b32 s18, s10, 9
    s_add_u32 s18, s18, 16384
    s_add_u32 s17, s17, 0
    v_lshlrev_b32 v5, 3, v0
    s_lshl_b32 s19, s10, 7
    s_add_u32 s19, s19, 51216384
    s_sub_u32 s16, s10, 36
    s_cmp_lt_u32 s16, 9
    s_cselect_b32 s16, 1.0, 0
    s_waitcnt lgkmcnt(0)
    v_pk_add_f32 v[20:21], v[20:21], v[28:29]
    v_pk_add_f32 v[22:23], v[22:23], v[30:31]
    v_pk_add_f32 v[24:25], v[24:25], v[32:33]
    v_pk_add_f32 v[26:27], v[26:27], v[34:35]
    v_pk_add_f32 v[20:21], v[20:21], v[24:25]
    v_pk_add_f32 v[22:23], v[22:23], v[26:27]
    v_pk_add_f32 v[20:21], v[20:21], v[22:23]
    v_add_f32 v20, v20, v21
    v_mov_b32 v21, s8
    v_cvt_pk_bf16_f32 v20, v20, v20
    v_lshlrev_b32 v20, 16, v20
    v_add_f32 v20, s16, v20
    v_cvt_pk_bf16_f32 v20, v20, v20
    v_lshlrev_b32 v20, 16, v20
    v_lshlrev_b32 v22, 2, v0
    v_and_b32 v22, 124, v22
    buffer_store_dwordx2 v[20:21], v5, s[28:31], s18 offen sc1
    buffer_store_dword v20, v4, s[28:31], s17 offen sc1
    s_waitcnt vmcnt(0)
    buffer_store_dword v21, v22, s[28:31], s19 offen sc1
SA_END:
    s_barrier
    s_load_dwordx2 s[36:37], s[0:1], 96
    s_and_b32 s10, s2, 7
    s_lshr_b32 s11, s2, 3
    s_sub_u32 s11, s11, 21
    s_cmp_lt_i32 s11, 0
    s_cselect_b32 s16, 14, 0
    s_add_u32 s11, s11, s16
    v_lshrrev_b32 v31, 3, v0
    v_mul_u32_u24 v31, 9216, v31
    v_and_b32 v30, 7, v0
    v_lshl_add_u32 v31, v30, 4, v31
    v_lshlrev_b32 v26, 7, v0
    s_mov_b32 s12, 572662306
    s_mov_b32 s13, 2307426
    s_lshl_b32 s16, s11, 2
    s_lshr_b64 s[12:13], s[12:13], s16
    s_and_b32 s58, s12, 15
    s_mov_b32 s12, 420943123
    s_mov_b32 s13, 555687195
    s_mov_b32 s14, 184942627
    s_mov_b32 s15, 4366
    s_cmp_lt_u32 s11, 8
    s_cselect_b64 s[12:13], s[12:13], s[14:15]
    s_lshl_b32 s16, s11, 3
    s_lshr_b64 s[12:13], s[12:13], s16
    s_and_b32 s56, s12, 255
    s_lshl_b32 s56, s56, 3
    s_add_u32 s56, s56, s10
    s_lshl_b32 s56, s56, 1
    s_lshr_b32 s16, s3, 1
    s_add_u32 s56, s56, s16
    s_lshl_b32 s56, s56, 13
    s_bitcmp1_b32 s3, 0
    s_cselect_b32 s40, s24, s20
    s_cselect_b32 s41, s25, s21
    s_cselect_b32 s42, s26, s22
    s_cselect_b32 s57, 1024, 0
    s_add_u32 s56, s56, s57
    s_mov_b32 s43, 0x00020000
    s_lshl_b32 s12, s11, 1
    s_mul_i32 s17, s10, 1152
    s_lshl_b32 s16, s10, 4
    s_add_u32 s16, s16, s11
    s_lshl_b32 s16, s16, 7
    s_add_u32 s59, s16, 51183616
    s_cmp_ge_u32 s11, 9
    s_cbranch_scc1 SD_S
    s_mul_i32 s16, s10, 18
    s_add_u32 s16, s16, s12
    s_mul_i32 s48, s16, 36864
    s_mul_i32 s5, s3, 9216
    s_add_u32 s48, s48, s5
    s_mov_b32 m0, s5
    s_mov_b32 s38, 5308416
    s_mov_b32 s39, 0x00020000
    s_waitcnt lgkmcnt(0)
    buffer_load_dwordx4 v1, s[36:39], s48 offen offset:0 nt lds
    buffer_load_dwordx4 v1, s[36:39], s48 offen offset:1024 nt lds
    buffer_load_dwordx4 v1, s[36:39], s48 offen offset:2048 nt lds
    buffer_load_dwordx4 v1, s[36:39], s48 offen offset:3072 nt lds
    s_add_u32 m0, m0, 4096
    s_add_u32 s48, s48, 4096
    buffer_load_dwordx4 v1, s[36:39], s48 offen offset:0 nt lds
    buffer_load_dwordx4 v1, s[36:39], s48 offen offset:1024 nt lds
    buffer_load_dwordx4 v1, s[36:39], s48 offen offset:2048 nt lds
    buffer_load_dwordx4 v1, s[36:39], s48 offen offset:3072 nt lds
    s_add_u32 m0, m0, 4096
    s_add_u32 s48, s48, 4096
    buffer_load_dwordx4 v1, s[36:39], s48 offen offset:0 nt lds
    s_add_u32 m0, m0, 28672
    s_add_u32 s48, s48, 28672
    buffer_load_dwordx4 v1, s[36:39], s48 offen offset:0 nt lds
    buffer_load_dwordx4 v1, s[36:39], s48 offen offset:1024 nt lds
    buffer_load_dwordx4 v1, s[36:39], s48 offen offset:2048 nt lds
    buffer_load_dwordx4 v1, s[36:39], s48 offen offset:3072 nt lds
    s_add_u32 m0, m0, 4096
    s_add_u32 s48, s48, 4096
    buffer_load_dwordx4 v1, s[36:39], s48 offen offset:0 nt lds
    buffer_load_dwordx4 v1, s[36:39], s48 offen offset:1024 nt lds
    buffer_load_dwordx4 v1, s[36:39], s48 offen offset:2048 nt lds
    buffer_load_dwordx4 v1, s[36:39], s48 offen offset:3072 nt lds
    s_add_u32 m0, m0, 4096
    s_add_u32 s48, s48, 4096
    buffer_load_dwordx4 v1, s[36:39], s48 offen offset:0 nt lds
    s_lshl_b32 s54, s11, 2
    s_add_u32 s54, s54, s3
    s_lshr_b32 s16, s54, 1
    s_mul_i32 s16, s16, 294912
    s_add_u32 s16, s16, s17
    s_sub_u32 s45, 3, s10
    s_and_b32 s45, s45, 7
    s_cselect_b32 s45, s45, 8
    s_lshl_b32 s45, s45, 7
    s_add_u32 s16, s16, s45
    s_add_u32 s16, s16, s57
    s_lshl_b32 s55, s3, 12
    s_add_u32 s55, s55, 73728
    s_mov_b32 m0, s55
    s_nop 0
    buffer_load_dwordx4 v31, s[40:43], s16 offen  lds
    s_add_u32 m0, m0, 1024
    s_add_u32 s16, s16, 73728
    buffer_load_dwordx4 v31, s[40:43], s16 offen  lds
    s_add_u32 m0, m0, 1024
    s_add_u32 s16, s16, 73728
    buffer_load_dwordx4 v31, s[40:43], s16 offen  lds
    s_add_u32 m0, m0, 1024
    s_add_u32 s16, s16, 73728
    buffer_load_dwordx4 v31, s[40:43], s16 offen  lds
    s_add_u32 m0, m0, 1024
    s_add_u32 s16, s16, 73728
    s_lshr_b32 s49, s10, 1
    s_lshl_b32 s18, s49, 2
    s_add_u32 s18, s18, s3
    s_mul_i32 s18, s18, 331776
    s_add_u32 s18, s18, 33554432
    s_sub_u32 s45, 3, s10
    s_and_b32 s45, s45, 7
    s_cselect_b32 s45, s45, 8
    s_cmp_gt_u32 s11, s45
    s_subb_u32 s47, s11, 0
    s_cmp_eq_u32 s11, s45
    s_cselect_b32 s47, 8, s47
    s_and_b32 s16, s10, 1
    s_lshl_b32 s17, s47, 1
    s_add_u32 s17, s17, 0
    s_lshr_b32 s12, s17, 2
    s_and_b32 s13, s17, 3
    s_lshl_b32 s14, s16, 3
    s_lshl_b32 s15, s12, 1
    s_add_u32 s14, s14, s15
    s_add_u32 s14, s14, s13
    s_lshl_b32 s15, s16, 2
    s_add_u32 s15, s15, s12
    s_lshl_b32 s19, s13, 3
    s_add_u32 s15, s15, s19
    s_add_u32 s15, s15, 4
    s_cmp_ge_u32 s13, 2
    s_cselect_b32 s14, s15, s14
    s_lshl_b32 s15, s16, 1
    s_add_u32 s15, s15, s17
    s_cmp_ge_u32 s17, 16
    s_cselect_b32 s14, s15, s14
    s_cmp_ge_u32 s14, 28
    s_cselect_b32 s12, 40960, 0
    s_cmp_ge_u32 s14, 20
    s_cselect_b32 s13, 40960, 0
    s_mul_i32 s16, s14, 5120
    s_add_u32 s16, s16, s12
    s_add_u32 s50, s16, s18
    s_lshl_b32 s16, s14, 11
    s_add_u32 s16, s16, s18
    s_add_u32 s52, s16, 258048
    s_add_u32 s16, s16, s13
    s_add_u32 s51, s16, 143360
    s_add_u32 s53, s50, 4096
    s_and_b32 s16, s10, 1
    s_lshl_b32 s17, s47, 1
    s_add_u32 s17, s17, 1
    s_lshr_b32 s12, s17, 2
    s_and_b32 s13, s17, 3
    s_lshl_b32 s14, s16, 3
    s_lshl_b32 s15, s12, 1
    s_add_u32 s14, s14, s15
    s_add_u32 s14, s14, s13
    s_lshl_b32 s15, s16, 2
    s_add_u32 s15, s15, s12
    s_lshl_b32 s19, s13, 3
    s_add_u32 s15, s15, s19
    s_add_u32 s15, s15, 4
    s_cmp_ge_u32 s13, 2
    s_cselect_b32 s14, s15, s14
    s_lshl_b32 s15, s16, 1
    s_add_u32 s15, s15, s17
    s_cmp_ge_u32 s17, 16
    s_cselect_b32 s14, s15, s14
    s_cmp_ge_u32 s14, 28
    s_cselect_b32 s12, 40960, 0
    s_cmp_ge_u32 s14, 20
    s_cselect_b32 s13, 40960, 0
    s_mul_i32 s16, s14, 5120
    s_add_u32 s16, s16, s12
    s_add_u32 s60, s16, s18
    s_lshl_b32 s16, s14, 11
    s_add_u32 s16, s16, s18
    s_add_u32 s62, s16, 258048
    s_add_u32 s16, s16, s13
    s_add_u32 s61, s16, 143360
    s_add_u32 s63, s60, 4096
    v_lshrrev_b32 v5, 2, v0
    v_mul_u32_u24 v5, 1152, v5
    s_mul_i32 s16, s3, 288
    v_add_u32 v5, s16, v5
    v_and_b32 v6, 3, v0
    v_lshl_add_u32 v24, v6, 3, v5
    v_lshl_add_u32 v5, v6, 4, v5
    s_add_u32 s19, s49, 0
    s_and_b32 s19, s19, 3
    s_lshl_b32 s19, s19, 6
    v_add_u32 v20, s19, v5
    s_add_u32 s19, s49, 1
    s_and_b32 s19, s19, 3
    s_lshl_b32 s19, s19, 6
    v_add_u32 v21, s19, v5
    s_add_u32 s19, s49, 2
    s_and_b32 s19, s19, 3
    s_lshl_b32 s19, s19, 6
    v_add_u32 v22, s19, v5
    s_add_u32 s19, s49, 3
    s_and_b32 s19, s19, 3
    s_lshl_b32 s19, s19, 6
    v_add_u32 v23, s19, v5
    s_waitcnt vmcnt(13)
    s_barrier
    ds_read_b64_tr_b16 v[32:33], v21 offset:0
    ds_read_b64_tr_b16 v[34:35], v21 offset:18432
    ds_read_b64_tr_b16 v[36:37], v21 offset:8
    ds_read_b64_tr_b16 v[38:39], v21 offset:18440
    ds_read_b64_tr_b16 v[40:41], v22 offset:0
    ds_read_b64_tr_b16 v[42:43], v22 offset:18432
    ds_read_b64_tr_b16 v[44:45], v22 offset:8
    ds_read_b64_tr_b16 v[46:47], v22 offset:18440
    ds_read_b64_tr_b16 v[48:49], v23 offset:0
    ds_read_b64_tr_b16 v[50:51], v23 offset:18432
    ds_read_b64_tr_b16 v[52:53], v23 offset:8
    ds_read_b64_tr_b16 v[54:55], v23 offset:18440
    s_waitcnt lgkmcnt(8)
    ds_read_b64_tr_b16 v[56:57], v20 offset:0
    ds_read_b64_tr_b16 v[58:59], v20 offset:18432
    ds_read_b64_tr_b16 v[60:61], v20 offset:8
    ds_read_b64_tr_b16 v[62:63], v20 offset:18440
    ds_read_b64_tr_b16 v[64:65], v24 offset:256
    ds_read_b64_tr_b16 v[66:67], v24 offset:18688
    buffer_store_dwordx4 v[32:35], v1, s[28:31], s50 offen offset:0 sc1
    buffer_store_dwordx4 v[36:39], v1, s[28:31], s50 offen offset:1024 sc1
    s_waitcnt lgkmcnt(12)
    buffer_store_dwordx4 v[40:43], v1, s[28:31], s50 offen offset:2048 sc1
    s_waitcnt lgkmcnt(10)
    buffer_store_dwordx4 v[44:47], v1, s[28:31], s50 offen offset:3072 sc1
    s_waitcnt lgkmcnt(8)
    buffer_store_dwordx4 v[48:51], v1, s[28:31], s51 offen offset:0 sc1
    s_waitcnt lgkmcnt(6)
    buffer_store_dwordx4 v[52:55], v1, s[28:31], s51 offen offset:1024 sc1
    s_waitcnt lgkmcnt(4)
    buffer_store_dwordx4 v[56:59], v1, s[28:31], s52 offen offset:0 sc1
    s_waitcnt lgkmcnt(2)
    buffer_store_dwordx4 v[60:63], v1, s[28:31], s52 offen offset:1024 sc1
    s_waitcnt lgkmcnt(0)
    buffer_store_dwordx4 v[64:67], v1, s[28:31], s53 offen sc1
    s_waitcnt vmcnt(13)
    s_barrier
    ds_read_b64_tr_b16 v[72:73], v21 offset:36864
    ds_read_b64_tr_b16 v[74:75], v21 offset:55296
    ds_read_b64_tr_b16 v[76:77], v21 offset:36872
    ds_read_b64_tr_b16 v[78:79], v21 offset:55304
    ds_read_b64_tr_b16 v[80:81], v22 offset:36864
    ds_read_b64_tr_b16 v[82:83], v22 offset:55296
    ds_read_b64_tr_b16 v[84:85], v22 offset:36872
    ds_read_b64_tr_b16 v[86:87], v22 offset:55304
    ds_read_b64_tr_b16 v[88:89], v23 offset:36864
    ds_read_b64_tr_b16 v[90:91], v23 offset:55296
    ds_read_b64_tr_b16 v[92:93], v23 offset:36872
    ds_read_b64_tr_b16 v[94:95], v23 offset:55304
    s_waitcnt lgkmcnt(8)
    ds_read_b64_tr_b16 v[96:97], v20 offset:36864
    ds_read_b64_tr_b16 v[98:99], v20 offset:55296
    ds_read_b64_tr_b16 v[100:101], v20 offset:36872
    ds_read_b64_tr_b16 v[102:103], v20 offset:55304
    ds_read_b64_tr_b16 v[104:105], v24 offset:37120
    ds_read_b64_tr_b16 v[106:107], v24 offset:55552
    buffer_store_dwordx4 v[72:75], v1, s[28:31], s60 offen offset:0 sc1
    buffer_store_dwordx4 v[76:79], v1, s[28:31], s60 offen offset:1024 sc1
    s_waitcnt lgkmcnt(12)
    buffer_store_dwordx4 v[80:83], v1, s[28:31], s60 offen offset:2048 sc1
    s_waitcnt lgkmcnt(10)
    buffer_store_dwordx4 v[84:87], v1, s[28:31], s60 offen offset:3072 sc1
    s_waitcnt lgkmcnt(8)
    buffer_store_dwordx4 v[88:91], v1, s[28:31], s61 offen offset:0 sc1
    s_waitcnt lgkmcnt(6)
    buffer_store_dwordx4 v[92:95], v1, s[28:31], s61 offen offset:1024 sc1
    s_waitcnt lgkmcnt(4)
    buffer_store_dwordx4 v[96:99], v1, s[28:31], s62 offen offset:0 sc1
    s_waitcnt lgkmcnt(2)
    buffer_store_dwordx4 v[100:103], v1, s[28:31], s62 offen offset:1024 sc1
    s_waitcnt lgkmcnt(0)
    buffer_store_dwordx4 v[104:107], v1, s[28:31], s63 offen sc1
    v_lshrrev_b32 v5, 2, v0
    v_lshlrev_b32 v5, 7, v5
    v_lshl_add_u32 v5, v6, 3, v5
    v_add_u32 v5, s55, v5
    s_mul_i32 s16, s10, 147456
    s_lshl_b32 s17, s54, 10
    s_add_u32 s16, s16, s17
    s_add_u32 s16, s16, 39845888
    s_waitcnt vmcnt(18)
    ds_read_b64_tr_b16 v[112:113], v5 offset:0
    ds_read_b64_tr_b16 v[114:115], v5 offset:2048
    ds_read_b64_tr_b16 v[116:117], v5 offset:32
    ds_read_b64_tr_b16 v[118:119], v5 offset:2080
    ds_read_b64_tr_b16 v[120:121], v5 offset:64
    ds_read_b64_tr_b16 v[122:123], v5 offset:2112
    ds_read_b64_tr_b16 v[124:125], v5 offset:96
    ds_read_b64_tr_b16 v[126:127], v5 offset:2144
    s_waitcnt lgkmcnt(6)
    buffer_store_dwordx4 v[112:115], v1, s[28:31], s16 offen sc1
    s_add_u32 s16, s16, 36864
    s_waitcnt lgkmcnt(4)
    buffer_store_dwordx4 v[116:119], v1, s[28:31], s16 offen sc1
    s_add_u32 s16, s16, 36864
    s_waitcnt lgkmcnt(2)
    buffer_store_dwordx4 v[120:123], v1, s[28:31], s16 offen sc1
    s_add_u32 s16, s16, 36864
    s_waitcnt lgkmcnt(0)
    buffer_store_dwordx4 v[124:127], v1, s[28:31], s16 offen sc1
    s_add_u32 s16, s16, 36864
SD_S:
    s_cmp_eq_u32 s58, 0
    s_cbranch_scc1 SD_T1_X
SD_T1:
    buffer_load_dword v240, v26, s[40:43], s56 offen
    s_add_u32 s56, s56, 131072
    s_sub_u32 s58, s58, 1
    s_cmp_lg_u32 s58, 0
    s_cbranch_scc1 SD_T1
SD_T1_X:
SD_P:
    v_lshlrev_b32 v10, 2, v0
    v_and_b32 v10, 124, v10
    v_mov_b32 v11, s8
    s_waitcnt vmcnt(0) lgkmcnt(0)
    s_barrier
    s_cmp_lg_u32 s3, 0
    s_cbranch_scc1 SD_B
    buffer_store_dword v11, v10, s[28:31], s59 offen sc1
SD_B:
    v_lshrrev_b32 v28, 3, v0
    v_and_b32 v29, 6, v28
    v_and_b32 v30, 7, v0
    v_xor_b32 v29, v29, v30
    v_lshlrev_b32 v29, 4, v29
    s_lshl_b32 s16, s3, 3
    v_add_u32 v28, s16, v28
    v_mul_u32_u24 v28, 9216, v28
    v_add_u32 v28, v28, v29
    s_branch SD_PF
CV_T:
    s_bfe_u32 s56, s2, 0x10003
    s_mul_i32 s56, s56, 2
    s_add_u32 s56, s56, 37
    s_lshl_b32 s56, s56, 3
    s_and_b32 s16, s2, 7
    s_add_u32 s56, s56, s16
    s_lshl_b32 s56, s56, 1
    s_lshr_b32 s16, s3, 1
    s_add_u32 s56, s56, s16
    s_lshl_b32 s56, s56, 13
    s_bitcmp1_b32 s3, 0
    s_cselect_b32 s40, s24, s20
    s_cselect_b32 s41, s25, s21
    s_cselect_b32 s42, s26, s22
    s_cselect_b32 s57, 1024, 0
    s_add_u32 s56, s56, s57
    s_mov_b32 s43, 0x00020000
    s_mov_b32 s58, 2
    v_lshlrev_b32 v26, 7, v0
    s_cmp_eq_u32 s58, 0
    s_cbranch_scc1 SD_T3_X
SD_T3:
    buffer_load_dword v240, v26, s[40:43], s56 offen
    s_add_u32 s56, s56, 131072
    s_sub_u32 s58, s58, 1
    s_cmp_lg_u32 s58, 0
    s_cbranch_scc1 SD_T3
SD_T3_X:
SD_PF:
    s_add_u32 s57, s44, 0
    s_add_u32 m0, s46, 106496
    s_nop 0
    buffer_load_dwordx4 v28, s[20:23], s57 offen lds
    buffer_load_dwordx4 v28, s[24:27], s57 offen offset:1024 lds
    s_add_u32 s57, s44, 294912
    s_add_u32 m0, s46, 114688
    s_nop 0
    buffer_load_dwordx4 v28, s[20:23], s57 offen lds
    buffer_load_dwordx4 v28, s[24:27], s57 offen offset:1024 lds
    s_add_u32 s57, s44, 589824
    s_add_u32 m0, s46, 122880
    s_nop 0
    buffer_load_dwordx4 v28, s[20:23], s57 offen lds
    buffer_load_dwordx4 v28, s[24:27], s57 offen offset:1024 lds
GEMM_START:
    s_getpc_b64 s[0:1]
GPC0:
    s_cmp_lt_u32 s2, 128
    s_cbranch_scc1 NOCT0
    v_lshlrev_b32 v199, 7, v0
    s_lshl_b32 s16, s3, 13
    v_add_u32 v199, s16, v199
    global_load_dword v199, v199, s[0:1]
NOCT0:
    s_and_b32 s11, s2, 7
    s_bfe_u32 s12, s2, 0x20003
    s_lshr_b32 s10, s2, 5
    s_lshl_b32 s15, s10, 4
    s_lshl_b32 s16, s3, 2
    s_add_u32 s15, s15, s16
    v_and_b32 v195, 3, v0
    v_add_u32 v195, s15, v195
    v_lshlrev_b32 v195, 7, v195
    s_and_b32 s16, s2, 0
    s_lshl_b32 s16, s16, 15
    s_add_u32 s9, s16, 51904512
    s_add_u32 s19, s16, 51642368
    buffer_load_dword v193, v195, s[28:31], s19 offen sc1
    s_mul_i32 s40, s15, 18432
    s_add_u32 s40, s40, 9437184
    v_add_u32 v226, 18432, v1
    v_add_u32 v227, 36864, v1
    v_add_u32 v228, 55296, v1
    v_lshrrev_b32 v2, 3, v0
    v_and_b32 v198, 6, v2
    v_and_b32 v196, 7, v0
    v_xor_b32 v198, v198, v196
    v_lshlrev_b32 v198, 4, v198
    s_lshl_b32 s16, s3, 3
    v_add_u32 v2, s16, v2
    v_mul_u32_u24 v2, 9216, v2
    v_add_u32 v2, v2, v198
    s_add_u32 s44, s44, 589824
    s_sub_u32 s13, 3, s11
    s_and_b32 s13, s13, 7
    s_cselect_b32 s13, s13, 8
    s_lshl_b32 s14, s12, 1
    s_add_u32 s14, s14, 1
    s_cmp_eq_u32 s14, s13
    s_cselect_b32 s37, 128, 0
    s_add_u32 s37, s37, 4289953920
    s_mul_i32 s13, s11, 9
    s_lshl_b32 s14, s12, 1
    s_add_u32 s14, s14, s13
    s_mul_i32 s41, s15, 147456
    s_add_u32 s41, s41, 12582912
    s_lshl_b32 s16, s14, 11
    s_add_u32 s42, s41, s16
    s_lshl_b32 s43, s15, 14
    s_lshl_b32 s16, s11, 2
    s_add_u32 s16, s16, s12
    s_lshl_b32 s18, s16, 10
    s_add_u32 s43, s43, s18
    s_add_u32 s43, s43, 31457280
    s_lshl_b32 s47, s3, 10
    s_mul_i32 s45, s16, 36864
    s_add_u32 s45, s45, s47
    s_add_u32 s45, s45, 39845888
    s_lshl_b32 s16, s15, 1
    s_add_u32 s16, s16, s11
    s_lshl_b32 s16, s16, 2
    s_add_u32 s16, s16, s12
    s_lshl_b32 s16, s16, 7
    s_add_u32 s60, s16, 50593792
    s_mov_b32 s66, 0
    s_mov_b32 s67, 131072
    s_mov_b32 s68, 262144
    s_mov_b32 s69, s15
    v_lshrrev_b32 v5, 2, v0
    v_lshrrev_b32 v3, 3, v0
    v_and_b32 v3, 2, v3
    v_and_b32 v4, 3, v0
    v_xor_b32 v3, v3, v4
    v_lshlrev_b32 v3, 4, v3
    s_lshl_b32 s16, s3, 4
    v_add_u32 v5, s16, v5
    v_mul_u32_u24 v5, 9216, v5
    v_add_u32 v5, v5, v3
    v_bfe_u32 v224, v0, 2, 3
    v_lshlrev_b32 v224, 7, v224
    v_and_b32 v225, 3, v0
    v_lshl_add_u32 v224, v225, 3, v224
    v_lshrrev_b32 v225, 5, v0
    v_lshl_add_u32 v224, v225, 11, v224
    v_add_u32 v224, 106496, v224
    v_bfe_u32 v225, v0, 3, 2
    v_xor_b32 v3, 0, v225
    v_lshl_add_u32 v3, v3, 5, v224
    v_xor_b32 v4, 1, v225
    v_lshl_add_u32 v4, v4, 5, v224
    v_xor_b32 v6, 2, v225
    v_lshl_add_u32 v6, v6, 5, v224
    v_xor_b32 v7, 3, v225
    v_lshl_add_u32 v7, v7, 5, v224
    s_and_b32 s16, s2, 6
    s_lshl_b32 s16, s16, 4
    v_and_b32 v194, 15, v0
    v_min_u32 v194, 13, v194
    v_and_or_b32 v192, v0, 16, v194
    v_add_u32 v192, s16, v192
    v_lshlrev_b32 v192, 7, v192
    s_mov_b32 s61, 51183616
    s_bfe_u32 s10, s2, 0x20001
    s_and_b32 s11, s2, 1
    s_lshl_b32 s11, s11, 3
    s_lshr_b32 s16, s2, 5
    s_add_u32 s11, s11, s16
    s_lshl_b32 s13, s11, 3
    s_lshl_b32 s16, s3, 1
    s_add_u32 s13, s13, s16
    s_mul_i32 s48, s13, 147456
    s_mul_i32 s16, s10, 36864
    s_add_u32 s48, s48, s16
    s_add_u32 s48, s48, 12582912
    s_lshl_b32 s7, s13, 14
    s_lshl_b32 s16, s10, 13
    s_add_u32 s7, s7, s16
    s_add_u32 s7, s7, 31457280
    s_lshl_b32 s41, s10, 2
    s_add_u32 s41, s41, s12
    s_mul_i32 s41, s41, 331776
    s_add_u32 s41, s41, s47
    s_add_u32 s41, s41, 33554432
    s_mul_i32 s14, s12, 144
    s_lshl_b32 s16, s10, 5
    s_add_u32 s15, s14, s16
    s_add_u32 s14, s14, 128
    s_mul_i32 s62, s13, 18432
    s_add_u32 s51, s62, 3670016
    s_lshr_b32 s50, s15, 4
    s_lshr_b32 s16, s14, 5
    s_lshl_b32 s16, s16, 10
    s_add_u32 s52, s51, s16
    s_bfe_u32 s16, s14, 0x10004
    s_lshl_b32 s16, s16, 3
    s_add_u32 s52, s52, s16
    s_lshl_b32 s63, s11, 2
    s_add_u32 s63, s63, s12
    s_lshl_b32 s63, s63, 2
    s_mul_i32 s17, s3, 6144
    s_add_u32 s16, s10, 1
    s_and_b32 s16, s16, 3
    s_add_u32 s16, s16, s63
    s_mul_i32 s16, s16, 24576
    s_add_u32 s16, s16, s17
    s_add_u32 s53, s16, 41943040
    s_add_u32 s16, s10, 2
    s_and_b32 s16, s16, 3
    s_add_u32 s16, s16, s63
    s_mul_i32 s16, s16, 24576
    s_add_u32 s16, s16, s17
    s_add_u32 s54, s16, 41945088
    s_add_u32 s16, s10, 3
    s_and_b32 s16, s16, 3
    s_add_u32 s16, s16, s63
    s_mul_i32 s16, s16, 24576
    s_add_u32 s16, s16, s17
    s_add_u32 s55, s16, 41947136
    s_add_u32 s16, s63, s3
    s_lshl_b32 s16, s16, 12
    s_lshl_b32 s18, s10, 10
    s_add_u32 s16, s16, s18
    s_add_u32 s56, s16, 49283072
    s_add_u32 s18, s63, s10
    s_mul_i32 s57, s18, 24576
    s_add_u32 s57, s57, s17
    s_add_u32 s57, s57, 41943040
    s_lshl_b32 s58, s18, 12
    s_add_u32 s58, s58, 49283072
    s_lshl_b32 s16, s18, 9
    s_lshl_b32 s64, s3, 7
    s_add_u32 s16, s16, s64
    s_add_u32 s59, s16, 50331648
    s_lshr_b32 s16, s13, 2
    s_lshl_b32 s16, s16, 2
    s_add_u32 s16, s16, s10
    s_lshl_b32 s16, s16, 10
    s_add_u32 s4, s16, 50593792
    s_lshl_b32 s5, s15, 2
    s_add_u32 s5, s5, 11520
    s_lshl_b32 s6, s14, 2
    s_add_u32 s6, s6, 11520
    s_mul_i32 s16, s3, 5
    s_min_u32 s16, s16, 14
    s_lshl_b32 s16, s16, 10
    s_mul_i32 s17, s2, 18432
    s_add_u32 s16, s16, s17
    s_add_u32 s16, s16, 3670016
    s_cmp_lt_u32 s2, 128
    s_cselect_b32 s38, s16, s30
    s_add_u32 s16, s38, 4096
    s_cmp_lt_u32 s3, 2
    s_cselect_b32 s39, s16, s30
    s_lshl_b32 s16, s2, 9
    s_lshl_b32 s17, s3, 7
    s_add_u32 s16, s16, s17
    s_add_u32 s65, s16, 51249152
    s_lshl_b32 s16, s2, 7
    s_add_u32 s17, s16, 51904512
    v_lshlrev_b32 v197, 2, v0
    v_and_b32 v197, 124, v197
    v_mov_b32 v220, s8
    v_mov_b32 v221, s8
    v_mov_b32 v222, s8
    v_mov_b32 v223, s8
    s_cmp_eq_u32 s3, 0
    s_cselect_b32 s17, s17, s30
    s_waitcnt vmcnt(0)
    v_cmp_ne_u32 vcc, s8, v193
    s_nop 1
    s_cbranch_vccz H2E_OK
    s_mov_b32 s16, 0
H2E_POLL:
    buffer_load_dword v193, v195, s[28:31], s19 offen sc1
    s_add_u32 s16, s16, 1
    s_waitcnt vmcnt(0)
    v_cmp_ne_u32 vcc, s8, v193
    s_cmp_ge_u32 s16, 60000
    s_cbranch_scc1 H2E_POLL_X
    s_and_b64 vcc, vcc, exec
    s_cbranch_scc0 H2E_POLL_X
    s_mov_b64 exec, vcc
    s_sleep 1
    s_branch H2E_POLL
H2E_POLL_X:
    s_mov_b64 exec, -1
H2E_OK:
    buffer_load_dwordx4 v[8:11], v1, s[28:31], s40 offen offset:0 sc1
    buffer_load_dwordx4 v[12:15], v226, s[28:31], s40 offen offset:0 sc1
    buffer_load_dwordx4 v[16:19], v227, s[28:31], s40 offen offset:0 sc1
    buffer_load_dwordx4 v[20:23], v228, s[28:31], s40 offen offset:0 sc1
    buffer_load_dwordx4 v[24:27], v1, s[28:31], s40 offen offset:1024 sc1
    buffer_load_dwordx4 v[28:31], v226, s[28:31], s40 offen offset:1024 sc1
    buffer_load_dwordx4 v[32:35], v227, s[28:31], s40 offen offset:1024 sc1
    buffer_load_dwordx4 v[36:39], v228, s[28:31], s40 offen offset:1024 sc1
    buffer_load_dwordx4 a[0:3], v1, s[28:31], s40 offen offset:2048 sc1
    buffer_load_dwordx4 a[4:7], v226, s[28:31], s40 offen offset:2048 sc1
    buffer_load_dwordx4 a[8:11], v227, s[28:31], s40 offen offset:2048 sc1
    buffer_load_dwordx4 a[12:15], v228, s[28:31], s40 offen offset:2048 sc1
    s_barrier
    buffer_store_dword v220, v197, s[28:31], s17 offen sc1
    ds_read_b64_tr_b16 v[40:41], v3 offset:0
    ds_read_b64_tr_b16 v[42:43], v3 offset:4096
    ds_read_b64_tr_b16 v[44:45], v3 offset:1024
    ds_read_b64_tr_b16 v[46:47], v3 offset:5120
    ds_read_b64_tr_b16 v[48:49], v4 offset:0
    ds_read_b64_tr_b16 v[50:51], v4 offset:4096
    ds_read_b64_tr_b16 v[52:53], v4 offset:1024
    ds_read_b64_tr_b16 v[54:55], v4 offset:5120
    ds_read_b64_tr_b16 v[56:57], v6 offset:0
    ds_read_b64_tr_b16 v[58:59], v6 offset:4096
    s_waitcnt vmcnt(9)
    v_max3_u32 v196, v8, v9, v10
    v_max3_u32 v194, v11, v12, v13
    v_max3_u32 v194, v194, v14, v15
    s_add_u32 s44, s44, 294912
    s_add_u32 m0, s46, 0
    s_nop 0
    buffer_load_dwordx4 v2, s[20:23], s44 offen lds
    v_max3_u32 v196, v196, v16, v17
    v_max3_u32 v194, v194, v18, v19
    buffer_load_dwordx4 v2, s[24:27], s44 offen offset:1024 lds
    v_max3_u32 v196, v196, v20, v21
    v_max3_u32 v194, v194, v22, v23
    v_max_u32 v196, v196, v194
    v_cmp_eq_u32 vcc, -1, v196
    s_nop 1
    s_cbranch_vccnz HV_SLOW0
HV_RET0:
    .p2align 3
    s_waitcnt lgkmcnt(8)
    v_mfma_f32_16x16x32_bf16 v[64:67], v[40:43], v[8:11], 0
    ds_read_b64_tr_b16 v[60:61], v6 offset:1024
    v_mfma_f32_16x16x32_bf16 v[68:71], v[40:43], v[12:15], 0
    ds_read_b64_tr_b16 v[62:63], v6 offset:5120
    v_mfma_f32_16x16x32_bf16 v[72:75], v[40:43], v[16:19], 0
    buffer_load_dwordx4 a[16:19], v1, s[28:31], s40 offen offset:3072 sc1
    v_mfma_f32_16x16x32_bf16 v[76:79], v[40:43], v[20:23], 0
    s_waitcnt lgkmcnt(8)
    v_mfma_f32_16x16x32_bf16 v[80:83], v[44:47], v[8:11], 0
    ds_read_b64_tr_b16 v[40:41], v7 offset:0
    v_mfma_f32_16x16x32_bf16 v[84:87], v[44:47], v[12:15], 0
    ds_read_b64_tr_b16 v[42:43], v7 offset:4096
    v_mfma_f32_16x16x32_bf16 v[88:91], v[44:47], v[16:19], 0
    buffer_load_dwordx4 a[20:23], v226, s[28:31], s40 offen offset:3072 sc1
    v_mfma_f32_16x16x32_bf16 v[92:95], v[44:47], v[20:23], 0
    s_waitcnt lgkmcnt(8)
    v_mfma_f32_16x16x32_bf16 v[96:99], v[48:51], v[8:11], 0
    ds_read_b64_tr_b16 v[44:45], v7 offset:1024
    v_mfma_f32_16x16x32_bf16 v[100:103], v[48:51], v[12:15], 0
    ds_read_b64_tr_b16 v[46:47], v7 offset:5120
    v_mfma_f32_16x16x32_bf16 v[104:107], v[48:51], v[16:19], 0
    buffer_load_dwordx4 a[24:27], v227, s[28:31], s40 offen offset:3072 sc1
    v_mfma_f32_16x16x32_bf16 v[108:111], v[48:51], v[20:23], 0
    s_waitcnt lgkmcnt(8)
    v_mfma_f32_16x16x32_bf16 v[112:115], v[52:55], v[8:11], 0
    ds_read_b64_tr_b16 v[48:49], v3 offset:8192
    s_waitcnt vmcnt(10)
    v_mfma_f32_16x16x32_bf16 v[116:119], v[52:55], v[12:15], 0
    ds_read_b64_tr_b16 v[50:51], v3 offset:12288
    v_max_u32 v238, v24, v25
    v_mfma_f32_16x16x32_bf16 v[120:123], v[52:55], v[16:19], 0
    buffer_load_dwordx4 a[28:31], v228, s[28:31], s40 offen offset:3072 sc1
    v_mfma_f32_16x16x32_bf16 v[124:127], v[52:55], v[20:23], 0
    s_waitcnt lgkmcnt(8)
    s_add_u32 s44, s44, 294912
    s_add_u32 m0, s46, 8192
    v_mfma_f32_16x16x32_bf16 v[128:131], v[56:59], v[8:11], 0
    ds_read_b64_tr_b16 v[52:53], v3 offset:9216
    v_max3_u32 v238, v238, v26, v27
    v_mfma_f32_16x16x32_bf16 v[132:135], v[56:59], v[12:15], 0
    ds_read_b64_tr_b16 v[54:55], v3 offset:13312
    v_max3_u32 v238, v238, v28, v29
    v_mfma_f32_16x16x32_bf16 v[136:139], v[56:59], v[16:19], 0
    buffer_load_dwordx4 v2, s[20:23], s44 offen lds
    v_mfma_f32_16x16x32_bf16 v[140:143], v[56:59], v[20:23], 0
    s_waitcnt lgkmcnt(8)
    v_max3_u32 v238, v238, v30, v31
    v_max3_u32 v238, v238, v32, v33
    v_mfma_f32_16x16x32_bf16 v[144:147], v[60:63], v[8:11], 0
    ds_read_b64_tr_b16 v[56:57], v4 offset:8192
    v_max3_u32 v238, v238, v34, v35
    v_mfma_f32_16x16x32_bf16 v[148:151], v[60:63], v[12:15], 0
    ds_read_b64_tr_b16 v[58:59], v4 offset:12288
    v_max3_u32 v238, v238, v36, v37
    v_mfma_f32_16x16x32_bf16 v[152:155], v[60:63], v[16:19], 0
    buffer_load_dwordx4 v2, s[24:27], s44 offen offset:1024 lds
    v_mfma_f32_16x16x32_bf16 v[156:159], v[60:63], v[20:23], 0
    s_waitcnt lgkmcnt(8)
    s_add_u32 s40, s40, 4096
    v_max3_u32 v238, v238, v38, v39
    v_mfma_f32_16x16x32_bf16 v[160:163], v[40:43], v[8:11], 0
    ds_read_b64_tr_b16 v[60:61], v4 offset:9216
    v_cmp_eq_u32 vcc, -1, v238
    s_nop 0
    s_cbranch_vccnz HV_SLOW1
HV_RET1:
    v_mfma_f32_16x16x32_bf16 v[164:167], v[40:43], v[12:15], 0
    ds_read_b64_tr_b16 v[62:63], v4 offset:13312
    s_waitcnt vmcnt(9)
    v_mfma_f32_16x16x32_bf16 v[168:171], v[40:43], v[16:19], 0
    buffer_load_dwordx4 a[32:35], v1, s[28:31], s40 offen offset:0 sc1
    v_mfma_f32_16x16x32_bf16 v[172:175], v[40:43], v[20:23], 0
    s_waitcnt lgkmcnt(8)
    v_accvgpr_read_b32 v236, a0
    v_accvgpr_read_b32 v237, a1
    v_mfma_f32_16x16x32_bf16 v[176:179], v[44:47], v[8:11], 0
    ds_read_b64_tr_b16 v[40:41], v6 offset:8192
    v_max_u32 v238, v236, v237
    v_mfma_f32_16x16x32_bf16 v[180:183], v[44:47], v[12:15], 0
    ds_read_b64_tr_b16 v[42:43], v6 offset:12288
    v_accvgpr_read_b32 v236, a2
    v_mfma_f32_16x16x32_bf16 v[184:187], v[44:47], v[16:19], 0
    buffer_load_dwordx4 a[36:39], v226, s[28:31], s40 offen offset:0 sc1
    v_mfma_f32_16x16x32_bf16 v[188:191], v[44:47], v[20:23], 0
    s_waitcnt lgkmcnt(8)
    v_accvgpr_read_b32 v237, a3
    v_max3_u32 v238, v238, v236, v237
    v_mfma_f32_16x16x32_bf16 v[64:67], v[48:51], v[24:27], v[64:67]
    ds_read_b64_tr_b16 v[44:45], v6 offset:9216
    v_accvgpr_read_b32 v236, a4
    v_mfma_f32_16x16x32_bf16 v[68:71], v[48:51], v[28:31], v[68:71]
    ds_read_b64_tr_b16 v[46:47], v6 offset:13312
    v_accvgpr_read_b32 v237, a5
    v_mfma_f32_16x16x32_bf16 v[72:75], v[48:51], v[32:35], v[72:75]
    buffer_load_dwordx4 a[40:43], v227, s[28:31], s40 offen offset:0 sc1
    v_mfma_f32_16x16x32_bf16 v[76:79], v[48:51], v[36:39], v[76:79]
    s_waitcnt lgkmcnt(8)
    v_max3_u32 v238, v238, v236, v237
    v_accvgpr_read_b32 v236, a6
    v_mfma_f32_16x16x32_bf16 v[80:83], v[52:55], v[24:27], v[80:83]
    ds_read_b64_tr_b16 v[48:49], v7 offset:8192
    v_accvgpr_read_b32 v237, a7
    v_mfma_f32_16x16x32_bf16 v[84:87], v[52:55], v[28:31], v[84:87]
    ds_read_b64_tr_b16 v[50:51], v7 offset:12288
    v_max3_u32 v238, v238, v236, v237
    v_mfma_f32_16x16x32_bf16 v[88:91], v[52:55], v[32:35], v[88:91]
    buffer_load_dwordx4 a[44:47], v228, s[28:31], s40 offen offset:0 sc1
    v_mfma_f32_16x16x32_bf16 v[92:95], v[52:55], v[36:39], v[92:95]
    s_waitcnt lgkmcnt(8)
    s_add_u32 s44, s44, 294912
    s_add_u32 m0, s46, 16384
    v_mfma_f32_16x16x32_bf16 v[96:99], v[56:59], v[24:27], v[96:99]
    ds_read_b64_tr_b16 v[52:53], v7 offset:9216
    v_accvgpr_read_b32 v236, a8
    v_mfma_f32_16x16x32_bf16 v[100:103], v[56:59], v[28:31], v[100:103]
    ds_read_b64_tr_b16 v[54:55], v7 offset:13312
    v_accvgpr_read_b32 v237, a9
    v_mfma_f32_16x16x32_bf16 v[104:107], v[56:59], v[32:35], v[104:107]
    buffer_load_dwordx4 v2, s[20:23], s44 offen lds
    v_mfma_f32_16x16x32_bf16 v[108:111], v[56:59], v[36:39], v[108:111]
    s_waitcnt lgkmcnt(8)
    v_max3_u32 v238, v238, v236, v237
    v_accvgpr_read_b32 v236, a10
    v_mfma_f32_16x16x32_bf16 v[112:115], v[60:63], v[24:27], v[112:115]
    ds_read_b64_tr_b16 v[56:57], v3 offset:16384
    v_accvgpr_read_b32 v237, a11
    v_mfma_f32_16x16x32_bf16 v[116:119], v[60:63], v[28:31], v[116:119]
    ds_read_b64_tr_b16 v[58:59], v3 offset:20480
    v_max3_u32 v238, v238, v236, v237
    v_mfma_f32_16x16x32_bf16 v[120:123], v[60:63], v[32:35], v[120:123]
    buffer_load_dwordx4 v2, s[24:27], s44 offen offset:1024 lds
    v_mfma_f32_16x16x32_bf16 v[124:127], v[60:63], v[36:39], v[124:127]
    s_waitcnt lgkmcnt(8)
    v_accvgpr_read_b32 v236, a12
    v_accvgpr_read_b32 v237, a13
    v_mfma_f32_16x16x32_bf16 v[128:131], v[40:43], v[24:27], v[128:131]
    ds_read_b64_tr_b16 v[60:61], v3 offset:17408
    v_max3_u32 v238, v238, v236, v237
    v_mfma_f32_16x16x32_bf16 v[132:135], v[40:43], v[28:31], v[132:135]
    ds_read_b64_tr_b16 v[62:63], v3 offset:21504
    v_accvgpr_read_b32 v236, a14
    v_mfma_f32_16x16x32_bf16 v[136:139], v[40:43], v[32:35], v[136:139]
    buffer_load_dword v193, v195, s[28:31], s9 offen sc1
    v_mfma_f32_16x16x32_bf16 v[140:143], v[40:43], v[36:39], v[140:143]
    s_waitcnt lgkmcnt(8)
    s_add_u32 s44, s44, 294912
    s_add_u32 m0, s46, 24576
    v_mfma_f32_16x16x32_bf16 v[144:147], v[44:47], v[24:27], v[144:147]
    ds_read_b64_tr_b16 v[40:41], v4 offset:16384
    v_accvgpr_read_b32 v237, a15
    v_mfma_f32_16x16x32_bf16 v[148:151], v[44:47], v[28:31], v[148:151]
    ds_read_b64_tr_b16 v[42:43], v4 offset:20480
    v_max3_u32 v238, v238, v236, v237
    v_mfma_f32_16x16x32_bf16 v[152:155], v[44:47], v[32:35], v[152:155]
    buffer_load_dwordx4 v2, s[20:23], s44 offen lds
    v_mfma_f32_16x16x32_bf16 v[156:159], v[44:47], v[36:39], v[156:159]
    s_waitcnt lgkmcnt(8)
    v_cmp_eq_u32 vcc, -1, v238
    s_nop 0
    s_cbranch_vccnz HV_SLOW2
HV_RET2:
    v_mfma_f32_16x16x32_bf16 v[160:163], v[48:51], v[24:27], v[160:163]
    ds_read_b64_tr_b16 v[44:45], v4 offset:17408
    s_waitcnt vmcnt(10)
    v_mfma_f32_16x16x32_bf16 v[164:167], v[48:51], v[28:31], v[164:167]
    ds_read_b64_tr_b16 v[46:47], v4 offset:21504
    v_accvgpr_read_b32 v236, a16
    v_mfma_f32_16x16x32_bf16 v[168:171], v[48:51], v[32:35], v[168:171]
    buffer_load_dwordx4 v2, s[24:27], s44 offen offset:1024 lds
    v_mfma_f32_16x16x32_bf16 v[172:175], v[48:51], v[36:39], v[172:175]
    s_waitcnt lgkmcnt(8)
    s_add_u32 s44, s44, 294912
    s_add_u32 m0, s46, 32768
    v_mfma_f32_16x16x32_bf16 v[176:179], v[52:55], v[24:27], v[176:179]
    ds_read_b64_tr_b16 v[48:49], v6 offset:16384
    v_accvgpr_read_b32 v237, a17
    v_mfma_f32_16x16x32_bf16 v[180:183], v[52:55], v[28:31], v[180:183]
    ds_read_b64_tr_b16 v[50:51], v6 offset:20480
    v_max_u32 v238, v236, v237
    v_mfma_f32_16x16x32_bf16 v[184:187], v[52:55], v[32:35], v[184:187]
    buffer_load_dwordx4 v2, s[20:23], s44 offen lds
    v_mfma_f32_16x16x32_bf16 v[188:191], v[52:55], v[36:39], v[188:191]
    s_waitcnt lgkmcnt(8)
    v_accvgpr_read_b32 v236, a18
    v_accvgpr_read_b32 v237, a19
    v_mfma_f32_16x16x32_bf16 v[64:67], v[56:59], a[0:3], v[64:67]
    ds_read_b64_tr_b16 v[52:53], v6 offset:17408
    v_max3_u32 v238, v238, v236, v237
    v_mfma_f32_16x16x32_bf16 v[68:71], v[56:59], a[4:7], v[68:71]
    ds_read_b64_tr_b16 v[54:55], v6 offset:21504
    v_accvgpr_read_b32 v236, a20
    v_mfma_f32_16x16x32_bf16 v[72:75], v[56:59], a[8:11], v[72:75]
    v_accvgpr_read_b32 v237, a21
    v_max3_u32 v238, v238, v236, v237
    v_mfma_f32_16x16x32_bf16 v[76:79], v[56:59], a[12:15], v[76:79]
    s_waitcnt lgkmcnt(8)
    v_accvgpr_read_b32 v236, a22
    v_accvgpr_read_b32 v237, a23
    v_mfma_f32_16x16x32_bf16 v[80:83], v[60:63], a[0:3], v[80:83]
    ds_read_b64_tr_b16 v[56:57], v7 offset:16384
    v_max3_u32 v238, v238, v236, v237
    v_mfma_f32_16x16x32_bf16 v[84:87], v[60:63], a[4:7], v[84:87]
    ds_read_b64_tr_b16 v[58:59], v7 offset:20480
    v_accvgpr_read_b32 v236, a24
    v_mfma_f32_16x16x32_bf16 v[88:91], v[60:63], a[8:11], v[88:91]
    buffer_load_dwordx4 v2, s[24:27], s44 offen offset:1024 lds
    v_mfma_f32_16x16x32_bf16 v[92:95], v[60:63], a[12:15], v[92:95]
    s_waitcnt lgkmcnt(8)
    s_add_u32 s44, s44, 294912
    s_add_u32 m0, s46, 40960
    v_mfma_f32_16x16x32_bf16 v[96:99], v[40:43], a[0:3], v[96:99]
    ds_read_b64_tr_b16 v[60:61], v7 offset:17408
    v_accvgpr_read_b32 v237, a25
    v_mfma_f32_16x16x32_bf16 v[100:103], v[40:43], a[4:7], v[100:103]
    ds_read_b64_tr_b16 v[62:63], v7 offset:21504
    v_max3_u32 v238, v238, v236, v237
    v_mfma_f32_16x16x32_bf16 v[104:107], v[40:43], a[8:11], v[104:107]
    buffer_load_dwordx4 v2, s[20:23], s44 offen lds
    v_mfma_f32_16x16x32_bf16 v[108:111], v[40:43], a[12:15], v[108:111]
    s_waitcnt lgkmcnt(8)
    s_barrier
    v_accvgpr_read_b32 v236, a26
    v_mfma_f32_16x16x32_bf16 v[112:115], v[44:47], a[0:3], v[112:115]
    v_add_u32 v3, 4294860800, v3
    v_accvgpr_read_b32 v237, a27
    v_mfma_f32_16x16x32_bf16 v[116:119], v[44:47], a[4:7], v[116:119]
    ds_read_b64_tr_b16 v[40:41], v3 offset:0
    v_max3_u32 v238, v238, v236, v237
    v_mfma_f32_16x16x32_bf16 v[120:123], v[44:47], a[8:11], v[120:123]
    ds_read_b64_tr_b16 v[42:43], v3 offset:4096
    v_accvgpr_read_b32 v236, a28
    v_mfma_f32_16x16x32_bf16 v[124:127], v[44:47], a[12:15], v[124:127]
    s_waitcnt lgkmcnt(8)
    buffer_load_dwordx4 v2, s[24:27], s44 offen offset:1024 lds
    v_mfma_f32_16x16x32_bf16 v[128:131], v[48:51], a[0:3], v[128:131]
    ds_read_b64_tr_b16 v[44:45], v3 offset:1024
    s_add_u32 s44, s44, 294912
    v_mfma_f32_16x16x32_bf16 v[132:135], v[48:51], a[4:7], v[132:135]
    ds_read_b64_tr_b16 v[46:47], v3 offset:5120
    s_add_u32 m0, s46, 49152
    v_mfma_f32_16x16x32_bf16 v[136:139], v[48:51], a[8:11], v[136:139]
    buffer_load_dwordx4 v2, s[20:23], s44 offen lds
    v_mfma_f32_16x16x32_bf16 v[140:143], v[48:51], a[12:15], v[140:143]
    s_waitcnt lgkmcnt(8)
    v_accvgpr_read_b32 v237, a29
    v_max3_u32 v238, v238, v236, v237
    v_mfma_f32_16x16x32_bf16 v[144:147], v[52:55], a[0:3], v[144:147]
    v_add_u32 v4, 4294860800, v4
    v_accvgpr_read_b32 v236, a30
    v_mfma_f32_16x16x32_bf16 v[148:151], v[52:55], a[4:7], v[148:151]
    ds_read_b64_tr_b16 v[48:49], v4 offset:0
    v_accvgpr_read_b32 v237, a31
    v_mfma_f32_16x16x32_bf16 v[152:155], v[52:55], a[8:11], v[152:155]
    ds_read_b64_tr_b16 v[50:51], v4 offset:4096
    v_max3_u32 v238, v238, v236, v237
    v_mfma_f32_16x16x32_bf16 v[156:159], v[52:55], a[12:15], v[156:159]
    s_waitcnt lgkmcnt(8)
    v_cmp_eq_u32 vcc, -1, v238
    s_nop 0
    s_cbranch_vccnz HV_SLOW3
HV_RET3:
    v_mfma_f32_16x16x32_bf16 v[160:163], v[56:59], a[0:3], v[160:163]
    ds_read_b64_tr_b16 v[52:53], v4 offset:1024
    s_waitcnt vmcnt(10)
    v_mfma_f32_16x16x32_bf16 v[164:167], v[56:59], a[4:7], v[164:167]
    ds_read_b64_tr_b16 v[54:55], v4 offset:5120
    v_accvgpr_read_b32 v236, a32
    v_mfma_f32_16x16x32_bf16 v[168:171], v[56:59], a[8:11], v[168:171]
    buffer_load_dwordx4 v2, s[24:27], s44 offen offset:1024 lds
    v_mfma_f32_16x16x32_bf16 v[172:175], v[56:59], a[12:15], v[172:175]
    s_waitcnt lgkmcnt(8)
    s_add_u32 s44, s44, 294912
    s_add_u32 m0, s46, 57344
    v_mfma_f32_16x16x32_bf16 v[176:179], v[60:63], a[0:3], v[176:179]
    v_add_u32 v6, 4294860800, v6
    v_accvgpr_read_b32 v237, a33
    v_mfma_f32_16x16x32_bf16 v[180:183], v[60:63], a[4:7], v[180:183]
    ds_read_b64_tr_b16 v[56:57], v6 offset:0
    v_max_u32 v238, v236, v237
    v_mfma_f32_16x16x32_bf16 v[184:187], v[60:63], a[8:11], v[184:187]
    ds_read_b64_tr_b16 v[58:59], v6 offset:4096
    v_accvgpr_read_b32 v236, a34
    v_mfma_f32_16x16x32_bf16 v[188:191], v[60:63], a[12:15], v[188:191]
    s_waitcnt lgkmcnt(8)
    buffer_load_dwordx4 v2, s[20:23], s44 offen lds
    v_mfma_f32_16x16x32_bf16 v[64:67], v[40:43], a[16:19], v[64:67]
    ds_read_b64_tr_b16 v[60:61], v6 offset:1024
    v_accvgpr_read_b32 v237, a35
    v_mfma_f32_16x16x32_bf16 v[68:71], v[40:43], a[20:23], v[68:71]
    ds_read_b64_tr_b16 v[62:63], v6 offset:5120
    v_max3_u32 v238, v238, v236, v237
    v_mfma_f32_16x16x32_bf16 v[72:75], v[40:43], a[24:27], v[72:75]
    buffer_load_dwordx4 v2, s[24:27], s44 offen offset:1024 lds
    v_mfma_f32_16x16x32_bf16 v[76:79], v[40:43], a[28:31], v[76:79]
    s_waitcnt lgkmcnt(8)
    s_waitcnt vmcnt(10)
    v_cmp_ne_u32 vcc, s8, v193
    s_nop 0
    s_cbranch_vccnz K4_SLOW0
K4_RET0:
    v_mfma_f32_16x16x32_bf16 v[80:83], v[44:47], a[16:19], v[80:83]
    s_sub_u32 s40, s40, 3145728
    v_add_u32 v7, 4294860800, v7
    v_accvgpr_read_b32 v236, a36
    v_mfma_f32_16x16x32_bf16 v[84:87], v[44:47], a[20:23], v[84:87]
    ds_read_b64_tr_b16 v[40:41], v7 offset:0
    v_accvgpr_read_b32 v237, a37
    v_mfma_f32_16x16x32_bf16 v[88:91], v[44:47], a[24:27], v[88:91]
    ds_read_b64_tr_b16 v[42:43], v7 offset:4096
    v_max3_u32 v238, v238, v236, v237
    v_mfma_f32_16x16x32_bf16 v[92:95], v[44:47], a[28:31], v[92:95]
    s_waitcnt lgkmcnt(8)
    v_accvgpr_read_b32 v236, a38
    v_accvgpr_read_b32 v237, a39
    v_mfma_f32_16x16x32_bf16 v[96:99], v[48:51], a[16:19], v[96:99]
    ds_read_b64_tr_b16 v[44:45], v7 offset:1024
    v_max3_u32 v238, v238, v236, v237
    v_mfma_f32_16x16x32_bf16 v[100:103], v[48:51], a[20:23], v[100:103]
    ds_read_b64_tr_b16 v[46:47], v7 offset:5120
    v_accvgpr_read_b32 v236, a40
    v_mfma_f32_16x16x32_bf16 v[104:107], v[48:51], a[24:27], v[104:107]
    buffer_load_dwordx4 a[48:51], v1, s[28:31], s40 offen offset:1024 sc1
    v_mfma_f32_16x16x32_bf16 v[108:111], v[48:51], a[28:31], v[108:111]
    s_waitcnt lgkmcnt(8)
    s_barrier
    v_accvgpr_read_b32 v237, a41
    v_mfma_f32_16x16x32_bf16 v[112:115], v[52:55], a[16:19], v[112:115]
    ds_read_b64_tr_b16 v[48:49], v3 offset:8192
    v_max3_u32 v238, v238, v236, v237
    v_mfma_f32_16x16x32_bf16 v[116:119], v[52:55], a[20:23], v[116:119]
    ds_read_b64_tr_b16 v[50:51], v3 offset:12288
    v_accvgpr_read_b32 v236, a42
    v_mfma_f32_16x16x32_bf16 v[120:123], v[52:55], a[24:27], v[120:123]
    buffer_load_dwordx4 a[52:55], v226, s[28:31], s40 offen offset:1024 sc1
    v_mfma_f32_16x16x32_bf16 v[124:127], v[52:55], a[28:31], v[124:127]
    s_waitcnt lgkmcnt(8)
    v_accvgpr_read_b32 v237, a43
    v_max3_u32 v238, v238, v236, v237
    v_mfma_f32_16x16x32_bf16 v[128:131], v[56:59], a[16:19], v[128:131]
    ds_read_b64_tr_b16 v[52:53], v3 offset:9216
    v_accvgpr_read_b32 v236, a44
    v_mfma_f32_16x16x32_bf16 v[132:135], v[56:59], a[20:23], v[132:135]
    ds_read_b64_tr_b16 v[54:55], v3 offset:13312
    v_accvgpr_read_b32 v237, a45
    v_mfma_f32_16x16x32_bf16 v[136:139], v[56:59], a[24:27], v[136:139]
    buffer_load_dwordx4 a[56:59], v227, s[28:31], s40 offen offset:1024 sc1
    v_mfma_f32_16x16x32_bf16 v[140:143], v[56:59], a[28:31], v[140:143]
    s_waitcnt lgkmcnt(8)
    v_max3_u32 v238, v238, v236, v237
    v_accvgpr_read_b32 v236, a46
    v_mfma_f32_16x16x32_bf16 v[144:147], v[60:63], a[16:19], v[144:147]
    ds_read_b64_tr_b16 v[56:57], v4 offset:8192
    v_accvgpr_read_b32 v237, a47
    v_mfma_f32_16x16x32_bf16 v[148:151], v[60:63], a[20:23], v[148:151]
    ds_read_b64_tr_b16 v[58:59], v4 offset:12288
    v_max3_u32 v238, v238, v236, v237
    v_mfma_f32_16x16x32_bf16 v[152:155], v[60:63], a[24:27], v[152:155]
    buffer_load_dwordx4 a[60:63], v228, s[28:31], s40 offen offset:1024 sc1
    v_mfma_f32_16x16x32_bf16 v[156:159], v[60:63], a[28:31], v[156:159]
    s_waitcnt lgkmcnt(8)
    v_cmp_eq_u32 vcc, -1, v238
    s_nop 0
    s_cbranch_vccnz HV_SLOW4
HV_RET4:
    v_mfma_f32_16x16x32_bf16 v[160:163], v[40:43], a[16:19], v[160:163]
    ds_read_b64_tr_b16 v[60:61], v4 offset:9216
    v_mfma_f32_16x16x32_bf16 v[164:167], v[40:43], a[20:23], v[164:167]
    ds_read_b64_tr_b16 v[62:63], v4 offset:13312
    v_mfma_f32_16x16x32_bf16 v[168:171], v[40:43], a[24:27], v[168:171]
    buffer_load_dwordx4 a[64:67], v1, s[28:31], s40 offen offset:2048 sc1
    v_mfma_f32_16x16x32_bf16 v[172:175], v[40:43], a[28:31], v[172:175]
    s_waitcnt lgkmcnt(8)
    v_mfma_f32_16x16x32_bf16 v[176:179], v[44:47], a[16:19], v[176:179]
    ds_read_b64_tr_b16 v[40:41], v6 offset:8192
    v_mfma_f32_16x16x32_bf16 v[180:183], v[44:47], a[20:23], v[180:183]
    ds_read_b64_tr_b16 v[42:43], v6 offset:12288
    v_mfma_f32_16x16x32_bf16 v[184:187], v[44:47], a[24:27], v[184:187]
    buffer_load_dwordx4 a[68:71], v226, s[28:31], s40 offen offset:2048 sc1
    v_mfma_f32_16x16x32_bf16 v[188:191], v[44:47], a[28:31], v[188:191]
    s_waitcnt lgkmcnt(8)
    v_mfma_f32_16x16x32_bf16 v[64:67], v[48:51], a[32:35], v[64:67]
    ds_read_b64_tr_b16 v[44:45], v6 offset:9216
    v_mfma_f32_16x16x32_bf16 v[68:71], v[48:51], a[36:39], v[68:71]
    ds_read_b64_tr_b16 v[46:47], v6 offset:13312
    v_mfma_f32_16x16x32_bf16 v[72:75], v[48:51], a[40:43], v[72:75]
    buffer_load_dwordx4 a[72:75], v227, s[28:31], s40 offen offset:2048 sc1
    v_mfma_f32_16x16x32_bf16 v[76:79], v[48:51], a[44:47], v[76:79]
    s_waitcnt lgkmcnt(8)
    v_mfma_f32_16x16x32_bf16 v[80:83], v[52:55], a[32:35], v[80:83]
    ds_read_b64_tr_b16 v[48:49], v7 offset:8192
    v_lshlrev_b32 v251, 2, v0
    v_mfma_f32_16x16x32_bf16 v[84:87], v[52:55], a[36:39], v[84:87]
    ds_read_b64_tr_b16 v[50:51], v7 offset:12288
    v_and_b32 v251, 124, v251
    v_mfma_f32_16x16x32_bf16 v[88:91], v[52:55], a[40:43], v[88:91]
    buffer_load_dwordx4 a[76:79], v228, s[28:31], s40 offen offset:2048 sc1
    v_mfma_f32_16x16x32_bf16 v[92:95], v[52:55], a[44:47], v[92:95]
    s_waitcnt lgkmcnt(8)
    v_mov_b32 v252, s8
    v_and_b32 v249, 7, v0
    v_mfma_f32_16x16x32_bf16 v[96:99], v[56:59], a[32:35], v[96:99]
    ds_read_b64_tr_b16 v[52:53], v7 offset:9216
    v_lshl_add_u32 v249, v249, 7, s4
    v_mfma_f32_16x16x32_bf16 v[100:103], v[56:59], a[36:39], v[100:103]
    ds_read_b64_tr_b16 v[54:55], v7 offset:13312
    v_lshrrev_b32 v229, 2, v0
    v_mfma_f32_16x16x32_bf16 v[104:107], v[56:59], a[40:43], v[104:107]
    buffer_load_dwordx4 a[80:83], v1, s[28:31], s40 offen offset:3072 sc1
    v_mfma_f32_16x16x32_bf16 v[108:111], v[56:59], a[44:47], v[108:111]
    s_waitcnt lgkmcnt(8)
    s_barrier
    v_lshlrev_b32 v229, 6, v229
    v_mfma_f32_16x16x32_bf16 v[112:115], v[60:63], a[32:35], v[112:115]
    ds_read_b64_tr_b16 v[56:57], v3 offset:16384
    v_and_b32 v230, 3, v0
    v_mfma_f32_16x16x32_bf16 v[116:119], v[60:63], a[36:39], v[116:119]
    ds_read_b64_tr_b16 v[58:59], v3 offset:20480
    v_lshl_add_u32 v229, v230, 3, v229
    v_mfma_f32_16x16x32_bf16 v[120:123], v[60:63], a[40:43], v[120:123]
    buffer_load_dwordx4 a[84:87], v226, s[28:31], s40 offen offset:3072 sc1
    v_mfma_f32_16x16x32_bf16 v[124:127], v[60:63], a[44:47], v[124:127]
    s_waitcnt lgkmcnt(8)
    v_bfe_u32 v230, v0, 4, 1
    v_lshl_add_u32 v229, v230, 5, v229
    v_mfma_f32_16x16x32_bf16 v[128:131], v[40:43], a[32:35], v[128:131]
    ds_read_b64_tr_b16 v[60:61], v3 offset:17408
    v_xor_b32 v230, 32, v229
    v_mfma_f32_16x16x32_bf16 v[132:135], v[40:43], a[36:39], v[132:135]
    ds_read_b64_tr_b16 v[62:63], v3 offset:21504
    v_add_u32 v236, 147456, v1
    v_mfma_f32_16x16x32_bf16 v[136:139], v[40:43], a[40:43], v[136:139]
    buffer_load_dwordx4 a[88:91], v227, s[28:31], s40 offen offset:3072 sc1
    v_mfma_f32_16x16x32_bf16 v[140:143], v[40:43], a[44:47], v[140:143]
    s_waitcnt lgkmcnt(8)
    v_mov_b32 v237, v1
    v_add_u32 v238, 0x10000, v1
    v_mfma_f32_16x16x32_bf16 v[144:147], v[44:47], a[32:35], v[144:147]
    ds_read_b64_tr_b16 v[40:41], v4 offset:16384
    v_add_u32 v239, 0x20000, v1
    v_mfma_f32_16x16x32_bf16 v[148:151], v[44:47], a[36:39], v[148:151]
    ds_read_b64_tr_b16 v[42:43], v4 offset:20480
    v_lshrrev_b32 v241, 5, v0
    v_mfma_f32_16x16x32_bf16 v[152:155], v[44:47], a[40:43], v[152:155]
    buffer_load_dwordx4 a[92:95], v228, s[28:31], s40 offen offset:3072 sc1
    v_mfma_f32_16x16x32_bf16 v[156:159], v[44:47], a[44:47], v[156:159]
    s_waitcnt lgkmcnt(8)
    s_add_u32 s40, s40, 4096
    v_add_u32 v241, s50, v241
    v_mfma_f32_16x16x32_bf16 v[160:163], v[48:51], a[32:35], v[160:163]
    ds_read_b64_tr_b16 v[44:45], v4 offset:17408
    v_lshrrev_b32 v240, 1, v241
    v_mfma_f32_16x16x32_bf16 v[164:167], v[48:51], a[36:39], v[164:167]
    ds_read_b64_tr_b16 v[46:47], v4 offset:21504
    v_lshlrev_b32 v240, 10, v240
    v_mfma_f32_16x16x32_bf16 v[168:171], v[48:51], a[40:43], v[168:171]
    buffer_load_dwordx4 a[96:99], v1, s[28:31], s40 offen offset:0 sc1
    v_mfma_f32_16x16x32_bf16 v[172:175], v[48:51], a[44:47], v[172:175]
    s_waitcnt lgkmcnt(8)
    v_and_b32 v241, 1, v241
    v_lshl_add_u32 v240, v241, 3, v240
    v_mfma_f32_16x16x32_bf16 v[176:179], v[52:55], a[32:35], v[176:179]
    ds_read_b64_tr_b16 v[48:49], v6 offset:16384
    v_bfe_u32 v241, v0, 4, 1
    v_mfma_f32_16x16x32_bf16 v[180:183], v[52:55], a[36:39], v[180:183]
    ds_read_b64_tr_b16 v[50:51], v6 offset:20480
    v_lshl_add_u32 v240, v241, 9, v240
    v_mfma_f32_16x16x32_bf16 v[184:187], v[52:55], a[40:43], v[184:187]
    buffer_load_dwordx4 a[100:103], v226, s[28:31], s40 offen offset:0 sc1
    v_mfma_f32_16x16x32_bf16 v[188:191], v[52:55], a[44:47], v[188:191]
    s_waitcnt vmcnt(10)
    s_waitcnt lgkmcnt(8)
    v_and_b32 v241, 15, v0
    v_mfma_f32_16x16x32_bf16 v[64:67], v[56:59], a[48:51], v[64:67]
    ds_read_b64_tr_b16 v[52:53], v6 offset:17408
    v_lshl_add_u32 v240, v241, 4, v240
    v_mfma_f32_16x16x32_bf16 v[68:71], v[56:59], a[52:55], v[68:71]
    ds_read_b64_tr_b16 v[54:55], v6 offset:21504
    v_and_b32 v245, 7, v0
    v_mfma_f32_16x16x32_bf16 v[72:75], v[56:59], a[56:59], v[72:75]
    buffer_load_dwordx4 a[104:107], v227, s[28:31], s40 offen offset:0 sc1
    v_mfma_f32_16x16x32_bf16 v[76:79], v[56:59], a[60:63], v[76:79]
    s_waitcnt lgkmcnt(8)
    v_lshl_add_u32 v245, s13, 2, v245
    v_lshlrev_b32 v245, 7, v245
    v_mfma_f32_16x16x32_bf16 v[80:83], v[60:63], a[48:51], v[80:83]
    ds_read_b64_tr_b16 v[56:57], v7 offset:16384
    v_add_u32 v245, 51249152, v245
    v_mfma_f32_16x16x32_bf16 v[84:87], v[60:63], a[52:55], v[84:87]
    ds_read_b64_tr_b16 v[58:59], v7 offset:20480
    v_lshrrev_b32 v244, 4, v0
    v_mfma_f32_16x16x32_bf16 v[88:91], v[60:63], a[56:59], v[88:91]
    buffer_load_dwordx4 a[108:111], v228, s[28:31], s40 offen offset:0 sc1
    v_mfma_f32_16x16x32_bf16 v[92:95], v[60:63], a[60:63], v[92:95]
    s_waitcnt lgkmcnt(8)
    v_lshl_add_u32 v241, v244, 5, s5
    v_lshl_add_u32 v242, v244, 4, s6
    v_mfma_f32_16x16x32_bf16 v[96:99], v[40:43], a[48:51], v[96:99]
    ds_read_b64_tr_b16 v[60:61], v7 offset:17408
    v_min_u32 v243, 2, v0
    v_mfma_f32_16x16x32_bf16 v[100:103], v[40:43], a[52:55], v[100:103]
    ds_read_b64_tr_b16 v[62:63], v7 offset:21504
    v_sub_u32 v243, s10, v243
    v_mfma_f32_16x16x32_bf16 v[104:107], v[40:43], a[56:59], v[104:107]
    buffer_load_dwordx4 a[112:115], v1, s[28:31], s40 offen offset:1024 sc1
    v_mfma_f32_16x16x32_bf16 v[108:111], v[40:43], a[60:63], v[108:111]
    s_waitcnt lgkmcnt(8)
    s_barrier
    v_add_u32 v243, 3, v243
    v_mfma_f32_16x16x32_bf16 v[112:115], v[44:47], a[48:51], v[112:115]
    ds_read_b64_tr_b16 v[40:41], v3 offset:24576
    v_and_b32 v243, 3, v243
    v_mfma_f32_16x16x32_bf16 v[116:119], v[44:47], a[52:55], v[116:119]
    ds_read_b64_tr_b16 v[42:43], v3 offset:28672
    v_add_u32 v243, s63, v243
    v_mfma_f32_16x16x32_bf16 v[120:123], v[44:47], a[56:59], v[120:123]
    buffer_load_dwordx4 a[116:119], v226, s[28:31], s40 offen offset:1024 sc1
    v_mfma_f32_16x16x32_bf16 v[124:127], v[44:47], a[60:63], v[124:127]
    s_waitcnt lgkmcnt(8)
    v_lshlrev_b32 v243, 9, v243
    v_add_u32 v243, s64, v243
    v_mfma_f32_16x16x32_bf16 v[128:131], v[48:51], a[48:51], v[128:131]
    ds_read_b64_tr_b16 v[44:45], v3 offset:25600
    v_add_u32 v243, 50331648, v243
    v_mfma_f32_16x16x32_bf16 v[132:135], v[48:51], a[52:55], v[132:135]
    ds_read_b64_tr_b16 v[46:47], v3 offset:29696
    v_mov_b32 v247, 0x3f80
    v_mfma_f32_16x16x32_bf16 v[136:139], v[48:51], a[56:59], v[136:139]
    buffer_load_dwordx4 a[120:123], v227, s[28:31], s40 offen offset:1024 sc1
    v_mfma_f32_16x16x32_bf16 v[140:143], v[48:51], a[60:63], v[140:143]
    s_waitcnt lgkmcnt(8)
    v_mov_b32 v248, 0x3f800000
    v_cmp_lt_u32 vcc, 3, v0
    s_nop 1
    v_cndmask_b32 v245, v243, v245, vcc
    v_mfma_f32_16x16x32_bf16 v[144:147], v[52:55], a[48:51], v[144:147]
    ds_read_b64_tr_b16 v[48:49], v4 offset:24576
    v_and_b32 v243, 15, v0
    v_mfma_f32_16x16x32_bf16 v[148:151], v[52:55], a[52:55], v[148:151]
    ds_read_b64_tr_b16 v[50:51], v4 offset:28672
    v_min_u32 v243, 8, v243
    v_mfma_f32_16x16x32_bf16 v[152:155], v[52:55], a[56:59], v[152:155]
    v_lshlrev_b32 v243, 7, v243
    v_add_u32 v243, 51222144, v243
    v_mfma_f32_16x16x32_bf16 v[156:159], v[52:55], a[60:63], v[156:159]
    s_waitcnt lgkmcnt(8)
    v_cmp_lt_u32 vcc, 31, v0
    s_nop 1
    v_cndmask_b32 v245, v245, v243, vcc
    v_mfma_f32_16x16x32_bf16 v[160:163], v[56:59], a[48:51], v[160:163]
    ds_read_b64_tr_b16 v[52:53], v4 offset:25600
    v_mfma_f32_16x16x32_bf16 v[164:167], v[56:59], a[52:55], v[164:167]
    ds_read_b64_tr_b16 v[54:55], v4 offset:29696
    v_mfma_f32_16x16x32_bf16 v[168:171], v[56:59], a[56:59], v[168:171]
    buffer_load_dwordx4 a[124:127], v228, s[28:31], s40 offen offset:1024 sc1
    v_mfma_f32_16x16x32_bf16 v[172:175], v[56:59], a[60:63], v[172:175]
    s_waitcnt lgkmcnt(8)
    v_mfma_f32_16x16x32_bf16 v[176:179], v[60:63], a[48:51], v[176:179]
    ds_read_b64_tr_b16 v[56:57], v6 offset:24576
    v_mfma_f32_16x16x32_bf16 v[180:183], v[60:63], a[52:55], v[180:183]
    ds_read_b64_tr_b16 v[58:59], v6 offset:28672
    v_mfma_f32_16x16x32_bf16 v[184:187], v[60:63], a[56:59], v[184:187]
    buffer_load_dwordx4 a[128:131], v1, s[28:31], s40 offen offset:2048 sc1
    v_mfma_f32_16x16x32_bf16 v[188:191], v[60:63], a[60:63], v[188:191]
    s_waitcnt vmcnt(13)
    s_waitcnt lgkmcnt(8)
    v_mfma_f32_16x16x32_bf16 v[64:67], v[40:43], a[64:67], v[64:67]
    ds_read_b64_tr_b16 v[60:61], v6 offset:25600
    v_mfma_f32_16x16x32_bf16 v[68:71], v[40:43], a[68:71], v[68:71]
    ds_read_b64_tr_b16 v[62:63], v6 offset:29696
    v_mfma_f32_16x16x32_bf16 v[72:75], v[40:43], a[72:75], v[72:75]
    buffer_load_dwordx4 a[132:135], v226, s[28:31], s40 offen offset:2048 sc1
    v_mfma_f32_16x16x32_bf16 v[76:79], v[40:43], a[76:79], v[76:79]
    s_waitcnt lgkmcnt(8)
    v_mfma_f32_16x16x32_bf16 v[80:83], v[44:47], a[64:67], v[80:83]
    ds_read_b64_tr_b16 v[40:41], v7 offset:24576
    v_mfma_f32_16x16x32_bf16 v[84:87], v[44:47], a[68:71], v[84:87]
    ds_read_b64_tr_b16 v[42:43], v7 offset:28672
    v_mfma_f32_16x16x32_bf16 v[88:91], v[44:47], a[72:75], v[88:91]
    buffer_load_dwordx4 a[136:139], v227, s[28:31], s40 offen offset:2048 sc1
    v_mfma_f32_16x16x32_bf16 v[92:95], v[44:47], a[76:79], v[92:95]
    s_waitcnt lgkmcnt(8)
    v_mfma_f32_16x16x32_bf16 v[96:99], v[48:51], a[64:67], v[96:99]
    ds_read_b64_tr_b16 v[44:45], v7 offset:25600
    v_mfma_f32_16x16x32_bf16 v[100:103], v[48:51], a[68:71], v[100:103]
    ds_read_b64_tr_b16 v[46:47], v7 offset:29696
    v_mfma_f32_16x16x32_bf16 v[104:107], v[48:51], a[72:75], v[104:107]
    v_mfma_f32_16x16x32_bf16 v[108:111], v[48:51], a[76:79], v[108:111]
    s_waitcnt lgkmcnt(8)
    s_barrier
    v_mfma_f32_16x16x32_bf16 v[112:115], v[52:55], a[64:67], v[112:115]
    ds_read_b64_tr_b16 v[48:49], v3 offset:32768
    v_mfma_f32_16x16x32_bf16 v[116:119], v[52:55], a[68:71], v[116:119]
    ds_read_b64_tr_b16 v[50:51], v3 offset:36864
    v_mfma_f32_16x16x32_bf16 v[120:123], v[52:55], a[72:75], v[120:123]
    buffer_load_dwordx4 a[140:143], v228, s[28:31], s40 offen offset:2048 sc1
    v_mfma_f32_16x16x32_bf16 v[124:127], v[52:55], a[76:79], v[124:127]
    s_waitcnt lgkmcnt(8)
    v_mfma_f32_16x16x32_bf16 v[128:131], v[56:59], a[64:67], v[128:131]
    ds_read_b64_tr_b16 v[52:53], v3 offset:33792
    v_mfma_f32_16x16x32_bf16 v[132:135], v[56:59], a[68:71], v[132:135]
    ds_read_b64_tr_b16 v[54:55], v3 offset:37888
    v_mfma_f32_16x16x32_bf16 v[136:139], v[56:59], a[72:75], v[136:139]
    buffer_load_dwordx4 a[144:147], v1, s[28:31], s40 offen offset:3072 sc1
    v_mfma_f32_16x16x32_bf16 v[140:143], v[56:59], a[76:79], v[140:143]
    s_waitcnt lgkmcnt(8)
    v_mfma_f32_16x16x32_bf16 v[144:147], v[60:63], a[64:67], v[144:147]
    ds_read_b64_tr_b16 v[56:57], v4 offset:32768
    v_mfma_f32_16x16x32_bf16 v[148:151], v[60:63], a[68:71], v[148:151]
    ds_read_b64_tr_b16 v[58:59], v4 offset:36864
    v_mfma_f32_16x16x32_bf16 v[152:155], v[60:63], a[72:75], v[152:155]
    buffer_load_dwordx4 a[148:151], v226, s[28:31], s40 offen offset:3072 sc1
    v_mfma_f32_16x16x32_bf16 v[156:159], v[60:63], a[76:79], v[156:159]
    s_waitcnt lgkmcnt(8)
    v_mfma_f32_16x16x32_bf16 v[160:163], v[40:43], a[64:67], v[160:163]
    ds_read_b64_tr_b16 v[60:61], v4 offset:33792
    v_mfma_f32_16x16x32_bf16 v[164:167], v[40:43], a[68:71], v[164:167]
    ds_read_b64_tr_b16 v[62:63], v4 offset:37888
    v_mfma_f32_16x16x32_bf16 v[168:171], v[40:43], a[72:75], v[168:171]
    buffer_load_dwordx4 a[152:155], v227, s[28:31], s40 offen offset:3072 sc1
    v_mfma_f32_16x16x32_bf16 v[172:175], v[40:43], a[76:79], v[172:175]
    s_waitcnt lgkmcnt(8)
    v_mfma_f32_16x16x32_bf16 v[176:179], v[44:47], a[64:67], v[176:179]
    ds_read_b64_tr_b16 v[40:41], v6 offset:32768
    v_mfma_f32_16x16x32_bf16 v[180:183], v[44:47], a[68:71], v[180:183]
    ds_read_b64_tr_b16 v[42:43], v6 offset:36864
    v_mfma_f32_16x16x32_bf16 v[184:187], v[44:47], a[72:75], v[184:187]
    v_mfma_f32_16x16x32_bf16 v[188:191], v[44:47], a[76:79], v[188:191]
    s_waitcnt vmcnt(15)
    s_waitcnt lgkmcnt(8)
    v_mfma_f32_16x16x32_bf16 v[64:67], v[48:51], a[80:83], v[64:67]
    ds_read_b64_tr_b16 v[44:45], v6 offset:33792
    v_mfma_f32_16x16x32_bf16 v[68:71], v[48:51], a[84:87], v[68:71]
    ds_read_b64_tr_b16 v[46:47], v6 offset:37888
    v_mfma_f32_16x16x32_bf16 v[72:75], v[48:51], a[88:91], v[72:75]
    buffer_load_dwordx4 a[156:159], v228, s[28:31], s40 offen offset:3072 sc1
    v_mfma_f32_16x16x32_bf16 v[76:79], v[48:51], a[92:95], v[76:79]
    s_waitcnt lgkmcnt(8)
    s_add_u32 s40, s40, 4096
    v_mfma_f32_16x16x32_bf16 v[80:83], v[52:55], a[80:83], v[80:83]
    ds_read_b64_tr_b16 v[48:49], v7 offset:32768
    v_mfma_f32_16x16x32_bf16 v[84:87], v[52:55], a[84:87], v[84:87]
    ds_read_b64_tr_b16 v[50:51], v7 offset:36864
    v_mfma_f32_16x16x32_bf16 v[88:91], v[52:55], a[88:91], v[88:91]
    buffer_load_dwordx4 a[160:163], v1, s[28:31], s40 offen offset:0 sc1
    v_mfma_f32_16x16x32_bf16 v[92:95], v[52:55], a[92:95], v[92:95]
    s_waitcnt lgkmcnt(8)
    v_mfma_f32_16x16x32_bf16 v[96:99], v[56:59], a[80:83], v[96:99]
    ds_read_b64_tr_b16 v[52:53], v7 offset:33792
    v_mfma_f32_16x16x32_bf16 v[100:103], v[56:59], a[84:87], v[100:103]
    ds_read_b64_tr_b16 v[54:55], v7 offset:37888
    v_mfma_f32_16x16x32_bf16 v[104:107], v[56:59], a[88:91], v[104:107]
    buffer_load_dwordx4 a[164:167], v226, s[28:31], s40 offen offset:0 sc1
    v_mfma_f32_16x16x32_bf16 v[108:111], v[56:59], a[92:95], v[108:111]
    s_waitcnt lgkmcnt(8)
    s_barrier
    v_mfma_f32_16x16x32_bf16 v[112:115], v[60:63], a[80:83], v[112:115]
    ds_read_b64_tr_b16 v[56:57], v3 offset:40960
    v_mfma_f32_16x16x32_bf16 v[116:119], v[60:63], a[84:87], v[116:119]
    ds_read_b64_tr_b16 v[58:59], v3 offset:45056
    v_mfma_f32_16x16x32_bf16 v[120:123], v[60:63], a[88:91], v[120:123]
    buffer_load_dwordx4 a[168:171], v227, s[28:31], s40 offen offset:0 sc1
    v_mfma_f32_16x16x32_bf16 v[124:127], v[60:63], a[92:95], v[124:127]
    s_waitcnt lgkmcnt(8)
    v_mfma_f32_16x16x32_bf16 v[128:131], v[40:43], a[80:83], v[128:131]
    ds_read_b64_tr_b16 v[60:61], v3 offset:41984
    v_mov_b32 v232, -1
    v_mfma_f32_16x16x32_bf16 v[132:135], v[40:43], a[84:87], v[132:135]
    ds_read_b64_tr_b16 v[62:63], v3 offset:46080
    v_mov_b32 v233, -1
    v_mfma_f32_16x16x32_bf16 v[136:139], v[40:43], a[88:91], v[136:139]
    v_mov_b32 v234, -1
    v_mov_b32 v235, -1
    v_mfma_f32_16x16x32_bf16 v[140:143], v[40:43], a[92:95], v[140:143]
    s_waitcnt lgkmcnt(8)
    v_mfma_f32_16x16x32_bf16 v[144:147], v[44:47], a[80:83], v[144:147]
    ds_read_b64_tr_b16 v[40:41], v4 offset:40960
    v_mfma_f32_16x16x32_bf16 v[148:151], v[44:47], a[84:87], v[148:151]
    ds_read_b64_tr_b16 v[42:43], v4 offset:45056
    v_mfma_f32_16x16x32_bf16 v[152:155], v[44:47], a[88:91], v[152:155]
    buffer_load_dwordx4 a[172:175], v228, s[28:31], s40 offen offset:0 sc1
    v_mfma_f32_16x16x32_bf16 v[156:159], v[44:47], a[92:95], v[156:159]
    s_waitcnt lgkmcnt(8)
    v_mfma_f32_16x16x32_bf16 v[160:163], v[48:51], a[80:83], v[160:163]
    ds_read_b64_tr_b16 v[44:45], v4 offset:41984
    v_mfma_f32_16x16x32_bf16 v[164:167], v[48:51], a[84:87], v[164:167]
    ds_read_b64_tr_b16 v[46:47], v4 offset:46080
    v_mfma_f32_16x16x32_bf16 v[168:171], v[48:51], a[88:91], v[168:171]
    buffer_load_dword v193, v192, s[28:31], s61 offen sc1
    v_mfma_f32_16x16x32_bf16 v[172:175], v[48:51], a[92:95], v[172:175]
    s_waitcnt lgkmcnt(8)
    s_add_u32 s44, s44, 294912
    s_add_u32 m0, s46, 65536
    v_mfma_f32_16x16x32_bf16 v[176:179], v[52:55], a[80:83], v[176:179]
    ds_read_b64_tr_b16 v[48:49], v6 offset:40960
    v_mfma_f32_16x16x32_bf16 v[180:183], v[52:55], a[84:87], v[180:183]
    ds_read_b64_tr_b16 v[50:51], v6 offset:45056
    v_mfma_f32_16x16x32_bf16 v[184:187], v[52:55], a[88:91], v[184:187]
    buffer_load_dwordx4 v2, s[20:23], s44 offen lds
    v_mfma_f32_16x16x32_bf16 v[188:191], v[52:55], a[92:95], v[188:191]
    s_waitcnt vmcnt(18)
    s_waitcnt lgkmcnt(8)
    v_mfma_f32_16x16x32_bf16 v[64:67], v[56:59], a[96:99], v[64:67]
    ds_read_b64_tr_b16 v[52:53], v6 offset:41984
    v_mfma_f32_16x16x32_bf16 v[68:71], v[56:59], a[100:103], v[68:71]
    ds_read_b64_tr_b16 v[54:55], v6 offset:46080
    v_mfma_f32_16x16x32_bf16 v[72:75], v[56:59], a[104:107], v[72:75]
    buffer_load_dwordx4 v2, s[24:27], s44 offen offset:1024 lds
    v_mfma_f32_16x16x32_bf16 v[76:79], v[56:59], a[108:111], v[76:79]
    s_waitcnt lgkmcnt(8)
    s_add_u32 s44, s44, 294912
    s_add_u32 m0, s46, 73728
    v_mfma_f32_16x16x32_bf16 v[80:83], v[60:63], a[96:99], v[80:83]
    ds_read_b64_tr_b16 v[56:57], v7 offset:40960
    v_mfma_f32_16x16x32_bf16 v[84:87], v[60:63], a[100:103], v[84:87]
    ds_read_b64_tr_b16 v[58:59], v7 offset:45056
    v_mfma_f32_16x16x32_bf16 v[88:91], v[60:63], a[104:107], v[88:91]
    buffer_load_dwordx4 v2, s[20:23], s44 offen lds
    v_mfma_f32_16x16x32_bf16 v[92:95], v[60:63], a[108:111], v[92:95]
    s_waitcnt lgkmcnt(8)
    v_mfma_f32_16x16x32_bf16 v[96:99], v[40:43], a[96:99], v[96:99]
    ds_read_b64_tr_b16 v[60:61], v7 offset:41984
    v_mfma_f32_16x16x32_bf16 v[100:103], v[40:43], a[100:103], v[100:103]
    ds_read_b64_tr_b16 v[62:63], v7 offset:46080
    v_mfma_f32_16x16x32_bf16 v[104:107], v[40:43], a[104:107], v[104:107]
    buffer_load_dwordx4 v2, s[24:27], s44 offen offset:1024 lds
    v_mfma_f32_16x16x32_bf16 v[108:111], v[40:43], a[108:111], v[108:111]
    s_waitcnt lgkmcnt(8)
    s_barrier
    s_add_u32 s44, s44, 294912
    v_mfma_f32_16x16x32_bf16 v[112:115], v[44:47], a[96:99], v[112:115]
    ds_read_b64_tr_b16 v[40:41], v3 offset:49152
    s_add_u32 m0, s46, 81920
    v_mfma_f32_16x16x32_bf16 v[116:119], v[44:47], a[100:103], v[116:119]
    ds_read_b64_tr_b16 v[42:43], v3 offset:53248
    v_mfma_f32_16x16x32_bf16 v[120:123], v[44:47], a[104:107], v[120:123]
    buffer_load_dwordx4 v2, s[20:23], s44 offen lds
    v_mfma_f32_16x16x32_bf16 v[124:127], v[44:47], a[108:111], v[124:127]
    s_waitcnt lgkmcnt(8)
    v_mfma_f32_16x16x32_bf16 v[128:131], v[48:51], a[96:99], v[128:131]
    ds_read_b64_tr_b16 v[44:45], v3 offset:50176
    v_mfma_f32_16x16x32_bf16 v[132:135], v[48:51], a[100:103], v[132:135]
    ds_read_b64_tr_b16 v[46:47], v3 offset:54272
    v_mfma_f32_16x16x32_bf16 v[136:139], v[48:51], a[104:107], v[136:139]
    buffer_load_dwordx4 v2, s[24:27], s44 offen offset:1024 lds
    v_mfma_f32_16x16x32_bf16 v[140:143], v[48:51], a[108:111], v[140:143]
    s_waitcnt lgkmcnt(8)
    v_mfma_f32_16x16x32_bf16 v[144:147], v[52:55], a[96:99], v[144:147]
    ds_read_b64_tr_b16 v[48:49], v4 offset:49152
    v_mfma_f32_16x16x32_bf16 v[148:151], v[52:55], a[100:103], v[148:151]
    ds_read_b64_tr_b16 v[50:51], v4 offset:53248
    v_mfma_f32_16x16x32_bf16 v[152:155], v[52:55], a[104:107], v[152:155]
    v_mfma_f32_16x16x32_bf16 v[156:159], v[52:55], a[108:111], v[156:159]
    s_waitcnt lgkmcnt(8)
    v_mfma_f32_16x16x32_bf16 v[160:163], v[56:59], a[96:99], v[160:163]
    ds_read_b64_tr_b16 v[52:53], v4 offset:50176
    v_mfma_f32_16x16x32_bf16 v[164:167], v[56:59], a[100:103], v[164:167]
    ds_read_b64_tr_b16 v[54:55], v4 offset:54272
    v_mfma_f32_16x16x32_bf16 v[168:171], v[56:59], a[104:107], v[168:171]
    buffer_load_dwordx4 a[176:179], v1, s[28:31], s40 offen offset:1024 sc1
    v_mfma_f32_16x16x32_bf16 v[172:175], v[56:59], a[108:111], v[172:175]
    s_waitcnt lgkmcnt(8)
    v_mfma_f32_16x16x32_bf16 v[176:179], v[60:63], a[96:99], v[176:179]
    ds_read_b64_tr_b16 v[56:57], v6 offset:49152
    v_mfma_f32_16x16x32_bf16 v[180:183], v[60:63], a[100:103], v[180:183]
    ds_read_b64_tr_b16 v[58:59], v6 offset:53248
    v_mfma_f32_16x16x32_bf16 v[184:187], v[60:63], a[104:107], v[184:187]
    buffer_load_dwordx4 a[180:183], v226, s[28:31], s40 offen offset:1024 sc1
    v_mfma_f32_16x16x32_bf16 v[188:191], v[60:63], a[108:111], v[188:191]
    s_waitcnt vmcnt(21)
    s_waitcnt lgkmcnt(8)
    v_mfma_f32_16x16x32_bf16 v[64:67], v[40:43], a[112:115], v[64:67]
    ds_read_b64_tr_b16 v[60:61], v6 offset:50176
    v_mfma_f32_16x16x32_bf16 v[68:71], v[40:43], a[116:119], v[68:71]
    ds_read_b64_tr_b16 v[62:63], v6 offset:54272
    v_mfma_f32_16x16x32_bf16 v[72:75], v[40:43], a[120:123], v[72:75]
    buffer_load_dwordx4 a[184:187], v227, s[28:31], s40 offen offset:1024 sc1
    v_mfma_f32_16x16x32_bf16 v[76:79], v[40:43], a[124:127], v[76:79]
    s_waitcnt lgkmcnt(8)
    v_mfma_f32_16x16x32_bf16 v[80:83], v[44:47], a[112:115], v[80:83]
    ds_read_b64_tr_b16 v[40:41], v7 offset:49152
    v_mfma_f32_16x16x32_bf16 v[84:87], v[44:47], a[116:119], v[84:87]
    ds_read_b64_tr_b16 v[42:43], v7 offset:53248
    v_mfma_f32_16x16x32_bf16 v[88:91], v[44:47], a[120:123], v[88:91]
    buffer_load_dwordx4 a[188:191], v228, s[28:31], s40 offen offset:1024 sc1
    v_mfma_f32_16x16x32_bf16 v[92:95], v[44:47], a[124:127], v[92:95]
    s_waitcnt lgkmcnt(8)
    s_add_u32 s44, s44, 294912
    s_add_u32 m0, s46, 90112
    v_mfma_f32_16x16x32_bf16 v[96:99], v[48:51], a[112:115], v[96:99]
    ds_read_b64_tr_b16 v[44:45], v7 offset:50176
    v_mfma_f32_16x16x32_bf16 v[100:103], v[48:51], a[116:119], v[100:103]
    ds_read_b64_tr_b16 v[46:47], v7 offset:54272
    v_mfma_f32_16x16x32_bf16 v[104:107], v[48:51], a[120:123], v[104:107]
    v_mfma_f32_16x16x32_bf16 v[108:111], v[48:51], a[124:127], v[108:111]
    s_waitcnt lgkmcnt(8)
    s_barrier
    v_mfma_f32_16x16x32_bf16 v[112:115], v[52:55], a[112:115], v[112:115]
    ds_read_b64_tr_b16 v[48:49], v3 offset:57344
    v_mfma_f32_16x16x32_bf16 v[116:119], v[52:55], a[116:119], v[116:119]
    ds_read_b64_tr_b16 v[50:51], v3 offset:61440
    v_mfma_f32_16x16x32_bf16 v[120:123], v[52:55], a[120:123], v[120:123]
    buffer_load_dwordx4 v2, s[20:23], s44 offen lds
    v_mfma_f32_16x16x32_bf16 v[124:127], v[52:55], a[124:127], v[124:127]
    s_waitcnt lgkmcnt(8)
    v_mfma_f32_16x16x32_bf16 v[128:131], v[56:59], a[112:115], v[128:131]
    ds_read_b64_tr_b16 v[52:53], v3 offset:58368
    v_mfma_f32_16x16x32_bf16 v[132:135], v[56:59], a[116:119], v[132:135]
    ds_read_b64_tr_b16 v[54:55], v3 offset:62464
    v_mfma_f32_16x16x32_bf16 v[136:139], v[56:59], a[120:123], v[136:139]
    buffer_load_dwordx4 v2, s[24:27], s44 offen offset:1024 lds
    v_mfma_f32_16x16x32_bf16 v[140:143], v[56:59], a[124:127], v[140:143]
    s_waitcnt lgkmcnt(8)
    v_mfma_f32_16x16x32_bf16 v[144:147], v[60:63], a[112:115], v[144:147]
    ds_read_b64_tr_b16 v[56:57], v4 offset:57344
    v_mfma_f32_16x16x32_bf16 v[148:151], v[60:63], a[116:119], v[148:151]
    ds_read_b64_tr_b16 v[58:59], v4 offset:61440
    v_mfma_f32_16x16x32_bf16 v[152:155], v[60:63], a[120:123], v[152:155]
    buffer_load_dwordx4 a[192:195], v1, s[28:31], s40 offen offset:2048 sc1
    v_mfma_f32_16x16x32_bf16 v[156:159], v[60:63], a[124:127], v[156:159]
    s_waitcnt lgkmcnt(8)
    v_mfma_f32_16x16x32_bf16 v[160:163], v[40:43], a[112:115], v[160:163]
    ds_read_b64_tr_b16 v[60:61], v4 offset:58368
    v_mfma_f32_16x16x32_bf16 v[164:167], v[40:43], a[116:119], v[164:167]
    ds_read_b64_tr_b16 v[62:63], v4 offset:62464
    v_mfma_f32_16x16x32_bf16 v[168:171], v[40:43], a[120:123], v[168:171]
    buffer_load_dwordx4 a[196:199], v226, s[28:31], s40 offen offset:2048 sc1
    v_mfma_f32_16x16x32_bf16 v[172:175], v[40:43], a[124:127], v[172:175]
    s_waitcnt lgkmcnt(8)
    v_mfma_f32_16x16x32_bf16 v[176:179], v[44:47], a[112:115], v[176:179]
    ds_read_b64_tr_b16 v[40:41], v6 offset:57344
    v_mfma_f32_16x16x32_bf16 v[180:183], v[44:47], a[116:119], v[180:183]
    ds_read_b64_tr_b16 v[42:43], v6 offset:61440
    v_mfma_f32_16x16x32_bf16 v[184:187], v[44:47], a[120:123], v[184:187]
    v_mfma_f32_16x16x32_bf16 v[188:191], v[44:47], a[124:127], v[188:191]
    s_waitcnt vmcnt(23)
    s_waitcnt lgkmcnt(8)
    v_mfma_f32_16x16x32_bf16 v[64:67], v[48:51], a[128:131], v[64:67]
    ds_read_b64_tr_b16 v[44:45], v6 offset:58368
    v_mfma_f32_16x16x32_bf16 v[68:71], v[48:51], a[132:135], v[68:71]
    ds_read_b64_tr_b16 v[46:47], v6 offset:62464
    v_mfma_f32_16x16x32_bf16 v[72:75], v[48:51], a[136:139], v[72:75]
    buffer_load_dwordx4 a[200:203], v227, s[28:31], s40 offen offset:2048 sc1
    v_mfma_f32_16x16x32_bf16 v[76:79], v[48:51], a[140:143], v[76:79]
    s_waitcnt lgkmcnt(8)
    v_mfma_f32_16x16x32_bf16 v[80:83], v[52:55], a[128:131], v[80:83]
    ds_read_b64_tr_b16 v[48:49], v7 offset:57344
    v_mfma_f32_16x16x32_bf16 v[84:87], v[52:55], a[132:135], v[84:87]
    ds_read_b64_tr_b16 v[50:51], v7 offset:61440
    v_mfma_f32_16x16x32_bf16 v[88:91], v[52:55], a[136:139], v[88:91]
    buffer_load_dwordx4 a[204:207], v228, s[28:31], s40 offen offset:2048 sc1
    v_mfma_f32_16x16x32_bf16 v[92:95], v[52:55], a[140:143], v[92:95]
    s_waitcnt lgkmcnt(8)
    s_add_u32 s44, s44, 294912
    s_add_u32 m0, s46, 98304
    v_mfma_f32_16x16x32_bf16 v[96:99], v[56:59], a[128:131], v[96:99]
    ds_read_b64_tr_b16 v[52:53], v7 offset:58368
    v_mfma_f32_16x16x32_bf16 v[100:103], v[56:59], a[132:135], v[100:103]
    ds_read_b64_tr_b16 v[54:55], v7 offset:62464
    v_mfma_f32_16x16x32_bf16 v[104:107], v[56:59], a[136:139], v[104:107]
    buffer_load_dwordx4 v2, s[20:23], s44 offen lds
    v_mfma_f32_16x16x32_bf16 v[108:111], v[56:59], a[140:143], v[108:111]
    s_waitcnt lgkmcnt(8)
    s_waitcnt vmcnt(15)
    s_barrier
    v_mfma_f32_16x16x32_bf16 v[112:115], v[60:63], a[128:131], v[112:115]
    v_add_u32 v3, 65536, v3
    v_mfma_f32_16x16x32_bf16 v[116:119], v[60:63], a[132:135], v[116:119]
    ds_read_b64_tr_b16 v[56:57], v3 offset:0
    v_mfma_f32_16x16x32_bf16 v[120:123], v[60:63], a[136:139], v[120:123]
    ds_read_b64_tr_b16 v[58:59], v3 offset:4096
    v_mfma_f32_16x16x32_bf16 v[124:127], v[60:63], a[140:143], v[124:127]
    s_waitcnt lgkmcnt(8)
    v_mfma_f32_16x16x32_bf16 v[128:131], v[40:43], a[128:131], v[128:131]
    ds_read_b64_tr_b16 v[60:61], v3 offset:1024
    v_mfma_f32_16x16x32_bf16 v[132:135], v[40:43], a[132:135], v[132:135]
    ds_read_b64_tr_b16 v[62:63], v3 offset:5120
    v_mfma_f32_16x16x32_bf16 v[136:139], v[40:43], a[136:139], v[136:139]
    buffer_load_dwordx4 v2, s[24:27], s44 offen offset:1024 lds
    v_mfma_f32_16x16x32_bf16 v[140:143], v[40:43], a[140:143], v[140:143]
    s_waitcnt lgkmcnt(8)
    v_mfma_f32_16x16x32_bf16 v[144:147], v[44:47], a[128:131], v[144:147]
    v_add_u32 v4, 65536, v4
    v_mfma_f32_16x16x32_bf16 v[148:151], v[44:47], a[132:135], v[148:151]
    ds_read_b64_tr_b16 v[40:41], v4 offset:0
    v_mfma_f32_16x16x32_bf16 v[152:155], v[44:47], a[136:139], v[152:155]
    ds_read_b64_tr_b16 v[42:43], v4 offset:4096
    v_mfma_f32_16x16x32_bf16 v[156:159], v[44:47], a[140:143], v[156:159]
    s_waitcnt lgkmcnt(8)
    buffer_load_dwordx4 a[208:211], v1, s[28:31], s40 offen offset:3072 sc1
    v_mfma_f32_16x16x32_bf16 v[160:163], v[48:51], a[128:131], v[160:163]
    ds_read_b64_tr_b16 v[44:45], v4 offset:1024
    v_mfma_f32_16x16x32_bf16 v[164:167], v[48:51], a[132:135], v[164:167]
    ds_read_b64_tr_b16 v[46:47], v4 offset:5120
    v_mfma_f32_16x16x32_bf16 v[168:171], v[48:51], a[136:139], v[168:171]
    buffer_load_dwordx4 a[212:215], v226, s[28:31], s40 offen offset:3072 sc1
    v_mfma_f32_16x16x32_bf16 v[172:175], v[48:51], a[140:143], v[172:175]
    s_waitcnt lgkmcnt(8)
    v_mfma_f32_16x16x32_bf16 v[176:179], v[52:55], a[128:131], v[176:179]
    v_add_u32 v6, 65536, v6
    v_mfma_f32_16x16x32_bf16 v[180:183], v[52:55], a[132:135], v[180:183]
    ds_read_b64_tr_b16 v[48:49], v6 offset:0
    v_mfma_f32_16x16x32_bf16 v[184:187], v[52:55], a[136:139], v[184:187]
    ds_read_b64_tr_b16 v[50:51], v6 offset:4096
    v_mfma_f32_16x16x32_bf16 v[188:191], v[52:55], a[140:143], v[188:191]
    s_waitcnt lgkmcnt(8)
    v_mfma_f32_16x16x32_bf16 v[64:67], v[56:59], a[144:147], v[64:67]
    ds_read_b64_tr_b16 v[52:53], v6 offset:1024
    v_mfma_f32_16x16x32_bf16 v[68:71], v[56:59], a[148:151], v[68:71]
    ds_read_b64_tr_b16 v[54:55], v6 offset:5120
    v_mfma_f32_16x16x32_bf16 v[72:75], v[56:59], a[152:155], v[72:75]
    buffer_load_dwordx4 a[216:219], v227, s[28:31], s40 offen offset:3072 sc1
    v_mfma_f32_16x16x32_bf16 v[76:79], v[56:59], a[156:159], v[76:79]
    s_waitcnt lgkmcnt(8)
    v_mfma_f32_16x16x32_bf16 v[80:83], v[60:63], a[144:147], v[80:83]
    v_add_u32 v7, 65536, v7
    v_mfma_f32_16x16x32_bf16 v[84:87], v[60:63], a[148:151], v[84:87]
    ds_read_b64_tr_b16 v[56:57], v7 offset:0
    v_mfma_f32_16x16x32_bf16 v[88:91], v[60:63], a[152:155], v[88:91]
    ds_read_b64_tr_b16 v[58:59], v7 offset:4096
    v_mfma_f32_16x16x32_bf16 v[92:95], v[60:63], a[156:159], v[92:95]
    s_waitcnt lgkmcnt(8)
    buffer_load_dwordx4 a[220:223], v228, s[28:31], s40 offen offset:3072 sc1
    v_mfma_f32_16x16x32_bf16 v[96:99], v[40:43], a[144:147], v[96:99]
    ds_read_b64_tr_b16 v[60:61], v7 offset:1024
    s_add_u32 s44, s44, 294912
    v_mfma_f32_16x16x32_bf16 v[100:103], v[40:43], a[148:151], v[100:103]
    ds_read_b64_tr_b16 v[62:63], v7 offset:5120
    s_add_u32 m0, s46, 106496
    v_mfma_f32_16x16x32_bf16 v[104:107], v[40:43], a[152:155], v[104:107]
    buffer_load_dwordx4 v2, s[20:23], s44 offen lds
    v_mfma_f32_16x16x32_bf16 v[108:111], v[40:43], a[156:159], v[108:111]
    s_waitcnt lgkmcnt(8)
    s_waitcnt vmcnt(19)
    s_barrier
    v_mfma_f32_16x16x32_bf16 v[112:115], v[44:47], a[144:147], v[112:115]
    ds_read_b64_tr_b16 v[40:41], v3 offset:8192
    v_mfma_f32_16x16x32_bf16 v[116:119], v[44:47], a[148:151], v[116:119]
    ds_read_b64_tr_b16 v[42:43], v3 offset:12288
    v_mfma_f32_16x16x32_bf16 v[120:123], v[44:47], a[152:155], v[120:123]
    buffer_load_dwordx4 v2, s[24:27], s44 offen offset:1024 lds
    v_mfma_f32_16x16x32_bf16 v[124:127], v[44:47], a[156:159], v[124:127]
    s_waitcnt lgkmcnt(8)
    s_add_u32 s40, s40, 4096
    v_mfma_f32_16x16x32_bf16 v[128:131], v[48:51], a[144:147], v[128:131]
    ds_read_b64_tr_b16 v[44:45], v3 offset:9216
    v_mfma_f32_16x16x32_bf16 v[132:135], v[48:51], a[148:151], v[132:135]
    ds_read_b64_tr_b16 v[46:47], v3 offset:13312
    v_mfma_f32_16x16x32_bf16 v[136:139], v[48:51], a[152:155], v[136:139]
    v_mfma_f32_16x16x32_bf16 v[140:143], v[48:51], a[156:159], v[140:143]
    s_waitcnt lgkmcnt(8)
    v_mfma_f32_16x16x32_bf16 v[144:147], v[52:55], a[144:147], v[144:147]
    ds_read_b64_tr_b16 v[48:49], v4 offset:8192
    v_mfma_f32_16x16x32_bf16 v[148:151], v[52:55], a[148:151], v[148:151]
    ds_read_b64_tr_b16 v[50:51], v4 offset:12288
    v_mfma_f32_16x16x32_bf16 v[152:155], v[52:55], a[152:155], v[152:155]
    buffer_load_dwordx4 a[224:227], v1, s[28:31], s40 offen offset:0 sc1
    v_mfma_f32_16x16x32_bf16 v[156:159], v[52:55], a[156:159], v[156:159]
    s_waitcnt lgkmcnt(8)
    v_mfma_f32_16x16x32_bf16 v[160:163], v[56:59], a[144:147], v[160:163]
    ds_read_b64_tr_b16 v[52:53], v4 offset:9216
    v_mfma_f32_16x16x32_bf16 v[164:167], v[56:59], a[148:151], v[164:167]
    ds_read_b64_tr_b16 v[54:55], v4 offset:13312
    v_mfma_f32_16x16x32_bf16 v[168:171], v[56:59], a[152:155], v[168:171]
    buffer_load_dwordx4 a[228:231], v226, s[28:31], s40 offen offset:0 sc1
    v_mfma_f32_16x16x32_bf16 v[172:175], v[56:59], a[156:159], v[172:175]
    s_waitcnt lgkmcnt(8)
    v_mfma_f32_16x16x32_bf16 v[176:179], v[60:63], a[144:147], v[176:179]
    ds_read_b64_tr_b16 v[56:57], v6 offset:8192
    v_mfma_f32_16x16x32_bf16 v[180:183], v[60:63], a[148:151], v[180:183]
    ds_read_b64_tr_b16 v[58:59], v6 offset:12288
    v_mfma_f32_16x16x32_bf16 v[184:187], v[60:63], a[152:155], v[184:187]
    buffer_load_dwordx4 a[232:235], v227, s[28:31], s40 offen offset:0 sc1
    v_mfma_f32_16x16x32_bf16 v[188:191], v[60:63], a[156:159], v[188:191]
    s_waitcnt lgkmcnt(8)
    v_mfma_f32_16x16x32_bf16 v[64:67], v[40:43], a[160:163], v[64:67]
    ds_read_b64_tr_b16 v[60:61], v6 offset:9216
    v_mfma_f32_16x16x32_bf16 v[68:71], v[40:43], a[164:167], v[68:71]
    ds_read_b64_tr_b16 v[62:63], v6 offset:13312
    v_mfma_f32_16x16x32_bf16 v[72:75], v[40:43], a[168:171], v[72:75]
    buffer_load_dwordx4 a[236:239], v228, s[28:31], s40 offen offset:0 sc1
    v_mfma_f32_16x16x32_bf16 v[76:79], v[40:43], a[172:175], v[76:79]
    s_waitcnt lgkmcnt(8)
    s_add_u32 s44, s44, 294912
    s_add_u32 m0, s46, 114688
    v_mfma_f32_16x16x32_bf16 v[80:83], v[44:47], a[160:163], v[80:83]
    ds_read_b64_tr_b16 v[40:41], v7 offset:8192
    v_mfma_f32_16x16x32_bf16 v[84:87], v[44:47], a[164:167], v[84:87]
    ds_read_b64_tr_b16 v[42:43], v7 offset:12288
    v_mfma_f32_16x16x32_bf16 v[88:91], v[44:47], a[168:171], v[88:91]
    v_mfma_f32_16x16x32_bf16 v[92:95], v[44:47], a[172:175], v[92:95]
    s_waitcnt lgkmcnt(8)
    v_mfma_f32_16x16x32_bf16 v[96:99], v[48:51], a[160:163], v[96:99]
    ds_read_b64_tr_b16 v[44:45], v7 offset:9216
    v_mfma_f32_16x16x32_bf16 v[100:103], v[48:51], a[164:167], v[100:103]
    ds_read_b64_tr_b16 v[46:47], v7 offset:13312
    v_mfma_f32_16x16x32_bf16 v[104:107], v[48:51], a[168:171], v[104:107]
    buffer_load_dwordx4 v2, s[20:23], s44 offen lds
    v_mfma_f32_16x16x32_bf16 v[108:111], v[48:51], a[172:175], v[108:111]
    s_waitcnt lgkmcnt(8)
    s_waitcnt vmcnt(23)
    s_barrier
    v_mfma_f32_16x16x32_bf16 v[112:115], v[52:55], a[160:163], v[112:115]
    ds_read_b64_tr_b16 v[48:49], v3 offset:16384
    v_mfma_f32_16x16x32_bf16 v[116:119], v[52:55], a[164:167], v[116:119]
    ds_read_b64_tr_b16 v[50:51], v3 offset:20480
    v_mfma_f32_16x16x32_bf16 v[120:123], v[52:55], a[168:171], v[120:123]
    buffer_load_dwordx4 v2, s[24:27], s44 offen offset:1024 lds
    v_mfma_f32_16x16x32_bf16 v[124:127], v[52:55], a[172:175], v[124:127]
    s_waitcnt lgkmcnt(8)
    v_cmp_ne_u32 vcc, s8, v193
    s_nop 0
    s_cbranch_vccnz K4_SLOW1
K4_RET1:
    v_mfma_f32_16x16x32_bf16 v[128:131], v[56:59], a[160:163], v[128:131]
    ds_read_b64_tr_b16 v[52:53], v3 offset:17408
    v_mfma_f32_16x16x32_bf16 v[132:135], v[56:59], a[164:167], v[132:135]
    ds_read_b64_tr_b16 v[54:55], v3 offset:21504
    v_mfma_f32_16x16x32_bf16 v[136:139], v[56:59], a[168:171], v[136:139]
    buffer_load_dwordx4 a[240:243], v1, s[28:31], s40 offen offset:1024 sc1
    v_mfma_f32_16x16x32_bf16 v[140:143], v[56:59], a[172:175], v[140:143]
    s_waitcnt lgkmcnt(8)
    v_mfma_f32_16x16x32_bf16 v[144:147], v[60:63], a[160:163], v[144:147]
    ds_read_b64_tr_b16 v[56:57], v4 offset:16384
    v_mfma_f32_16x16x32_bf16 v[148:151], v[60:63], a[164:167], v[148:151]
    ds_read_b64_tr_b16 v[58:59], v4 offset:20480
    v_mfma_f32_16x16x32_bf16 v[152:155], v[60:63], a[168:171], v[152:155]
    buffer_load_dwordx4 a[244:247], v226, s[28:31], s40 offen offset:1024 sc1
    v_mfma_f32_16x16x32_bf16 v[156:159], v[60:63], a[172:175], v[156:159]
    s_waitcnt lgkmcnt(8)
    v_mfma_f32_16x16x32_bf16 v[160:163], v[40:43], a[160:163], v[160:163]
    ds_read_b64_tr_b16 v[60:61], v4 offset:17408
    v_mfma_f32_16x16x32_bf16 v[164:167], v[40:43], a[164:167], v[164:167]
    ds_read_b64_tr_b16 v[62:63], v4 offset:21504
    v_mfma_f32_16x16x32_bf16 v[168:171], v[40:43], a[168:171], v[168:171]
    v_mfma_f32_16x16x32_bf16 v[172:175], v[40:43], a[172:175], v[172:175]
    s_waitcnt lgkmcnt(8)
    v_mfma_f32_16x16x32_bf16 v[176:179], v[44:47], a[160:163], v[176:179]
    ds_read_b64_tr_b16 v[40:41], v6 offset:16384
    v_mfma_f32_16x16x32_bf16 v[180:183], v[44:47], a[164:167], v[180:183]
    ds_read_b64_tr_b16 v[42:43], v6 offset:20480
    v_mfma_f32_16x16x32_bf16 v[184:187], v[44:47], a[168:171], v[184:187]
    buffer_load_dwordx4 a[248:251], v227, s[28:31], s40 offen offset:1024 sc1
    v_mfma_f32_16x16x32_bf16 v[188:191], v[44:47], a[172:175], v[188:191]
    s_waitcnt vmcnt(23)
    s_waitcnt lgkmcnt(8)
    v_mfma_f32_16x16x32_bf16 v[64:67], v[48:51], a[176:179], v[64:67]
    ds_read_b64_tr_b16 v[44:45], v6 offset:17408
    v_mfma_f32_16x16x32_bf16 v[68:71], v[48:51], a[180:183], v[68:71]
    ds_read_b64_tr_b16 v[46:47], v6 offset:21504
    v_mfma_f32_16x16x32_bf16 v[72:75], v[48:51], a[184:187], v[72:75]
    buffer_load_dwordx4 a[252:255], v228, s[28:31], s40 offen offset:1024 sc1
    v_mfma_f32_16x16x32_bf16 v[76:79], v[48:51], a[188:191], v[76:79]
    s_waitcnt lgkmcnt(8)
    s_add_u32 m0, s47, 122880
    v_mfma_f32_16x16x32_bf16 v[80:83], v[52:55], a[176:179], v[80:83]
    ds_read_b64_tr_b16 v[48:49], v7 offset:16384
    v_mfma_f32_16x16x32_bf16 v[84:87], v[52:55], a[180:183], v[84:87]
    ds_read_b64_tr_b16 v[50:51], v7 offset:20480
    v_mfma_f32_16x16x32_bf16 v[88:91], v[52:55], a[184:187], v[88:91]
    buffer_load_dwordx4 v1, s[28:31], s45 offen sc1 lds
    v_mfma_f32_16x16x32_bf16 v[92:95], v[52:55], a[188:191], v[92:95]
    s_waitcnt lgkmcnt(8)
    s_add_u32 s45, s45, 4096
    s_add_u32 m0, s47, 126976
    v_mfma_f32_16x16x32_bf16 v[96:99], v[56:59], a[176:179], v[96:99]
    ds_read_b64_tr_b16 v[52:53], v7 offset:17408
    v_mfma_f32_16x16x32_bf16 v[100:103], v[56:59], a[180:183], v[100:103]
    ds_read_b64_tr_b16 v[54:55], v7 offset:21504
    v_mfma_f32_16x16x32_bf16 v[104:107], v[56:59], a[184:187], v[104:107]
    buffer_load_dwordx4 v1, s[28:31], s45 offen sc1 lds
    v_mfma_f32_16x16x32_bf16 v[108:111], v[56:59], a[188:191], v[108:111]
    s_waitcnt lgkmcnt(8)
    s_waitcnt vmcnt(24)
    s_barrier
    v_mfma_f32_16x16x32_bf16 v[112:115], v[60:63], a[176:179], v[112:115]
    ds_read_b64_tr_b16 v[56:57], v3 offset:24576
    s_add_u32 s45, s45, 4096
    v_mfma_f32_16x16x32_bf16 v[116:119], v[60:63], a[180:183], v[116:119]
    ds_read_b64_tr_b16 v[58:59], v3 offset:28672
    s_add_u32 m0, s47, 131072
    v_mfma_f32_16x16x32_bf16 v[120:123], v[60:63], a[184:187], v[120:123]
    v_mfma_f32_16x16x32_bf16 v[124:127], v[60:63], a[188:191], v[124:127]
    s_waitcnt lgkmcnt(8)
    v_mfma_f32_16x16x32_bf16 v[128:131], v[40:43], a[176:179], v[128:131]
    ds_read_b64_tr_b16 v[60:61], v3 offset:25600
    v_mfma_f32_16x16x32_bf16 v[132:135], v[40:43], a[180:183], v[132:135]
    ds_read_b64_tr_b16 v[62:63], v3 offset:29696
    v_mfma_f32_16x16x32_bf16 v[136:139], v[40:43], a[184:187], v[136:139]
    buffer_load_dwordx4 v1, s[28:31], s45 offen sc1 lds
    v_mfma_f32_16x16x32_bf16 v[140:143], v[40:43], a[188:191], v[140:143]
    s_waitcnt lgkmcnt(8)
    s_add_u32 s45, s45, 4096
    s_add_u32 m0, s47, 135168
    v_mfma_f32_16x16x32_bf16 v[144:147], v[44:47], a[176:179], v[144:147]
    ds_read_b64_tr_b16 v[40:41], v4 offset:24576
    v_mfma_f32_16x16x32_bf16 v[148:151], v[44:47], a[180:183], v[148:151]
    ds_read_b64_tr_b16 v[42:43], v4 offset:28672
    v_mfma_f32_16x16x32_bf16 v[152:155], v[44:47], a[184:187], v[152:155]
    buffer_load_dwordx4 v1, s[28:31], s45 offen sc1 lds
    v_mfma_f32_16x16x32_bf16 v[156:159], v[44:47], a[188:191], v[156:159]
    s_waitcnt lgkmcnt(8)
    s_add_u32 s45, s45, 4096
    s_add_u32 m0, s47, 139264
    v_mfma_f32_16x16x32_bf16 v[160:163], v[48:51], a[176:179], v[160:163]
    ds_read_b64_tr_b16 v[44:45], v4 offset:25600
    v_mfma_f32_16x16x32_bf16 v[164:167], v[48:51], a[180:183], v[164:167]
    ds_read_b64_tr_b16 v[46:47], v4 offset:29696
    v_mfma_f32_16x16x32_bf16 v[168:171], v[48:51], a[184:187], v[168:171]
    buffer_load_dwordx4 v1, s[28:31], s45 offen sc1 lds
    v_mfma_f32_16x16x32_bf16 v[172:175], v[48:51], a[188:191], v[172:175]
    s_waitcnt lgkmcnt(8)
    s_add_u32 s45, s45, 4096
    s_add_u32 m0, s47, 143360
    v_mfma_f32_16x16x32_bf16 v[176:179], v[52:55], a[176:179], v[176:179]
    ds_read_b64_tr_b16 v[48:49], v6 offset:24576
    v_mfma_f32_16x16x32_bf16 v[180:183], v[52:55], a[180:183], v[180:183]
    ds_read_b64_tr_b16 v[50:51], v6 offset:28672
    v_mfma_f32_16x16x32_bf16 v[184:187], v[52:55], a[184:187], v[184:187]
    buffer_load_dwordx4 v1, s[28:31], s45 offen sc1 lds
    v_mfma_f32_16x16x32_bf16 v[188:191], v[52:55], a[188:191], v[188:191]
    s_waitcnt vmcnt(24)
    s_waitcnt lgkmcnt(8)
    s_add_u32 s45, s45, 4096
    v_mfma_f32_16x16x32_bf16 v[64:67], v[56:59], a[192:195], v[64:67]
    ds_read_b64_tr_b16 v[52:53], v6 offset:25600
    s_add_u32 m0, s47, 147456
    v_mfma_f32_16x16x32_bf16 v[68:71], v[56:59], a[196:199], v[68:71]
    ds_read_b64_tr_b16 v[54:55], v6 offset:29696
    v_mfma_f32_16x16x32_bf16 v[72:75], v[56:59], a[200:203], v[72:75]
    v_mfma_f32_16x16x32_bf16 v[76:79], v[56:59], a[204:207], v[76:79]
    s_waitcnt lgkmcnt(8)
    v_mfma_f32_16x16x32_bf16 v[80:83], v[60:63], a[192:195], v[80:83]
    ds_read_b64_tr_b16 v[56:57], v7 offset:24576
    v_mfma_f32_16x16x32_bf16 v[84:87], v[60:63], a[196:199], v[84:87]
    ds_read_b64_tr_b16 v[58:59], v7 offset:28672
    v_mfma_f32_16x16x32_bf16 v[88:91], v[60:63], a[200:203], v[88:91]
    buffer_load_dwordx4 v1, s[28:31], s45 offen sc1 lds
    v_mfma_f32_16x16x32_bf16 v[92:95], v[60:63], a[204:207], v[92:95]
    s_waitcnt lgkmcnt(8)
    s_add_u32 s45, s45, 4096
    s_add_u32 m0, s47, 151552
    v_mfma_f32_16x16x32_bf16 v[96:99], v[40:43], a[192:195], v[96:99]
    ds_read_b64_tr_b16 v[60:61], v7 offset:25600
    v_mfma_f32_16x16x32_bf16 v[100:103], v[40:43], a[196:199], v[100:103]
    ds_read_b64_tr_b16 v[62:63], v7 offset:29696
    v_mfma_f32_16x16x32_bf16 v[104:107], v[40:43], a[200:203], v[104:107]
    buffer_load_dwordx4 v1, s[28:31], s45 offen sc1 lds
    v_mfma_f32_16x16x32_bf16 v[108:111], v[40:43], a[204:207], v[108:111]
    s_waitcnt lgkmcnt(8)
    s_waitcnt vmcnt(24)
    s_barrier
    v_mfma_f32_16x16x32_bf16 v[112:115], v[44:47], a[192:195], v[112:115]
    ds_read_b64_tr_b16 v[40:41], v3 offset:32768
    s_add_u32 s45, s45, 4096
    v_mfma_f32_16x16x32_bf16 v[116:119], v[44:47], a[196:199], v[116:119]
    ds_read_b64_tr_b16 v[42:43], v3 offset:36864
    s_add_u32 m0, s47, 155648
    v_mfma_f32_16x16x32_bf16 v[120:123], v[44:47], a[200:203], v[120:123]
    buffer_load_dwordx4 v1, s[28:31], s45 offen sc1 lds
    v_mfma_f32_16x16x32_bf16 v[124:127], v[44:47], a[204:207], v[124:127]
    s_waitcnt lgkmcnt(8)
    s_add_u32 s44, s44, s37
    s_add_u32 s18, s44, 64
    v_mfma_f32_16x16x32_bf16 v[128:131], v[48:51], a[192:195], v[128:131]
    ds_read_b64_tr_b16 v[44:45], v3 offset:33792
    s_add_u32 m0, s46, 0
    v_mfma_f32_16x16x32_bf16 v[132:135], v[48:51], a[196:199], v[132:135]
    ds_read_b64_tr_b16 v[46:47], v3 offset:37888
    v_mfma_f32_16x16x32_bf16 v[136:139], v[48:51], a[200:203], v[136:139]
    buffer_load_dwordx4 v5, s[20:23], s44 offen lds
    v_mfma_f32_16x16x32_bf16 v[140:143], v[48:51], a[204:207], v[140:143]
    s_waitcnt lgkmcnt(8)
    s_add_u32 m0, s46, 8192
    v_mfma_f32_16x16x32_bf16 v[144:147], v[52:55], a[192:195], v[144:147]
    ds_read_b64_tr_b16 v[48:49], v4 offset:32768
    v_mfma_f32_16x16x32_bf16 v[148:151], v[52:55], a[196:199], v[148:151]
    ds_read_b64_tr_b16 v[50:51], v4 offset:36864
    v_mfma_f32_16x16x32_bf16 v[152:155], v[52:55], a[200:203], v[152:155]
    buffer_load_dwordx4 v5, s[20:23], s18 offen lds
    v_mfma_f32_16x16x32_bf16 v[156:159], v[52:55], a[204:207], v[156:159]
    s_waitcnt lgkmcnt(8)
    v_mfma_f32_16x16x32_bf16 v[160:163], v[56:59], a[192:195], v[160:163]
    ds_read_b64_tr_b16 v[52:53], v4 offset:33792
    v_mfma_f32_16x16x32_bf16 v[164:167], v[56:59], a[196:199], v[164:167]
    ds_read_b64_tr_b16 v[54:55], v4 offset:37888
    v_mfma_f32_16x16x32_bf16 v[168:171], v[56:59], a[200:203], v[168:171]
    v_mfma_f32_16x16x32_bf16 v[172:175], v[56:59], a[204:207], v[172:175]
    s_waitcnt lgkmcnt(8)
    v_mfma_f32_16x16x32_bf16 v[176:179], v[60:63], a[192:195], v[176:179]
    ds_read_b64_tr_b16 v[56:57], v6 offset:32768
    v_mfma_f32_16x16x32_bf16 v[180:183], v[60:63], a[196:199], v[180:183]
    ds_read_b64_tr_b16 v[58:59], v6 offset:36864
    v_mfma_f32_16x16x32_bf16 v[184:187], v[60:63], a[200:203], v[184:187]
    buffer_load_dwordx4 v5, s[24:27], s18 offen offset:1024 lds
    v_mfma_f32_16x16x32_bf16 v[188:191], v[60:63], a[204:207], v[188:191]
    s_waitcnt vmcnt(24)
    s_waitcnt lgkmcnt(8)
    s_add_u32 m0, s46, 0
    v_mfma_f32_16x16x32_bf16 v[64:67], v[40:43], a[208:211], v[64:67]
    ds_read_b64_tr_b16 v[60:61], v6 offset:33792
    v_mfma_f32_16x16x32_bf16 v[68:71], v[40:43], a[212:215], v[68:71]
    ds_read_b64_tr_b16 v[62:63], v6 offset:37888
    v_mfma_f32_16x16x32_bf16 v[72:75], v[40:43], a[216:219], v[72:75]
    buffer_store_dwordx4 v[200:203], v1, s[28:31], s38 offen offset:0 sc1
    v_mfma_f32_16x16x32_bf16 v[76:79], v[40:43], a[220:223], v[76:79]
    s_waitcnt lgkmcnt(8)
    buffer_load_dwordx4 v5, s[24:27], s44 offen offset:1024 lds
    v_mfma_f32_16x16x32_bf16 v[80:83], v[44:47], a[208:211], v[80:83]
    ds_read_b64_tr_b16 v[40:41], v7 offset:32768
    s_add_u32 s44, s44, 589824
    v_mfma_f32_16x16x32_bf16 v[84:87], v[44:47], a[212:215], v[84:87]
    ds_read_b64_tr_b16 v[42:43], v7 offset:36864
    s_add_u32 s18, s44, 64
    v_mfma_f32_16x16x32_bf16 v[88:91], v[44:47], a[216:219], v[88:91]
    s_add_u32 m0, s46, 16384
    v_mfma_f32_16x16x32_bf16 v[92:95], v[44:47], a[220:223], v[92:95]
    s_waitcnt lgkmcnt(8)
    v_mfma_f32_16x16x32_bf16 v[96:99], v[48:51], a[208:211], v[96:99]
    ds_read_b64_tr_b16 v[44:45], v7 offset:33792
    v_mfma_f32_16x16x32_bf16 v[100:103], v[48:51], a[212:215], v[100:103]
    ds_read_b64_tr_b16 v[46:47], v7 offset:37888
    v_mfma_f32_16x16x32_bf16 v[104:107], v[48:51], a[216:219], v[104:107]
    buffer_load_dwordx4 v5, s[20:23], s44 offen lds
    v_mfma_f32_16x16x32_bf16 v[108:111], v[48:51], a[220:223], v[108:111]
    s_waitcnt lgkmcnt(8)
    s_waitcnt vmcnt(25)
    s_barrier
    v_mfma_f32_16x16x32_bf16 v[112:115], v[52:55], a[208:211], v[112:115]
    ds_read_b64_tr_b16 v[48:49], v3 offset:40960
    s_add_u32 m0, s46, 24576
    v_mfma_f32_16x16x32_bf16 v[116:119], v[52:55], a[212:215], v[116:119]
    ds_read_b64_tr_b16 v[50:51], v3 offset:45056
    v_mfma_f32_16x16x32_bf16 v[120:123], v[52:55], a[216:219], v[120:123]
    buffer_load_dwordx4 v5, s[20:23], s18 offen lds
    v_mfma_f32_16x16x32_bf16 v[124:127], v[52:55], a[220:223], v[124:127]
    s_waitcnt lgkmcnt(8)
    v_mfma_f32_16x16x32_bf16 v[128:131], v[56:59], a[208:211], v[128:131]
    ds_read_b64_tr_b16 v[52:53], v3 offset:41984
    v_mfma_f32_16x16x32_bf16 v[132:135], v[56:59], a[212:215], v[132:135]
    ds_read_b64_tr_b16 v[54:55], v3 offset:46080
    v_mfma_f32_16x16x32_bf16 v[136:139], v[56:59], a[216:219], v[136:139]
    buffer_store_dwordx4 v[204:207], v1, s[28:31], s38 offen offset:1024 sc1
    v_mfma_f32_16x16x32_bf16 v[140:143], v[56:59], a[220:223], v[140:143]
    s_waitcnt lgkmcnt(8)
    v_mfma_f32_16x16x32_bf16 v[144:147], v[60:63], a[208:211], v[144:147]
    ds_read_b64_tr_b16 v[56:57], v4 offset:40960
    v_mfma_f32_16x16x32_bf16 v[148:151], v[60:63], a[212:215], v[148:151]
    ds_read_b64_tr_b16 v[58:59], v4 offset:45056
    v_mfma_f32_16x16x32_bf16 v[152:155], v[60:63], a[216:219], v[152:155]
    buffer_load_dwordx4 v5, s[24:27], s18 offen offset:1024 lds
    v_mfma_f32_16x16x32_bf16 v[156:159], v[60:63], a[220:223], v[156:159]
    s_waitcnt lgkmcnt(8)
    s_add_u32 m0, s46, 16384
    v_mfma_f32_16x16x32_bf16 v[160:163], v[40:43], a[208:211], v[160:163]
    ds_read_b64_tr_b16 v[60:61], v4 offset:41984
    v_mfma_f32_16x16x32_bf16 v[164:167], v[40:43], a[212:215], v[164:167]
    ds_read_b64_tr_b16 v[62:63], v4 offset:46080
    v_mfma_f32_16x16x32_bf16 v[168:171], v[40:43], a[216:219], v[168:171]
    buffer_load_dwordx4 v5, s[24:27], s44 offen offset:1024 lds
    v_mfma_f32_16x16x32_bf16 v[172:175], v[40:43], a[220:223], v[172:175]
    s_waitcnt lgkmcnt(8)
    s_add_u32 s44, s44, 589824
    s_add_u32 s18, s44, 64
    v_mfma_f32_16x16x32_bf16 v[176:179], v[44:47], a[208:211], v[176:179]
    ds_read_b64_tr_b16 v[40:41], v6 offset:40960
    s_add_u32 m0, s46, 32768
    v_mfma_f32_16x16x32_bf16 v[180:183], v[44:47], a[212:215], v[180:183]
    ds_read_b64_tr_b16 v[42:43], v6 offset:45056
    v_mfma_f32_16x16x32_bf16 v[184:187], v[44:47], a[216:219], v[184:187]
    v_mfma_f32_16x16x32_bf16 v[188:191], v[44:47], a[220:223], v[188:191]
    s_waitcnt vmcnt(25)
    s_waitcnt lgkmcnt(8)
    v_mfma_f32_16x16x32_bf16 v[64:67], v[48:51], a[224:227], v[64:67]
    ds_read_b64_tr_b16 v[44:45], v6 offset:41984
    v_mfma_f32_16x16x32_bf16 v[68:71], v[48:51], a[228:231], v[68:71]
    ds_read_b64_tr_b16 v[46:47], v6 offset:46080
    v_mfma_f32_16x16x32_bf16 v[72:75], v[48:51], a[232:235], v[72:75]
    buffer_store_dwordx4 v[208:211], v1, s[28:31], s38 offen offset:2048 sc1
    v_mfma_f32_16x16x32_bf16 v[76:79], v[48:51], a[236:239], v[76:79]
    s_waitcnt lgkmcnt(8)
    buffer_load_dwordx4 v5, s[20:23], s44 offen lds
    v_mfma_f32_16x16x32_bf16 v[80:83], v[52:55], a[224:227], v[80:83]
    ds_read_b64_tr_b16 v[48:49], v7 offset:40960
    s_add_u32 m0, s46, 40960
    v_mfma_f32_16x16x32_bf16 v[84:87], v[52:55], a[228:231], v[84:87]
    ds_read_b64_tr_b16 v[50:51], v7 offset:45056
    v_mfma_f32_16x16x32_bf16 v[88:91], v[52:55], a[232:235], v[88:91]
    buffer_load_dwordx4 v5, s[20:23], s18 offen lds
    v_mfma_f32_16x16x32_bf16 v[92:95], v[52:55], a[236:239], v[92:95]
    s_waitcnt lgkmcnt(8)
    v_mfma_f32_16x16x32_bf16 v[96:99], v[56:59], a[224:227], v[96:99]
    ds_read_b64_tr_b16 v[52:53], v7 offset:41984
    v_mfma_f32_16x16x32_bf16 v[100:103], v[56:59], a[228:231], v[100:103]
    ds_read_b64_tr_b16 v[54:55], v7 offset:46080
    v_mfma_f32_16x16x32_bf16 v[104:107], v[56:59], a[232:235], v[104:107]
    v_mfma_f32_16x16x32_bf16 v[108:111], v[56:59], a[236:239], v[108:111]
    s_waitcnt lgkmcnt(8)
    s_waitcnt vmcnt(26)
    s_barrier
    v_mfma_f32_16x16x32_bf16 v[112:115], v[60:63], a[224:227], v[112:115]
    ds_read_b64_tr_b16 v[56:57], v3 offset:49152
    v_mfma_f32_16x16x32_bf16 v[116:119], v[60:63], a[228:231], v[116:119]
    ds_read_b64_tr_b16 v[58:59], v3 offset:53248
    v_mfma_f32_16x16x32_bf16 v[120:123], v[60:63], a[232:235], v[120:123]
    buffer_load_dwordx4 v5, s[24:27], s18 offen offset:1024 lds
    v_mfma_f32_16x16x32_bf16 v[124:127], v[60:63], a[236:239], v[124:127]
    s_waitcnt lgkmcnt(8)
    s_add_u32 m0, s46, 32768
    v_mfma_f32_16x16x32_bf16 v[128:131], v[40:43], a[224:227], v[128:131]
    ds_read_b64_tr_b16 v[60:61], v3 offset:50176
    v_mfma_f32_16x16x32_bf16 v[132:135], v[40:43], a[228:231], v[132:135]
    ds_read_b64_tr_b16 v[62:63], v3 offset:54272
    v_mfma_f32_16x16x32_bf16 v[136:139], v[40:43], a[232:235], v[136:139]
    buffer_store_dwordx4 v[212:215], v1, s[28:31], s38 offen offset:3072 sc1
    v_mfma_f32_16x16x32_bf16 v[140:143], v[40:43], a[236:239], v[140:143]
    s_waitcnt lgkmcnt(8)
    buffer_load_dwordx4 v5, s[24:27], s44 offen offset:1024 lds
    v_mfma_f32_16x16x32_bf16 v[144:147], v[44:47], a[224:227], v[144:147]
    ds_read_b64_tr_b16 v[40:41], v4 offset:49152
    s_add_u32 s44, s44, 589824
    v_mfma_f32_16x16x32_bf16 v[148:151], v[44:47], a[228:231], v[148:151]
    ds_read_b64_tr_b16 v[42:43], v4 offset:53248
    s_add_u32 s18, s44, 64
    v_mfma_f32_16x16x32_bf16 v[152:155], v[44:47], a[232:235], v[152:155]
    s_add_u32 m0, s46, 49152
    v_mfma_f32_16x16x32_bf16 v[156:159], v[44:47], a[236:239], v[156:159]
    s_waitcnt lgkmcnt(8)
    v_mfma_f32_16x16x32_bf16 v[160:163], v[48:51], a[224:227], v[160:163]
    ds_read_b64_tr_b16 v[44:45], v4 offset:50176
    v_mfma_f32_16x16x32_bf16 v[164:167], v[48:51], a[228:231], v[164:167]
    ds_read_b64_tr_b16 v[46:47], v4 offset:54272
    v_mfma_f32_16x16x32_bf16 v[168:171], v[48:51], a[232:235], v[168:171]
    buffer_load_dwordx4 v5, s[20:23], s44 offen lds
    v_mfma_f32_16x16x32_bf16 v[172:175], v[48:51], a[236:239], v[172:175]
    s_waitcnt lgkmcnt(8)
    s_add_u32 m0, s46, 57344
    v_mfma_f32_16x16x32_bf16 v[176:179], v[52:55], a[224:227], v[176:179]
    ds_read_b64_tr_b16 v[48:49], v6 offset:49152
    v_mfma_f32_16x16x32_bf16 v[180:183], v[52:55], a[228:231], v[180:183]
    ds_read_b64_tr_b16 v[50:51], v6 offset:53248
    v_mfma_f32_16x16x32_bf16 v[184:187], v[52:55], a[232:235], v[184:187]
    buffer_load_dwordx4 v5, s[20:23], s18 offen lds
    v_mfma_f32_16x16x32_bf16 v[188:191], v[52:55], a[236:239], v[188:191]
    s_waitcnt vmcnt(27)
    s_waitcnt lgkmcnt(8)
    v_mfma_f32_16x16x32_bf16 v[64:67], v[56:59], a[240:243], v[64:67]
    ds_read_b64_tr_b16 v[52:53], v6 offset:50176
    v_mfma_f32_16x16x32_bf16 v[68:71], v[56:59], a[244:247], v[68:71]
    ds_read_b64_tr_b16 v[54:55], v6 offset:54272
    v_mfma_f32_16x16x32_bf16 v[72:75], v[56:59], a[248:251], v[72:75]
    buffer_store_dwordx4 v[216:219], v1, s[28:31], s39 offen offset:0 sc1
    v_mfma_f32_16x16x32_bf16 v[76:79], v[56:59], a[252:255], v[76:79]
    s_waitcnt lgkmcnt(8)
    v_mfma_f32_16x16x32_bf16 v[80:83], v[60:63], a[240:243], v[80:83]
    ds_read_b64_tr_b16 v[56:57], v7 offset:49152
    v_mfma_f32_16x16x32_bf16 v[84:87], v[60:63], a[244:247], v[84:87]
    ds_read_b64_tr_b16 v[58:59], v7 offset:53248
    v_mfma_f32_16x16x32_bf16 v[88:91], v[60:63], a[248:251], v[88:91]
    buffer_load_dwordx4 v5, s[24:27], s18 offen offset:1024 lds
    v_mfma_f32_16x16x32_bf16 v[92:95], v[60:63], a[252:255], v[92:95]
    s_waitcnt lgkmcnt(8)
    s_add_u32 m0, s46, 49152
    v_mfma_f32_16x16x32_bf16 v[96:99], v[40:43], a[240:243], v[96:99]
    ds_read_b64_tr_b16 v[60:61], v7 offset:50176
    v_mfma_f32_16x16x32_bf16 v[100:103], v[40:43], a[244:247], v[100:103]
    ds_read_b64_tr_b16 v[62:63], v7 offset:54272
    v_mfma_f32_16x16x32_bf16 v[104:107], v[40:43], a[248:251], v[104:107]
    buffer_load_dwordx4 v5, s[24:27], s44 offen offset:1024 lds
    v_mfma_f32_16x16x32_bf16 v[108:111], v[40:43], a[252:255], v[108:111]
    s_waitcnt lgkmcnt(8)
    s_waitcnt vmcnt(27)
    s_barrier
    v_mfma_f32_16x16x32_bf16 v[112:115], v[44:47], a[240:243], v[112:115]
    ds_read_b128 v[40:43], v238 offset:57344
    s_add_u32 s44, s44, 589824
    v_mfma_f32_16x16x32_bf16 v[116:119], v[44:47], a[244:247], v[116:119]
    s_add_u32 s18, s44, 64
    s_add_u32 m0, s46, 65536
    v_mfma_f32_16x16x32_bf16 v[120:123], v[44:47], a[248:251], v[120:123]
    v_mfma_f32_16x16x32_bf16 v[124:127], v[44:47], a[252:255], v[124:127]
    s_waitcnt lgkmcnt(7)
    v_mfma_f32_16x16x32_bf16 v[128:131], v[48:51], a[240:243], v[128:131]
    ds_read_b128 v[44:47], v238 offset:58368
    v_mfma_f32_16x16x32_bf16 v[132:135], v[48:51], a[244:247], v[132:135]
    buffer_load_dwordx4 v5, s[20:23], s44 offen lds
    v_mfma_f32_16x16x32_bf16 v[136:139], v[48:51], a[248:251], v[136:139]
    s_add_u32 m0, s46, 73728
    v_mfma_f32_16x16x32_bf16 v[140:143], v[48:51], a[252:255], v[140:143]
    s_waitcnt lgkmcnt(6)
    v_mfma_f32_16x16x32_bf16 v[144:147], v[52:55], a[240:243], v[144:147]
    ds_read_b128 v[48:51], v238 offset:59392
    v_mfma_f32_16x16x32_bf16 v[148:151], v[52:55], a[244:247], v[148:151]
    buffer_load_dwordx4 v5, s[20:23], s18 offen lds
    v_mfma_f32_16x16x32_bf16 v[152:155], v[52:55], a[248:251], v[152:155]
    v_mfma_f32_16x16x32_bf16 v[156:159], v[52:55], a[252:255], v[156:159]
    s_waitcnt lgkmcnt(5)
    v_mfma_f32_16x16x32_bf16 v[160:163], v[56:59], a[240:243], v[160:163]
    ds_read_b128 v[52:55], v238 offset:60416
    v_mfma_f32_16x16x32_bf16 v[164:167], v[56:59], a[244:247], v[164:167]
    v_mfma_f32_16x16x32_bf16 v[168:171], v[56:59], a[248:251], v[168:171]
    v_mfma_f32_16x16x32_bf16 v[172:175], v[56:59], a[252:255], v[172:175]
    s_waitcnt lgkmcnt(4)
    v_mfma_f32_16x16x32_bf16 v[176:179], v[60:63], a[240:243], v[176:179]
    ds_read_b128 v[56:59], v238 offset:61440
    v_mfma_f32_16x16x32_bf16 v[180:183], v[60:63], a[244:247], v[180:183]
    buffer_load_dwordx4 v5, s[24:27], s18 offen offset:1024 lds
    v_mfma_f32_16x16x32_bf16 v[184:187], v[60:63], a[248:251], v[184:187]
    s_add_u32 m0, s46, 65536
    v_mfma_f32_16x16x32_bf16 v[188:191], v[60:63], a[252:255], v[188:191]
    s_waitcnt lgkmcnt(3)
    buffer_load_dwordx4 v5, s[24:27], s44 offen offset:1024 lds
    v_mfma_f32_16x16x32_bf16 v[192:195], v[40:43], v[8:11], 0
    ds_read_b128 v[60:63], v238 offset:62464
    s_add_u32 s44, s44, 589824
    v_mfma_f32_16x16x32_bf16 v[196:199], v[40:43], v[12:15], 0
    s_add_u32 s18, s44, 64
    s_add_u32 m0, s46, 81920
    v_mfma_f32_16x16x32_bf16 v[200:203], v[40:43], v[16:19], 0
    v_mfma_f32_16x16x32_bf16 v[204:207], v[40:43], v[20:23], 0
    v_mfma_f32_16x16x32_bf16 v[208:211], v[44:47], v[8:11], 0
    ds_read_b128 v[40:43], v238 offset:63488
    v_mfma_f32_16x16x32_bf16 v[212:215], v[44:47], v[12:15], 0
    v_mfma_f32_16x16x32_bf16 v[216:219], v[44:47], v[16:19], 0
    buffer_load_dwordx4 v5, s[20:23], s44 offen lds
    v_mfma_f32_16x16x32_bf16 v[220:223], v[44:47], v[20:23], 0
    s_waitcnt lgkmcnt(3)
    s_add_u32 m0, s46, 90112
    v_mfma_f32_16x16x32_bf16 v[192:195], v[48:51], v[24:27], v[192:195]
    ds_read_b128 v[44:47], v238 offset:64512
    v_max_f32 v64, 0, v64
    v_mfma_f32_16x16x32_bf16 v[196:199], v[48:51], v[28:31], v[196:199]
    buffer_load_dwordx4 v5, s[20:23], s18 offen lds
    v_mfma_f32_16x16x32_bf16 v[200:203], v[48:51], v[32:35], v[200:203]
    v_max_f32 v65, 0, v65
    v_max_f32 v66, 0, v66
    v_mfma_f32_16x16x32_bf16 v[204:207], v[48:51], v[36:39], v[204:207]
    v_max_f32 v67, 0, v67
    v_mul_f32 v64, v64, v80
    v_mfma_f32_16x16x32_bf16 v[208:211], v[52:55], v[24:27], v[208:211]
    ds_read_b128 v[48:51], v239 offset:0
    v_mul_f32 v65, v65, v81
    v_mfma_f32_16x16x32_bf16 v[212:215], v[52:55], v[28:31], v[212:215]
    v_mul_f32 v66, v66, v82
    v_mul_f32 v67, v67, v83
    v_mfma_f32_16x16x32_bf16 v[216:219], v[52:55], v[32:35], v[216:219]
    v_max_f32 v96, 0, v96
    v_max_f32 v97, 0, v97
    v_mfma_f32_16x16x32_bf16 v[220:223], v[52:55], v[36:39], v[220:223]
    s_waitcnt lgkmcnt(3)
    v_max_f32 v98, 0, v98
    v_max_f32 v99, 0, v99
    v_mfma_f32_16x16x32_bf16 v[192:195], v[56:59], a[0:3], v[192:195]
    ds_read_b128 v[52:55], v239 offset:1024
    v_mul_f32 v96, v96, v112
    v_mfma_f32_16x16x32_bf16 v[196:199], v[56:59], a[4:7], v[196:199]
    buffer_load_dwordx4 v5, s[24:27], s18 offen offset:1024 lds
    v_mfma_f32_16x16x32_bf16 v[200:203], v[56:59], a[8:11], v[200:203]
    s_add_u32 m0, s46, 81920
    v_mul_f32 v97, v97, v113
    v_mul_f32 v98, v98, v114
    v_mfma_f32_16x16x32_bf16 v[204:207], v[56:59], a[12:15], v[204:207]
    buffer_load_dwordx4 v5, s[24:27], s44 offen offset:1024 lds
    v_mfma_f32_16x16x32_bf16 v[208:211], v[60:63], a[0:3], v[208:211]
    ds_read_b128 v[56:59], v239 offset:2048
    s_add_u32 s44, s44, 589824
    v_mfma_f32_16x16x32_bf16 v[212:215], v[60:63], a[4:7], v[212:215]
    s_add_u32 s18, s44, 64
    s_add_u32 m0, s46, 98304
    v_mul_f32 v99, v99, v115
    v_mfma_f32_16x16x32_bf16 v[216:219], v[60:63], a[8:11], v[216:219]
    s_add_u32 s19, s42, 0
    v_cvt_pk_bf16_f32 v80, v64, v65
    v_cvt_pk_bf16_f32 v81, v66, v67
    v_mfma_f32_16x16x32_bf16 v[220:223], v[60:63], a[12:15], v[220:223]
    s_waitcnt lgkmcnt(3)
    v_cvt_pk_bf16_f32 v82, v96, v97
    v_cvt_pk_bf16_f32 v83, v98, v99
    v_mfma_f32_16x16x32_bf16 v[192:195], v[40:43], a[16:19], v[192:195]
    ds_read_b128 v[60:63], v239 offset:3072
    v_mfma_f32_16x16x32_bf16 v[196:199], v[40:43], a[20:23], v[196:199]
    buffer_store_dwordx4 v[80:83], v1, s[28:31], s19 offen sc1
    v_mfma_f32_16x16x32_bf16 v[200:203], v[40:43], a[24:27], v[200:203]
    v_max_f32 v68, 0, v68
    v_max_f32 v69, 0, v69
    v_mfma_f32_16x16x32_bf16 v[204:207], v[40:43], a[28:31], v[204:207]
    s_waitcnt vmcnt(33)
    s_barrier
    v_max_f32 v70, 0, v70
    v_mfma_f32_16x16x32_bf16 v[208:211], v[44:47], a[16:19], v[208:211]
    ds_read_b128 v[40:43], v239 offset:4096
    v_max_f32 v71, 0, v71
    v_mfma_f32_16x16x32_bf16 v[212:215], v[44:47], a[20:23], v[212:215]
    buffer_load_dwordx4 v5, s[20:23], s44 offen lds
    v_mfma_f32_16x16x32_bf16 v[216:219], v[44:47], a[24:27], v[216:219]
    s_add_u32 m0, s46, 106496
    v_mul_f32 v68, v68, v84
    v_mul_f32 v69, v69, v85
    v_mfma_f32_16x16x32_bf16 v[220:223], v[44:47], a[28:31], v[220:223]
    s_waitcnt lgkmcnt(3)
    v_mul_f32 v70, v70, v86
    v_mul_f32 v71, v71, v87
    v_mfma_f32_16x16x32_bf16 v[192:195], v[48:51], a[32:35], v[192:195]
    ds_read_b128 v[44:47], v239 offset:5120
    v_max_f32 v100, 0, v100
    v_mfma_f32_16x16x32_bf16 v[196:199], v[48:51], a[36:39], v[196:199]
    buffer_load_dwordx4 v5, s[20:23], s18 offen lds
    v_mfma_f32_16x16x32_bf16 v[200:203], v[48:51], a[40:43], v[200:203]
    v_max_f32 v101, 0, v101
    v_max_f32 v102, 0, v102
    v_mfma_f32_16x16x32_bf16 v[204:207], v[48:51], a[44:47], v[204:207]
    v_max_f32 v103, 0, v103
    v_mul_f32 v100, v100, v116
    v_mfma_f32_16x16x32_bf16 v[208:211], v[52:55], a[32:35], v[208:211]
    ds_read_b128 v[48:51], v239 offset:6144
    v_mul_f32 v101, v101, v117
    v_mfma_f32_16x16x32_bf16 v[212:215], v[52:55], a[36:39], v[212:215]
    v_mul_f32 v102, v102, v118
    v_mul_f32 v103, v103, v119
    v_mfma_f32_16x16x32_bf16 v[216:219], v[52:55], a[40:43], v[216:219]
    s_add_u32 s19, s42, 147456
    v_cvt_pk_bf16_f32 v84, v68, v69
    v_cvt_pk_bf16_f32 v85, v70, v71
    v_mfma_f32_16x16x32_bf16 v[220:223], v[52:55], a[44:47], v[220:223]
    s_waitcnt lgkmcnt(3)
    v_cvt_pk_bf16_f32 v86, v100, v101
    v_cvt_pk_bf16_f32 v87, v102, v103
    v_mfma_f32_16x16x32_bf16 v[192:195], v[56:59], a[48:51], v[192:195]
    ds_read_b128 v[52:55], v239 offset:7168
    v_mfma_f32_16x16x32_bf16 v[196:199], v[56:59], a[52:55], v[196:199]
    buffer_store_dwordx4 v[84:87], v1, s[28:31], s19 offen sc1
    v_mfma_f32_16x16x32_bf16 v[200:203], v[56:59], a[56:59], v[200:203]
    buffer_load_dwordx4 v5, s[24:27], s18 offen offset:1024 lds
    v_mfma_f32_16x16x32_bf16 v[204:207], v[56:59], a[60:63], v[204:207]
    s_add_u32 m0, s46, 98304
    v_max_f32 v72, 0, v72
    v_max_f32 v73, 0, v73
    v_mfma_f32_16x16x32_bf16 v[208:211], v[60:63], a[48:51], v[208:211]
    ds_read_b128 v[56:59], v239 offset:8192
    v_max_f32 v74, 0, v74
    v_mfma_f32_16x16x32_bf16 v[212:215], v[60:63], a[52:55], v[212:215]
    buffer_load_dwordx4 v5, s[24:27], s44 offen offset:1024 lds
    v_mfma_f32_16x16x32_bf16 v[216:219], v[60:63], a[56:59], v[216:219]
    v_max_f32 v75, 0, v75
    v_mul_f32 v72, v72, v88
    v_mfma_f32_16x16x32_bf16 v[220:223], v[60:63], a[60:63], v[220:223]
    s_waitcnt lgkmcnt(3)
    v_mul_f32 v73, v73, v89
    v_mul_f32 v74, v74, v90
    v_mfma_f32_16x16x32_bf16 v[192:195], v[40:43], a[64:67], v[192:195]
    ds_read_b128 v[60:63], v239 offset:9216
    v_mul_f32 v75, v75, v91
    v_mfma_f32_16x16x32_bf16 v[196:199], v[40:43], a[68:71], v[196:199]
    v_max_f32 v104, 0, v104
    v_max_f32 v105, 0, v105
    v_mfma_f32_16x16x32_bf16 v[200:203], v[40:43], a[72:75], v[200:203]
    v_max_f32 v106, 0, v106
    v_max_f32 v107, 0, v107
    v_mfma_f32_16x16x32_bf16 v[204:207], v[40:43], a[76:79], v[204:207]
    v_mul_f32 v104, v104, v120
    v_mul_f32 v105, v105, v121
    v_mfma_f32_16x16x32_bf16 v[208:211], v[44:47], a[64:67], v[208:211]
    ds_read_b128 v[40:43], v239 offset:10240
    v_mul_f32 v106, v106, v122
    v_mfma_f32_16x16x32_bf16 v[212:215], v[44:47], a[68:71], v[212:215]
    v_mul_f32 v107, v107, v123
    s_add_u32 s19, s42, 294912
    v_mfma_f32_16x16x32_bf16 v[216:219], v[44:47], a[72:75], v[216:219]
    v_cvt_pk_bf16_f32 v88, v72, v73
    v_cvt_pk_bf16_f32 v89, v74, v75
    v_mfma_f32_16x16x32_bf16 v[220:223], v[44:47], a[76:79], v[220:223]
    s_waitcnt lgkmcnt(3)
    v_cvt_pk_bf16_f32 v90, v104, v105
    v_cvt_pk_bf16_f32 v91, v106, v107
    v_mfma_f32_16x16x32_bf16 v[192:195], v[48:51], a[80:83], v[192:195]
    ds_read_b128 v[44:47], v239 offset:11264
    v_mfma_f32_16x16x32_bf16 v[196:199], v[48:51], a[84:87], v[196:199]
    buffer_store_dwordx4 v[88:91], v1, s[28:31], s19 offen sc1
    v_mfma_f32_16x16x32_bf16 v[200:203], v[48:51], a[88:91], v[200:203]
    v_max_f32 v76, 0, v76
    v_max_f32 v77, 0, v77
    v_mfma_f32_16x16x32_bf16 v[204:207], v[48:51], a[92:95], v[204:207]
    v_max_f32 v78, 0, v78
    v_max_f32 v79, 0, v79
    v_mfma_f32_16x16x32_bf16 v[208:211], v[52:55], a[80:83], v[208:211]
    ds_read_b128 v[48:51], v239 offset:12288
    v_mul_f32 v76, v76, v92
    v_mfma_f32_16x16x32_bf16 v[212:215], v[52:55], a[84:87], v[212:215]
    v_mul_f32 v77, v77, v93
    v_mul_f32 v78, v78, v94
    v_mfma_f32_16x16x32_bf16 v[216:219], v[52:55], a[88:91], v[216:219]
    v_mul_f32 v79, v79, v95
    v_max_f32 v108, 0, v108
    v_mfma_f32_16x16x32_bf16 v[220:223], v[52:55], a[92:95], v[220:223]
    s_waitcnt lgkmcnt(3)
    v_max_f32 v109, 0, v109
    v_max_f32 v110, 0, v110
    v_mfma_f32_16x16x32_bf16 v[192:195], v[56:59], a[96:99], v[192:195]
    ds_read_b128 v[52:55], v239 offset:13312
    v_max_f32 v111, 0, v111
    v_mfma_f32_16x16x32_bf16 v[196:199], v[56:59], a[100:103], v[196:199]
    v_mul_f32 v108, v108, v124
    v_mul_f32 v109, v109, v125
    v_mfma_f32_16x16x32_bf16 v[200:203], v[56:59], a[104:107], v[200:203]
    v_mul_f32 v110, v110, v126
    v_mul_f32 v111, v111, v127
    v_mfma_f32_16x16x32_bf16 v[204:207], v[56:59], a[108:111], v[204:207]
    s_add_u32 s19, s42, 442368
    v_cvt_pk_bf16_f32 v92, v76, v77
    v_cvt_pk_bf16_f32 v93, v78, v79
    v_mfma_f32_16x16x32_bf16 v[208:211], v[60:63], a[96:99], v[208:211]
    ds_read_b128 v[56:59], v239 offset:14336
    v_cvt_pk_bf16_f32 v94, v108, v109
    v_mfma_f32_16x16x32_bf16 v[212:215], v[60:63], a[100:103], v[212:215]
    v_cvt_pk_bf16_f32 v95, v110, v111
    v_mfma_f32_16x16x32_bf16 v[216:219], v[60:63], a[104:107], v[216:219]
    v_mfma_f32_16x16x32_bf16 v[220:223], v[60:63], a[108:111], v[220:223]
    s_waitcnt lgkmcnt(3)
    v_mfma_f32_16x16x32_bf16 v[192:195], v[40:43], a[112:115], v[192:195]
    ds_read_b128 v[60:63], v239 offset:15360
    v_mfma_f32_16x16x32_bf16 v[196:199], v[40:43], a[116:119], v[196:199]
    buffer_store_dwordx4 v[92:95], v1, s[28:31], s19 offen sc1
    v_mfma_f32_16x16x32_bf16 v[200:203], v[40:43], a[120:123], v[200:203]
    v_max_f32 v128, 0, v128
    v_max_f32 v129, 0, v129
    v_mfma_f32_16x16x32_bf16 v[204:207], v[40:43], a[124:127], v[204:207]
    s_waitcnt vmcnt(37)
    s_barrier
    v_max_f32 v130, 0, v130
    v_mfma_f32_16x16x32_bf16 v[208:211], v[44:47], a[112:115], v[208:211]
    ds_read_b128 v[40:43], v239 offset:16384
    s_add_u32 s44, s44, 589824
    v_mfma_f32_16x16x32_bf16 v[212:215], v[44:47], a[116:119], v[212:215]
    s_add_u32 s18, s44, 64
    s_add_u32 m0, s46, 114688
    v_max_f32 v131, 0, v131
    v_mfma_f32_16x16x32_bf16 v[216:219], v[44:47], a[120:123], v[216:219]
    buffer_load_dwordx4 v5, s[20:23], s44 offen lds
    v_mfma_f32_16x16x32_bf16 v[220:223], v[44:47], a[124:127], v[220:223]
    s_waitcnt lgkmcnt(3)
    s_add_u32 m0, s46, 122880
    v_mul_f32 v128, v128, v144
    v_mfma_f32_16x16x32_bf16 v[192:195], v[48:51], a[128:131], v[192:195]
    ds_read_b128 v[44:47], v239 offset:17408
    v_mul_f32 v129, v129, v145
    v_mfma_f32_16x16x32_bf16 v[196:199], v[48:51], a[132:135], v[196:199]
    buffer_load_dwordx4 v5, s[20:23], s18 offen lds
    v_mfma_f32_16x16x32_bf16 v[200:203], v[48:51], a[136:139], v[200:203]
    v_mul_f32 v130, v130, v146
    v_mul_f32 v131, v131, v147
    v_mfma_f32_16x16x32_bf16 v[204:207], v[48:51], a[140:143], v[204:207]
    v_max_f32 v160, 0, v160
    v_max_f32 v161, 0, v161
    v_mfma_f32_16x16x32_bf16 v[208:211], v[52:55], a[128:131], v[208:211]
    ds_read_b128 v[48:51], v239 offset:18432
    v_max_f32 v162, 0, v162
    v_mfma_f32_16x16x32_bf16 v[212:215], v[52:55], a[132:135], v[212:215]
    v_max_f32 v163, 0, v163
    v_mul_f32 v160, v160, v176
    v_mfma_f32_16x16x32_bf16 v[216:219], v[52:55], a[136:139], v[216:219]
    v_mul_f32 v161, v161, v177
    v_mul_f32 v162, v162, v178
    v_mfma_f32_16x16x32_bf16 v[220:223], v[52:55], a[140:143], v[220:223]
    s_waitcnt lgkmcnt(3)
    v_mul_f32 v163, v163, v179
    s_add_u32 s19, s42, 1024
    v_mfma_f32_16x16x32_bf16 v[192:195], v[56:59], a[144:147], v[192:195]
    ds_read_b128 v[52:55], v239 offset:19456
    v_cvt_pk_bf16_f32 v144, v128, v129
    v_mfma_f32_16x16x32_bf16 v[196:199], v[56:59], a[148:151], v[196:199]
    buffer_load_dwordx4 v5, s[24:27], s18 offen offset:1024 lds
    v_mfma_f32_16x16x32_bf16 v[200:203], v[56:59], a[152:155], v[200:203]
    s_add_u32 m0, s46, 114688
    v_cvt_pk_bf16_f32 v145, v130, v131
    v_cvt_pk_bf16_f32 v146, v160, v161
    v_mfma_f32_16x16x32_bf16 v[204:207], v[56:59], a[156:159], v[204:207]
    buffer_load_dwordx4 v5, s[24:27], s44 offen offset:1024 lds
    v_mfma_f32_16x16x32_bf16 v[208:211], v[60:63], a[144:147], v[208:211]
    ds_read_b128 v[56:59], v239 offset:20480
    v_cvt_pk_bf16_f32 v147, v162, v163
    v_mfma_f32_16x16x32_bf16 v[212:215], v[60:63], a[148:151], v[212:215]
    buffer_store_dwordx4 v[144:147], v1, s[28:31], s19 offen sc1
    v_mfma_f32_16x16x32_bf16 v[216:219], v[60:63], a[152:155], v[216:219]
    v_max_f32 v132, 0, v132
    v_max_f32 v133, 0, v133
    v_mfma_f32_16x16x32_bf16 v[220:223], v[60:63], a[156:159], v[220:223]
    s_waitcnt lgkmcnt(3)
    v_max_f32 v134, 0, v134
    v_max_f32 v135, 0, v135
    v_mfma_f32_16x16x32_bf16 v[192:195], v[40:43], a[160:163], v[192:195]
    ds_read_b128 v[60:63], v239 offset:21504
    v_mul_f32 v132, v132, v148
    v_mfma_f32_16x16x32_bf16 v[196:199], v[40:43], a[164:167], v[196:199]
    v_mul_f32 v133, v133, v149
    v_mul_f32 v134, v134, v150
    v_mfma_f32_16x16x32_bf16 v[200:203], v[40:43], a[168:171], v[200:203]
    v_mul_f32 v135, v135, v151
    v_max_f32 v164, 0, v164
    v_mfma_f32_16x16x32_bf16 v[204:207], v[40:43], a[172:175], v[204:207]
    v_max_f32 v165, 0, v165
    v_max_f32 v166, 0, v166
    v_mfma_f32_16x16x32_bf16 v[208:211], v[44:47], a[160:163], v[208:211]
    ds_read_b128 v[40:43], v239 offset:22528
    v_max_f32 v167, 0, v167
    v_mfma_f32_16x16x32_bf16 v[212:215], v[44:47], a[164:167], v[212:215]
    v_mul_f32 v164, v164, v180
    v_mul_f32 v165, v165, v181
    v_mfma_f32_16x16x32_bf16 v[216:219], v[44:47], a[168:171], v[216:219]
    v_mul_f32 v166, v166, v182
    v_mul_f32 v167, v167, v183
    v_mfma_f32_16x16x32_bf16 v[220:223], v[44:47], a[172:175], v[220:223]
    s_waitcnt lgkmcnt(3)
    s_add_u32 s19, s42, 148480
    v_cvt_pk_bf16_f32 v148, v132, v133
    v_mfma_f32_16x16x32_bf16 v[192:195], v[48:51], a[176:179], v[192:195]
    ds_read_b128 v[44:47], v239 offset:23552
    v_cvt_pk_bf16_f32 v149, v134, v135
    v_mfma_f32_16x16x32_bf16 v[196:199], v[48:51], a[180:183], v[196:199]
    v_cvt_pk_bf16_f32 v150, v164, v165
    v_cvt_pk_bf16_f32 v151, v166, v167
    v_mfma_f32_16x16x32_bf16 v[200:203], v[48:51], a[184:187], v[200:203]
    v_mfma_f32_16x16x32_bf16 v[204:207], v[48:51], a[188:191], v[204:207]
    v_mfma_f32_16x16x32_bf16 v[208:211], v[52:55], a[176:179], v[208:211]
    ds_read_b128 v[48:51], v239 offset:24576
    v_mfma_f32_16x16x32_bf16 v[212:215], v[52:55], a[180:183], v[212:215]
    buffer_store_dwordx4 v[148:151], v1, s[28:31], s19 offen sc1
    v_mfma_f32_16x16x32_bf16 v[216:219], v[52:55], a[184:187], v[216:219]
    v_max_f32 v136, 0, v136
    v_max_f32 v137, 0, v137
    v_mfma_f32_16x16x32_bf16 v[220:223], v[52:55], a[188:191], v[220:223]
    s_waitcnt lgkmcnt(3)
    v_max_f32 v138, 0, v138
    v_max_f32 v139, 0, v139
    v_mfma_f32_16x16x32_bf16 v[192:195], v[56:59], a[192:195], v[192:195]
    ds_read_b128 v[52:55], v239 offset:25600
    v_mul_f32 v136, v136, v152
    v_mfma_f32_16x16x32_bf16 v[196:199], v[56:59], a[196:199], v[196:199]
    v_mul_f32 v137, v137, v153
    v_mul_f32 v138, v138, v154
    v_mfma_f32_16x16x32_bf16 v[200:203], v[56:59], a[200:203], v[200:203]
    v_mul_f32 v139, v139, v155
    v_max_f32 v168, 0, v168
    v_mfma_f32_16x16x32_bf16 v[204:207], v[56:59], a[204:207], v[204:207]
    v_max_f32 v169, 0, v169
    v_max_f32 v170, 0, v170
    v_mfma_f32_16x16x32_bf16 v[208:211], v[60:63], a[192:195], v[208:211]
    ds_read_b128 v[56:59], v239 offset:26624
    v_max_f32 v171, 0, v171
    v_mfma_f32_16x16x32_bf16 v[212:215], v[60:63], a[196:199], v[212:215]
    v_mul_f32 v168, v168, v184
    v_mul_f32 v169, v169, v185
    v_mfma_f32_16x16x32_bf16 v[216:219], v[60:63], a[200:203], v[216:219]
    v_mul_f32 v170, v170, v186
    v_mul_f32 v171, v171, v187
    v_mfma_f32_16x16x32_bf16 v[220:223], v[60:63], a[204:207], v[220:223]
    s_waitcnt lgkmcnt(3)
    s_add_u32 s19, s42, 295936
    v_cvt_pk_bf16_f32 v152, v136, v137
    v_mfma_f32_16x16x32_bf16 v[192:195], v[40:43], a[208:211], v[192:195]
    ds_read_b128 v[60:63], v239 offset:27648
    v_cvt_pk_bf16_f32 v153, v138, v139
    v_mfma_f32_16x16x32_bf16 v[196:199], v[40:43], a[212:215], v[196:199]
    v_cvt_pk_bf16_f32 v154, v168, v169
    v_cvt_pk_bf16_f32 v155, v170, v171
    v_mfma_f32_16x16x32_bf16 v[200:203], v[40:43], a[216:219], v[200:203]
    v_mfma_f32_16x16x32_bf16 v[204:207], v[40:43], a[220:223], v[204:207]
    s_waitcnt vmcnt(38)
    s_barrier
    v_mfma_f32_16x16x32_bf16 v[208:211], v[44:47], a[208:211], v[208:211]
    ds_read_b64_tr_b16 v[40:41], v229 offset:0
    s_add_u32 s44, s44, 589824
    v_mfma_f32_16x16x32_bf16 v[212:215], v[44:47], a[212:215], v[212:215]
    ds_read_b64_tr_b16 v[42:43], v229 offset:2048
    s_add_u32 s18, s44, 64
    v_mfma_f32_16x16x32_bf16 v[216:219], v[44:47], a[216:219], v[216:219]
    buffer_store_dwordx4 v[152:155], v1, s[28:31], s19 offen sc1
    v_mfma_f32_16x16x32_bf16 v[220:223], v[44:47], a[220:223], v[220:223]
    s_waitcnt lgkmcnt(4)
    s_add_u32 m0, s46, 131072
    v_max_f32 v140, 0, v140
    v_mfma_f32_16x16x32_bf16 v[192:195], v[48:51], a[224:227], v[192:195]
    ds_read_b64_tr_b16 v[44:45], v229 offset:1024
    v_max_f32 v141, 0, v141
    v_mfma_f32_16x16x32_bf16 v[196:199], v[48:51], a[228:231], v[196:199]
    ds_read_b64_tr_b16 v[46:47], v229 offset:3072
    v_max_f32 v142, 0, v142
    v_mfma_f32_16x16x32_bf16 v[200:203], v[48:51], a[232:235], v[200:203]
    buffer_load_dwordx4 v5, s[20:23], s44 offen lds
    v_mfma_f32_16x16x32_bf16 v[204:207], v[48:51], a[236:239], v[204:207]
    s_add_u32 m0, s46, 139264
    v_max_f32 v143, 0, v143
    v_mul_f32 v140, v140, v156
    v_mfma_f32_16x16x32_bf16 v[208:211], v[52:55], a[224:227], v[208:211]
    ds_read_b64_tr_b16 v[48:49], v230 offset:0
    v_mul_f32 v141, v141, v157
    v_mfma_f32_16x16x32_bf16 v[212:215], v[52:55], a[228:231], v[212:215]
    ds_read_b64_tr_b16 v[50:51], v230 offset:2048
    v_mul_f32 v142, v142, v158
    v_mfma_f32_16x16x32_bf16 v[216:219], v[52:55], a[232:235], v[216:219]
    buffer_load_dwordx4 v5, s[20:23], s18 offen lds
    v_mfma_f32_16x16x32_bf16 v[220:223], v[52:55], a[236:239], v[220:223]
    s_waitcnt lgkmcnt(6)
    v_mul_f32 v143, v143, v159
    v_max_f32 v172, 0, v172
    v_mfma_f32_16x16x32_bf16 v[192:195], v[56:59], a[240:243], v[192:195]
    ds_read_b64_tr_b16 v[52:53], v230 offset:1024
    v_max_f32 v173, 0, v173
    v_mfma_f32_16x16x32_bf16 v[196:199], v[56:59], a[244:247], v[196:199]
    ds_read_b64_tr_b16 v[54:55], v230 offset:3072
    v_max_f32 v174, 0, v174
    v_mfma_f32_16x16x32_bf16 v[200:203], v[56:59], a[248:251], v[200:203]
    v_max_f32 v175, 0, v175
    v_mul_f32 v172, v172, v188
    v_mfma_f32_16x16x32_bf16 v[204:207], v[56:59], a[252:255], v[204:207]
    v_mul_f32 v173, v173, v189
    v_mul_f32 v174, v174, v190
    v_mfma_f32_16x16x32_bf16 v[208:211], v[60:63], a[240:243], v[208:211]
    ds_read_b64_tr_b16 v[56:57], v229 offset:4096
    v_mul_f32 v175, v175, v191
    v_mfma_f32_16x16x32_bf16 v[212:215], v[60:63], a[244:247], v[212:215]
    ds_read_b64_tr_b16 v[58:59], v229 offset:6144
    s_add_u32 s19, s42, 443392
    v_mfma_f32_16x16x32_bf16 v[216:219], v[60:63], a[248:251], v[216:219]
    buffer_load_dwordx4 v5, s[24:27], s18 offen offset:1024 lds
    v_mfma_f32_16x16x32_bf16 v[220:223], v[60:63], a[252:255], v[220:223]
    s_waitcnt lgkmcnt(8)
    s_add_u32 m0, s46, 131072
    v_cvt_pk_bf16_f32 v156, v140, v141
    v_mfma_f32_16x16x32_bf16 v[64:67], v[40:43], v[8:11], 0
    ds_read_b64_tr_b16 v[60:61], v229 offset:5120
    v_cvt_pk_bf16_f32 v157, v142, v143
    v_mfma_f32_16x16x32_bf16 v[68:71], v[40:43], v[12:15], 0
    ds_read_b64_tr_b16 v[62:63], v229 offset:7168
    v_cvt_pk_bf16_f32 v158, v172, v173
    v_mfma_f32_16x16x32_bf16 v[72:75], v[40:43], v[16:19], 0
    buffer_load_dwordx4 v5, s[24:27], s44 offen offset:1024 lds
    v_mfma_f32_16x16x32_bf16 v[76:79], v[40:43], v[20:23], 0
    s_waitcnt lgkmcnt(8)
    s_add_u32 m0, s47, 147456
    v_cvt_pk_bf16_f32 v159, v174, v175
    v_mfma_f32_16x16x32_bf16 v[80:83], v[44:47], v[8:11], 0
    ds_read_b64_tr_b16 v[40:41], v230 offset:4096
    v_mfma_f32_16x16x32_bf16 v[84:87], v[44:47], v[12:15], 0
    ds_read_b64_tr_b16 v[42:43], v230 offset:6144
    v_mfma_f32_16x16x32_bf16 v[88:91], v[44:47], v[16:19], 0
    buffer_store_dwordx4 v[156:159], v1, s[28:31], s19 offen sc1
    v_mfma_f32_16x16x32_bf16 v[92:95], v[44:47], v[20:23], 0
    s_waitcnt lgkmcnt(8)
    v_mfma_f32_16x16x32_bf16 v[96:99], v[48:51], v[8:11], 0
    ds_read_b64_tr_b16 v[44:45], v230 offset:5120
    v_max_f32 v192, 0, v192
    v_mfma_f32_16x16x32_bf16 v[100:103], v[48:51], v[12:15], 0
    ds_read_b64_tr_b16 v[46:47], v230 offset:7168
    v_max_f32 v193, 0, v193
    v_mfma_f32_16x16x32_bf16 v[104:107], v[48:51], v[16:19], 0
    buffer_load_dwordx4 v1, s[28:31], s41 offen sc1 lds
    v_mfma_f32_16x16x32_bf16 v[108:111], v[48:51], v[20:23], 0
    s_waitcnt lgkmcnt(8)
    s_waitcnt vmcnt(34)
    s_barrier
    v_mfma_f32_16x16x32_bf16 v[112:115], v[52:55], v[8:11], 0
    ds_read_b64_tr_b16 v[48:49], v229 offset:16384
    s_add_u32 s41, s41, 4096
    v_mfma_f32_16x16x32_bf16 v[116:119], v[52:55], v[12:15], 0
    ds_read_b64_tr_b16 v[50:51], v229 offset:18432
    s_add_u32 m0, s47, 159744
    v_mfma_f32_16x16x32_bf16 v[120:123], v[52:55], v[16:19], 0
    buffer_load_dwordx4 v1, s[28:31], s41 offen sc1 lds
    v_mfma_f32_16x16x32_bf16 v[124:127], v[52:55], v[20:23], 0
    s_waitcnt lgkmcnt(8)
    s_add_u32 s41, s41, 4096
    s_add_u32 m0, s47, 151552
    v_mfma_f32_16x16x32_bf16 v[64:67], v[56:59], v[24:27], v[64:67]
    ds_read_b64_tr_b16 v[52:53], v229 offset:17408
    v_max_f32 v194, 0, v194
    v_mfma_f32_16x16x32_bf16 v[68:71], v[56:59], v[28:31], v[68:71]
    ds_read_b64_tr_b16 v[54:55], v229 offset:19456
    v_max_f32 v195, 0, v195
    v_mfma_f32_16x16x32_bf16 v[72:75], v[56:59], v[32:35], v[72:75]
    buffer_load_dwordx4 v1, s[28:31], s41 offen sc1 lds
    v_mfma_f32_16x16x32_bf16 v[76:79], v[56:59], v[36:39], v[76:79]
    s_waitcnt lgkmcnt(8)
    s_add_u32 s41, s41, 4096
    s_add_u32 m0, s47, 155648
    v_mfma_f32_16x16x32_bf16 v[80:83], v[60:63], v[24:27], v[80:83]
    ds_read_b64_tr_b16 v[56:57], v230 offset:16384
    v_mul_f32 v192, v192, v208
    v_mfma_f32_16x16x32_bf16 v[84:87], v[60:63], v[28:31], v[84:87]
    ds_read_b64_tr_b16 v[58:59], v230 offset:18432
    v_mul_f32 v193, v193, v209
    v_mfma_f32_16x16x32_bf16 v[88:91], v[60:63], v[32:35], v[88:91]
    v_mul_f32 v194, v194, v210
    v_mul_f32 v195, v195, v211
    v_mfma_f32_16x16x32_bf16 v[92:95], v[60:63], v[36:39], v[92:95]
    s_waitcnt lgkmcnt(8)
    v_max_f32 v196, 0, v196
    v_max_f32 v197, 0, v197
    v_mfma_f32_16x16x32_bf16 v[96:99], v[40:43], v[24:27], v[96:99]
    ds_read_b64_tr_b16 v[60:61], v230 offset:17408
    v_max_f32 v198, 0, v198
    v_mfma_f32_16x16x32_bf16 v[100:103], v[40:43], v[28:31], v[100:103]
    ds_read_b64_tr_b16 v[62:63], v230 offset:19456
    v_max_f32 v199, 0, v199
    v_mfma_f32_16x16x32_bf16 v[104:107], v[40:43], v[32:35], v[104:107]
    buffer_load_dwordx4 v1, s[28:31], s41 offen sc1 lds
    v_mfma_f32_16x16x32_bf16 v[108:111], v[40:43], v[36:39], v[108:111]
    s_waitcnt lgkmcnt(8)
    v_mul_f32 v196, v196, v212
    v_mul_f32 v197, v197, v213
    v_mfma_f32_16x16x32_bf16 v[112:115], v[44:47], v[24:27], v[112:115]
    ds_read_b64_tr_b16 v[40:41], v229 offset:20480
    v_mul_f32 v198, v198, v214
    v_mfma_f32_16x16x32_bf16 v[116:119], v[44:47], v[28:31], v[116:119]
    ds_read_b64_tr_b16 v[42:43], v229 offset:22528
    v_mul_f32 v199, v199, v215
    v_mfma_f32_16x16x32_bf16 v[120:123], v[44:47], v[32:35], v[120:123]
    v_cvt_pk_bf16_f32 v208, v192, v193
    v_cvt_pk_bf16_f32 v209, v194, v195
    v_mfma_f32_16x16x32_bf16 v[124:127], v[44:47], v[36:39], v[124:127]
    s_waitcnt lgkmcnt(8)
    v_cvt_pk_bf16_f32 v210, v196, v197
    v_cvt_pk_bf16_f32 v211, v198, v199
    v_mfma_f32_16x16x32_bf16 v[64:67], v[48:51], a[0:3], v[64:67]
    ds_read_b64_tr_b16 v[44:45], v229 offset:21504
    v_mfma_f32_16x16x32_bf16 v[68:71], v[48:51], a[4:7], v[68:71]
    ds_read_b64_tr_b16 v[46:47], v229 offset:23552
    v_mfma_f32_16x16x32_bf16 v[72:75], v[48:51], a[8:11], v[72:75]
    buffer_store_dwordx4 v[208:211], v1, s[28:31], s43 offen sc1
    v_mfma_f32_16x16x32_bf16 v[76:79], v[48:51], a[12:15], v[76:79]
    s_waitcnt lgkmcnt(8)
    v_max_f32 v200, 0, v200
    v_max_f32 v201, 0, v201
    v_mfma_f32_16x16x32_bf16 v[80:83], v[52:55], a[0:3], v[80:83]
    ds_read_b64_tr_b16 v[48:49], v230 offset:20480
    v_max_f32 v202, 0, v202
    v_mfma_f32_16x16x32_bf16 v[84:87], v[52:55], a[4:7], v[84:87]
    ds_read_b64_tr_b16 v[50:51], v230 offset:22528
    v_max_f32 v203, 0, v203
    v_mfma_f32_16x16x32_bf16 v[88:91], v[52:55], a[8:11], v[88:91]
    v_mul_f32 v200, v200, v216
    v_mul_f32 v201, v201, v217
    v_mfma_f32_16x16x32_bf16 v[92:95], v[52:55], a[12:15], v[92:95]
    s_waitcnt lgkmcnt(8)
    v_mul_f32 v202, v202, v218
    v_mul_f32 v203, v203, v219
    v_mfma_f32_16x16x32_bf16 v[96:99], v[56:59], a[0:3], v[96:99]
    ds_read_b64_tr_b16 v[52:53], v230 offset:21504
    v_max_f32 v204, 0, v204
    v_mfma_f32_16x16x32_bf16 v[100:103], v[56:59], a[4:7], v[100:103]
    ds_read_b64_tr_b16 v[54:55], v230 offset:23552
    v_max_f32 v205, 0, v205
    v_mfma_f32_16x16x32_bf16 v[104:107], v[56:59], a[8:11], v[104:107]
    v_max_f32 v206, 0, v206
    v_max_f32 v207, 0, v207
    v_mfma_f32_16x16x32_bf16 v[108:111], v[56:59], a[12:15], v[108:111]
    s_waitcnt lgkmcnt(8)
    v_mul_f32 v204, v204, v220
    v_mul_f32 v205, v205, v221
    v_mfma_f32_16x16x32_bf16 v[112:115], v[60:63], a[0:3], v[112:115]
    ds_read_b64_tr_b16 v[56:57], v229 offset:32768
    v_mul_f32 v206, v206, v222
    v_mfma_f32_16x16x32_bf16 v[116:119], v[60:63], a[4:7], v[116:119]
    ds_read_b64_tr_b16 v[58:59], v229 offset:34816
    v_mul_f32 v207, v207, v223
    v_mfma_f32_16x16x32_bf16 v[120:123], v[60:63], a[8:11], v[120:123]
    s_add_u32 s43, s43, 32768
    v_cvt_pk_bf16_f32 v216, v200, v201
    v_cvt_pk_bf16_f32 v217, v202, v203
    v_mfma_f32_16x16x32_bf16 v[124:127], v[60:63], a[12:15], v[124:127]
    s_waitcnt lgkmcnt(8)
    v_cvt_pk_bf16_f32 v218, v204, v205
    v_cvt_pk_bf16_f32 v219, v206, v207
    v_mfma_f32_16x16x32_bf16 v[64:67], v[40:43], a[16:19], v[64:67]
    ds_read_b64_tr_b16 v[60:61], v229 offset:33792
    v_mfma_f32_16x16x32_bf16 v[68:71], v[40:43], a[20:23], v[68:71]
    ds_read_b64_tr_b16 v[62:63], v229 offset:35840
    v_mfma_f32_16x16x32_bf16 v[72:75], v[40:43], a[24:27], v[72:75]
    buffer_store_dwordx4 v[216:219], v1, s[28:31], s43 offen sc1
    v_mfma_f32_16x16x32_bf16 v[76:79], v[40:43], a[28:31], v[76:79]
    s_waitcnt lgkmcnt(8)
    s_add_u32 s9, s10, 1
    s_and_b32 s9, s9, 3
    v_mfma_f32_16x16x32_bf16 v[80:83], v[44:47], a[16:19], v[80:83]
    ds_read_b64_tr_b16 v[40:41], v230 offset:32768
    s_lshl_b32 s9, s9, 10
    v_mfma_f32_16x16x32_bf16 v[84:87], v[44:47], a[20:23], v[84:87]
    ds_read_b64_tr_b16 v[42:43], v230 offset:34816
    s_add_u32 s9, s9, s58
    v_mfma_f32_16x16x32_bf16 v[88:91], v[44:47], a[24:27], v[88:91]
    s_cmp_eq_u32 s3, s10
    s_cselect_b32 s38, s9, s30
    s_add_u32 s9, s10, 2
    s_and_b32 s9, s9, 3
    v_mfma_f32_16x16x32_bf16 v[92:95], v[44:47], a[28:31], v[92:95]
    s_waitcnt lgkmcnt(8)
    s_lshl_b32 s9, s9, 10
    s_add_u32 s9, s9, s58
    v_mfma_f32_16x16x32_bf16 v[96:99], v[48:51], a[16:19], v[96:99]
    ds_read_b64_tr_b16 v[44:45], v230 offset:33792
    s_cmp_eq_u32 s3, s10
    s_cselect_b32 s39, s9, s30
    v_mfma_f32_16x16x32_bf16 v[100:103], v[48:51], a[20:23], v[100:103]
    ds_read_b64_tr_b16 v[46:47], v230 offset:35840
    s_add_u32 s9, s10, 3
    v_mfma_f32_16x16x32_bf16 v[104:107], v[48:51], a[24:27], v[104:107]
    s_and_b32 s9, s9, 3
    s_lshl_b32 s9, s9, 10
    s_add_u32 s9, s9, s58
    v_mfma_f32_16x16x32_bf16 v[108:111], v[48:51], a[28:31], v[108:111]
    s_waitcnt lgkmcnt(8)
    s_cmp_eq_u32 s3, s10
    s_cselect_b32 s40, s9, s30
    v_mfma_f32_16x16x32_bf16 v[112:115], v[52:55], a[16:19], v[112:115]
    ds_read_b64_tr_b16 v[48:49], v229 offset:36864
    v_mfma_f32_16x16x32_bf16 v[116:119], v[52:55], a[20:23], v[116:119]
    ds_read_b64_tr_b16 v[50:51], v229 offset:38912
    v_mfma_f32_16x16x32_bf16 v[120:123], v[52:55], a[24:27], v[120:123]
    v_mfma_f32_16x16x32_bf16 v[124:127], v[52:55], a[28:31], v[124:127]
    s_waitcnt lgkmcnt(8)
    v_mfma_f32_16x16x32_bf16 v[64:67], v[56:59], a[32:35], v[64:67]
    ds_read_b64_tr_b16 v[52:53], v229 offset:37888
    v_mfma_f32_16x16x32_bf16 v[68:71], v[56:59], a[36:39], v[68:71]
    ds_read_b64_tr_b16 v[54:55], v229 offset:39936
    v_mfma_f32_16x16x32_bf16 v[72:75], v[56:59], a[40:43], v[72:75]
    v_mfma_f32_16x16x32_bf16 v[76:79], v[56:59], a[44:47], v[76:79]
    s_waitcnt lgkmcnt(8)
    v_mfma_f32_16x16x32_bf16 v[80:83], v[60:63], a[32:35], v[80:83]
    ds_read_b64_tr_b16 v[56:57], v230 offset:36864
    v_mfma_f32_16x16x32_bf16 v[84:87], v[60:63], a[36:39], v[84:87]
    ds_read_b64_tr_b16 v[58:59], v230 offset:38912
    v_mfma_f32_16x16x32_bf16 v[88:91], v[60:63], a[40:43], v[88:91]
    v_mfma_f32_16x16x32_bf16 v[92:95], v[60:63], a[44:47], v[92:95]
    s_waitcnt lgkmcnt(8)
    v_mfma_f32_16x16x32_bf16 v[96:99], v[40:43], a[32:35], v[96:99]
    ds_read_b64_tr_b16 v[60:61], v230 offset:37888
    v_mfma_f32_16x16x32_bf16 v[100:103], v[40:43], a[36:39], v[100:103]
    ds_read_b64_tr_b16 v[62:63], v230 offset:39936
    v_mfma_f32_16x16x32_bf16 v[104:107], v[40:43], a[40:43], v[104:107]
    v_mfma_f32_16x16x32_bf16 v[108:111], v[40:43], a[44:47], v[108:111]
    s_waitcnt lgkmcnt(8)
    s_waitcnt vmcnt(30)
    s_barrier
    v_mfma_f32_16x16x32_bf16 v[112:115], v[44:47], a[32:35], v[112:115]
    ds_read_b64_tr_b16 v[40:41], v229 offset:49152
    s_add_u32 s41, s41, 4096
    v_mfma_f32_16x16x32_bf16 v[116:119], v[44:47], a[36:39], v[116:119]
    ds_read_b64_tr_b16 v[42:43], v229 offset:51200
    s_add_u32 m0, s47, 0
    v_mfma_f32_16x16x32_bf16 v[120:123], v[44:47], a[40:43], v[120:123]
    buffer_load_dwordx4 v1, s[28:31], s41 offen sc1 lds
    v_mfma_f32_16x16x32_bf16 v[124:127], v[44:47], a[44:47], v[124:127]
    s_waitcnt lgkmcnt(8)
    s_add_u32 s41, s41, 4096
    s_add_u32 m0, s47, 4096
    v_mfma_f32_16x16x32_bf16 v[64:67], v[48:51], a[48:51], v[64:67]
    ds_read_b64_tr_b16 v[44:45], v229 offset:50176
    v_mfma_f32_16x16x32_bf16 v[68:71], v[48:51], a[52:55], v[68:71]
    ds_read_b64_tr_b16 v[46:47], v229 offset:52224
    v_mfma_f32_16x16x32_bf16 v[72:75], v[48:51], a[56:59], v[72:75]
    buffer_load_dwordx4 v1, s[28:31], s41 offen sc1 lds
    v_mfma_f32_16x16x32_bf16 v[76:79], v[48:51], a[60:63], v[76:79]
    s_waitcnt lgkmcnt(8)
    s_add_u32 s41, s41, 4096
    s_add_u32 m0, s47, 16384
    v_mfma_f32_16x16x32_bf16 v[80:83], v[52:55], a[48:51], v[80:83]
    ds_read_b64_tr_b16 v[48:49], v230 offset:49152
    v_mfma_f32_16x16x32_bf16 v[84:87], v[52:55], a[52:55], v[84:87]
    ds_read_b64_tr_b16 v[50:51], v230 offset:51200
    v_mfma_f32_16x16x32_bf16 v[88:91], v[52:55], a[56:59], v[88:91]
    buffer_load_dwordx4 v1, s[28:31], s41 offen sc1 lds
    v_mfma_f32_16x16x32_bf16 v[92:95], v[52:55], a[60:63], v[92:95]
    s_waitcnt lgkmcnt(8)
    s_add_u32 s41, s41, 4096
    s_add_u32 m0, s47, 20480
    v_mfma_f32_16x16x32_bf16 v[96:99], v[56:59], a[48:51], v[96:99]
    ds_read_b64_tr_b16 v[52:53], v230 offset:50176
    v_mfma_f32_16x16x32_bf16 v[100:103], v[56:59], a[52:55], v[100:103]
    ds_read_b64_tr_b16 v[54:55], v230 offset:52224
    v_mfma_f32_16x16x32_bf16 v[104:107], v[56:59], a[56:59], v[104:107]
    buffer_load_dwordx4 v1, s[28:31], s41 offen sc1 lds
    v_mfma_f32_16x16x32_bf16 v[108:111], v[56:59], a[60:63], v[108:111]
    s_waitcnt lgkmcnt(8)
    v_mfma_f32_16x16x32_bf16 v[112:115], v[60:63], a[48:51], v[112:115]
    ds_read_b64_tr_b16 v[56:57], v229 offset:53248
    v_mfma_f32_16x16x32_bf16 v[116:119], v[60:63], a[52:55], v[116:119]
    ds_read_b64_tr_b16 v[58:59], v229 offset:55296
    v_mfma_f32_16x16x32_bf16 v[120:123], v[60:63], a[56:59], v[120:123]
    v_mfma_f32_16x16x32_bf16 v[124:127], v[60:63], a[60:63], v[124:127]
    s_waitcnt lgkmcnt(8)
    v_mfma_f32_16x16x32_bf16 v[64:67], v[40:43], a[64:67], v[64:67]
    ds_read_b64_tr_b16 v[60:61], v229 offset:54272
    s_waitcnt vmcnt(10)
    v_mfma_f32_16x16x32_bf16 v[68:71], v[40:43], a[68:71], v[68:71]
    ds_read_b64_tr_b16 v[62:63], v229 offset:56320
    v_mfma_f32_16x16x32_bf16 v[72:75], v[40:43], a[72:75], v[72:75]
    buffer_store_dword v252, v251, s[28:31], s60 offen sc1
    v_mfma_f32_16x16x32_bf16 v[76:79], v[40:43], a[76:79], v[76:79]
    s_waitcnt lgkmcnt(8)
    s_add_u32 s60, s60, 131072
    v_mfma_f32_16x16x32_bf16 v[80:83], v[44:47], a[64:67], v[80:83]
    ds_read_b64_tr_b16 v[40:41], v230 offset:53248
    v_mfma_f32_16x16x32_bf16 v[84:87], v[44:47], a[68:71], v[84:87]
    ds_read_b64_tr_b16 v[42:43], v230 offset:55296
    v_mfma_f32_16x16x32_bf16 v[88:91], v[44:47], a[72:75], v[88:91]
    buffer_store_dword v252, v251, s[28:31], s65 offen sc1
    v_mfma_f32_16x16x32_bf16 v[92:95], v[44:47], a[76:79], v[92:95]
    s_waitcnt lgkmcnt(8)
    v_mfma_f32_16x16x32_bf16 v[96:99], v[48:51], a[64:67], v[96:99]
    ds_read_b64_tr_b16 v[44:45], v230 offset:54272
    v_mfma_f32_16x16x32_bf16 v[100:103], v[48:51], a[68:71], v[100:103]
    ds_read_b64_tr_b16 v[46:47], v230 offset:56320
    v_mfma_f32_16x16x32_bf16 v[104:107], v[48:51], a[72:75], v[104:107]
    v_mfma_f32_16x16x32_bf16 v[108:111], v[48:51], a[76:79], v[108:111]
    s_waitcnt lgkmcnt(8)
    v_mfma_f32_16x16x32_bf16 v[112:115], v[52:55], a[64:67], v[112:115]
    v_add_u32 v229, 65536, v229
    v_mfma_f32_16x16x32_bf16 v[116:119], v[52:55], a[68:71], v[116:119]
    ds_read_b64_tr_b16 v[48:49], v229 offset:0
    v_mfma_f32_16x16x32_bf16 v[120:123], v[52:55], a[72:75], v[120:123]
    ds_read_b64_tr_b16 v[50:51], v229 offset:2048
    v_mfma_f32_16x16x32_bf16 v[124:127], v[52:55], a[76:79], v[124:127]
    s_waitcnt lgkmcnt(8)
    v_mfma_f32_16x16x32_bf16 v[64:67], v[56:59], a[80:83], v[64:67]
    ds_read_b64_tr_b16 v[52:53], v229 offset:1024
    v_mfma_f32_16x16x32_bf16 v[68:71], v[56:59], a[84:87], v[68:71]
    ds_read_b64_tr_b16 v[54:55], v229 offset:3072
    v_mfma_f32_16x16x32_bf16 v[72:75], v[56:59], a[88:91], v[72:75]
    buffer_store_dwordx4 v[232:235], v1, s[28:31], s53 offen offset:0 sc1
    v_mfma_f32_16x16x32_bf16 v[76:79], v[56:59], a[92:95], v[76:79]
    s_waitcnt lgkmcnt(8)
    v_mfma_f32_16x16x32_bf16 v[80:83], v[60:63], a[80:83], v[80:83]
    v_add_u32 v230, 65536, v230
    v_mfma_f32_16x16x32_bf16 v[84:87], v[60:63], a[84:87], v[84:87]
    ds_read_b64_tr_b16 v[56:57], v230 offset:0
    v_mfma_f32_16x16x32_bf16 v[88:91], v[60:63], a[88:91], v[88:91]
    ds_read_b64_tr_b16 v[58:59], v230 offset:2048
    v_mfma_f32_16x16x32_bf16 v[92:95], v[60:63], a[92:95], v[92:95]
    s_waitcnt lgkmcnt(8)
    v_mfma_f32_16x16x32_bf16 v[96:99], v[40:43], a[80:83], v[96:99]
    ds_read_b64_tr_b16 v[60:61], v230 offset:1024
    v_mfma_f32_16x16x32_bf16 v[100:103], v[40:43], a[84:87], v[100:103]
    ds_read_b64_tr_b16 v[62:63], v230 offset:3072
    v_mfma_f32_16x16x32_bf16 v[104:107], v[40:43], a[88:91], v[104:107]
    v_mfma_f32_16x16x32_bf16 v[108:111], v[40:43], a[92:95], v[108:111]
    s_waitcnt lgkmcnt(8)
    v_mfma_f32_16x16x32_bf16 v[112:115], v[44:47], a[80:83], v[112:115]
    ds_read_b64_tr_b16 v[40:41], v229 offset:4096
    v_mfma_f32_16x16x32_bf16 v[116:119], v[44:47], a[84:87], v[116:119]
    ds_read_b64_tr_b16 v[42:43], v229 offset:6144
    v_mfma_f32_16x16x32_bf16 v[120:123], v[44:47], a[88:91], v[120:123]
    v_mfma_f32_16x16x32_bf16 v[124:127], v[44:47], a[92:95], v[124:127]
    s_waitcnt lgkmcnt(8)
    v_mfma_f32_16x16x32_bf16 v[64:67], v[48:51], a[96:99], v[64:67]
    ds_read_b64_tr_b16 v[44:45], v229 offset:5120
    v_mfma_f32_16x16x32_bf16 v[68:71], v[48:51], a[100:103], v[68:71]
    ds_read_b64_tr_b16 v[46:47], v229 offset:7168
    v_mfma_f32_16x16x32_bf16 v[72:75], v[48:51], a[104:107], v[72:75]
    buffer_store_dwordx4 v[232:235], v1, s[28:31], s53 offen offset:1024 sc1
    v_mfma_f32_16x16x32_bf16 v[76:79], v[48:51], a[108:111], v[76:79]
    s_waitcnt lgkmcnt(8)
    v_mfma_f32_16x16x32_bf16 v[80:83], v[52:55], a[96:99], v[80:83]
    ds_read_b64_tr_b16 v[48:49], v230 offset:4096
    v_mfma_f32_16x16x32_bf16 v[84:87], v[52:55], a[100:103], v[84:87]
    ds_read_b64_tr_b16 v[50:51], v230 offset:6144
    v_mfma_f32_16x16x32_bf16 v[88:91], v[52:55], a[104:107], v[88:91]
    v_mfma_f32_16x16x32_bf16 v[92:95], v[52:55], a[108:111], v[92:95]
    s_waitcnt lgkmcnt(8)
    v_mfma_f32_16x16x32_bf16 v[96:99], v[56:59], a[96:99], v[96:99]
    ds_read_b64_tr_b16 v[52:53], v230 offset:5120
    v_mfma_f32_16x16x32_bf16 v[100:103], v[56:59], a[100:103], v[100:103]
    ds_read_b64_tr_b16 v[54:55], v230 offset:7168
    v_mfma_f32_16x16x32_bf16 v[104:107], v[56:59], a[104:107], v[104:107]
    v_mfma_f32_16x16x32_bf16 v[108:111], v[56:59], a[108:111], v[108:111]
    s_waitcnt lgkmcnt(8)
    s_barrier
    v_mfma_f32_16x16x32_bf16 v[112:115], v[60:63], a[96:99], v[112:115]
    ds_read_b64_tr_b16 v[56:57], v229 offset:16384
    s_add_u32 s41, s41, 4096
    v_mfma_f32_16x16x32_bf16 v[116:119], v[60:63], a[100:103], v[116:119]
    ds_read_b64_tr_b16 v[58:59], v229 offset:18432
    s_add_u32 m0, s47, 32768
    v_mfma_f32_16x16x32_bf16 v[120:123], v[60:63], a[104:107], v[120:123]
    buffer_load_dwordx4 v1, s[28:31], s41 offen sc1 lds
    v_mfma_f32_16x16x32_bf16 v[124:127], v[60:63], a[108:111], v[124:127]
    s_waitcnt lgkmcnt(8)
    s_add_u32 s41, s41, 4096
    s_add_u32 m0, s47, 36864
    v_mfma_f32_16x16x32_bf16 v[64:67], v[40:43], a[112:115], v[64:67]
    ds_read_b64_tr_b16 v[60:61], v229 offset:17408
    v_mfma_f32_16x16x32_bf16 v[68:71], v[40:43], a[116:119], v[68:71]
    ds_read_b64_tr_b16 v[62:63], v229 offset:19456
    v_mfma_f32_16x16x32_bf16 v[72:75], v[40:43], a[120:123], v[72:75]
    buffer_store_dwordx4 v[232:235], v1, s[28:31], s54 offen offset:0 sc1
    v_mfma_f32_16x16x32_bf16 v[76:79], v[40:43], a[124:127], v[76:79]
    s_waitcnt lgkmcnt(8)
    buffer_load_dwordx4 v1, s[28:31], s41 offen sc1 lds
    v_mfma_f32_16x16x32_bf16 v[80:83], v[44:47], a[112:115], v[80:83]
    ds_read_b64_tr_b16 v[40:41], v230 offset:16384
    s_add_u32 s41, s41, 4096
    v_mfma_f32_16x16x32_bf16 v[84:87], v[44:47], a[116:119], v[84:87]
    ds_read_b64_tr_b16 v[42:43], v230 offset:18432
    s_add_u32 m0, s47, 49152
    v_mfma_f32_16x16x32_bf16 v[88:91], v[44:47], a[120:123], v[88:91]
    buffer_load_dwordx4 v1, s[28:31], s41 offen sc1 lds
    v_mfma_f32_16x16x32_bf16 v[92:95], v[44:47], a[124:127], v[92:95]
    s_waitcnt lgkmcnt(8)
    s_add_u32 s41, s41, 4096
    s_add_u32 m0, s47, 53248
    v_mfma_f32_16x16x32_bf16 v[96:99], v[48:51], a[112:115], v[96:99]
    ds_read_b64_tr_b16 v[44:45], v230 offset:17408
    v_mfma_f32_16x16x32_bf16 v[100:103], v[48:51], a[116:119], v[100:103]
    ds_read_b64_tr_b16 v[46:47], v230 offset:19456
    v_mfma_f32_16x16x32_bf16 v[104:107], v[48:51], a[120:123], v[104:107]
    buffer_load_dwordx4 v1, s[28:31], s41 offen sc1 lds
    v_mfma_f32_16x16x32_bf16 v[108:111], v[48:51], a[124:127], v[108:111]
    s_waitcnt lgkmcnt(8)
    v_mfma_f32_16x16x32_bf16 v[112:115], v[52:55], a[112:115], v[112:115]
    ds_read_b64_tr_b16 v[48:49], v229 offset:20480
    v_mfma_f32_16x16x32_bf16 v[116:119], v[52:55], a[116:119], v[116:119]
    ds_read_b64_tr_b16 v[50:51], v229 offset:22528
    v_mfma_f32_16x16x32_bf16 v[120:123], v[52:55], a[120:123], v[120:123]
    v_mfma_f32_16x16x32_bf16 v[124:127], v[52:55], a[124:127], v[124:127]
    s_waitcnt lgkmcnt(8)
    v_mfma_f32_16x16x32_bf16 v[64:67], v[56:59], a[128:131], v[64:67]
    ds_read_b64_tr_b16 v[52:53], v229 offset:21504
    v_mfma_f32_16x16x32_bf16 v[68:71], v[56:59], a[132:135], v[68:71]
    ds_read_b64_tr_b16 v[54:55], v229 offset:23552
    v_mfma_f32_16x16x32_bf16 v[72:75], v[56:59], a[136:139], v[72:75]
    buffer_store_dwordx4 v[232:235], v1, s[28:31], s54 offen offset:1024 sc1
    v_mfma_f32_16x16x32_bf16 v[76:79], v[56:59], a[140:143], v[76:79]
    s_waitcnt lgkmcnt(8)
    v_mfma_f32_16x16x32_bf16 v[80:83], v[60:63], a[128:131], v[80:83]
    ds_read_b64_tr_b16 v[56:57], v230 offset:20480
    v_mfma_f32_16x16x32_bf16 v[84:87], v[60:63], a[132:135], v[84:87]
    ds_read_b64_tr_b16 v[58:59], v230 offset:22528
    v_mfma_f32_16x16x32_bf16 v[88:91], v[60:63], a[136:139], v[88:91]
    v_mfma_f32_16x16x32_bf16 v[92:95], v[60:63], a[140:143], v[92:95]
    s_waitcnt lgkmcnt(8)
    v_mfma_f32_16x16x32_bf16 v[96:99], v[40:43], a[128:131], v[96:99]
    ds_read_b64_tr_b16 v[60:61], v230 offset:21504
    v_mfma_f32_16x16x32_bf16 v[100:103], v[40:43], a[132:135], v[100:103]
    ds_read_b64_tr_b16 v[62:63], v230 offset:23552
    v_mfma_f32_16x16x32_bf16 v[104:107], v[40:43], a[136:139], v[104:107]
    v_mfma_f32_16x16x32_bf16 v[108:111], v[40:43], a[140:143], v[108:111]
    s_waitcnt lgkmcnt(8)
    v_mfma_f32_16x16x32_bf16 v[112:115], v[44:47], a[128:131], v[112:115]
    ds_read_b64_tr_b16 v[40:41], v229 offset:32768
    v_mfma_f32_16x16x32_bf16 v[116:119], v[44:47], a[132:135], v[116:119]
    ds_read_b64_tr_b16 v[42:43], v229 offset:34816
    v_mfma_f32_16x16x32_bf16 v[120:123], v[44:47], a[136:139], v[120:123]
    v_mfma_f32_16x16x32_bf16 v[124:127], v[44:47], a[140:143], v[124:127]
    s_waitcnt lgkmcnt(8)
    v_mfma_f32_16x16x32_bf16 v[64:67], v[48:51], a[144:147], v[64:67]
    ds_read_b64_tr_b16 v[44:45], v229 offset:33792
    v_mfma_f32_16x16x32_bf16 v[68:71], v[48:51], a[148:151], v[68:71]
    ds_read_b64_tr_b16 v[46:47], v229 offset:35840
    v_mfma_f32_16x16x32_bf16 v[72:75], v[48:51], a[152:155], v[72:75]
    buffer_store_dwordx4 v[232:235], v1, s[28:31], s55 offen offset:0 sc1
    v_mfma_f32_16x16x32_bf16 v[76:79], v[48:51], a[156:159], v[76:79]
    s_waitcnt lgkmcnt(8)
    v_mfma_f32_16x16x32_bf16 v[80:83], v[52:55], a[144:147], v[80:83]
    ds_read_b64_tr_b16 v[48:49], v230 offset:32768
    v_mfma_f32_16x16x32_bf16 v[84:87], v[52:55], a[148:151], v[84:87]
    ds_read_b64_tr_b16 v[50:51], v230 offset:34816
    v_mfma_f32_16x16x32_bf16 v[88:91], v[52:55], a[152:155], v[88:91]
    v_mfma_f32_16x16x32_bf16 v[92:95], v[52:55], a[156:159], v[92:95]
    s_waitcnt lgkmcnt(8)
    v_mfma_f32_16x16x32_bf16 v[96:99], v[56:59], a[144:147], v[96:99]
    ds_read_b64_tr_b16 v[52:53], v230 offset:33792
    v_mfma_f32_16x16x32_bf16 v[100:103], v[56:59], a[148:151], v[100:103]
    ds_read_b64_tr_b16 v[54:55], v230 offset:35840
    v_mfma_f32_16x16x32_bf16 v[104:107], v[56:59], a[152:155], v[104:107]
    v_mfma_f32_16x16x32_bf16 v[108:111], v[56:59], a[156:159], v[108:111]
    s_waitcnt lgkmcnt(8)
    v_mfma_f32_16x16x32_bf16 v[112:115], v[60:63], a[144:147], v[112:115]
    ds_read_b64_tr_b16 v[56:57], v229 offset:36864
    v_mfma_f32_16x16x32_bf16 v[116:119], v[60:63], a[148:151], v[116:119]
    ds_read_b64_tr_b16 v[58:59], v229 offset:38912
    v_mfma_f32_16x16x32_bf16 v[120:123], v[60:63], a[152:155], v[120:123]
    v_mfma_f32_16x16x32_bf16 v[124:127], v[60:63], a[156:159], v[124:127]
    s_waitcnt lgkmcnt(8)
    v_mfma_f32_16x16x32_bf16 v[64:67], v[40:43], a[160:163], v[64:67]
    ds_read_b64_tr_b16 v[60:61], v229 offset:37888
    v_mfma_f32_16x16x32_bf16 v[68:71], v[40:43], a[164:167], v[68:71]
    ds_read_b64_tr_b16 v[62:63], v229 offset:39936
    v_mfma_f32_16x16x32_bf16 v[72:75], v[40:43], a[168:171], v[72:75]
    buffer_store_dwordx4 v[232:235], v1, s[28:31], s55 offen offset:1024 sc1
    v_mfma_f32_16x16x32_bf16 v[76:79], v[40:43], a[172:175], v[76:79]
    s_waitcnt lgkmcnt(8)
    v_mfma_f32_16x16x32_bf16 v[80:83], v[44:47], a[160:163], v[80:83]
    ds_read_b64_tr_b16 v[40:41], v230 offset:36864
    v_mfma_f32_16x16x32_bf16 v[84:87], v[44:47], a[164:167], v[84:87]
    ds_read_b64_tr_b16 v[42:43], v230 offset:38912
    v_mfma_f32_16x16x32_bf16 v[88:91], v[44:47], a[168:171], v[88:91]
    v_mfma_f32_16x16x32_bf16 v[92:95], v[44:47], a[172:175], v[92:95]
    s_waitcnt lgkmcnt(8)
    v_mfma_f32_16x16x32_bf16 v[96:99], v[48:51], a[160:163], v[96:99]
    ds_read_b64_tr_b16 v[44:45], v230 offset:37888
    v_mfma_f32_16x16x32_bf16 v[100:103], v[48:51], a[164:167], v[100:103]
    ds_read_b64_tr_b16 v[46:47], v230 offset:39936
    v_mfma_f32_16x16x32_bf16 v[104:107], v[48:51], a[168:171], v[104:107]
    v_mfma_f32_16x16x32_bf16 v[108:111], v[48:51], a[172:175], v[108:111]
    s_waitcnt lgkmcnt(8)
    s_barrier
    v_mfma_f32_16x16x32_bf16 v[112:115], v[52:55], a[160:163], v[112:115]
    ds_read_b64_tr_b16 v[48:49], v229 offset:49152
    s_add_u32 s41, s41, 4096
    v_mfma_f32_16x16x32_bf16 v[116:119], v[52:55], a[164:167], v[116:119]
    ds_read_b64_tr_b16 v[50:51], v229 offset:51200
    s_add_u32 m0, s47, 65536
    v_mfma_f32_16x16x32_bf16 v[120:123], v[52:55], a[168:171], v[120:123]
    buffer_load_dwordx4 v1, s[28:31], s41 offen sc1 lds
    v_mfma_f32_16x16x32_bf16 v[124:127], v[52:55], a[172:175], v[124:127]
    s_waitcnt lgkmcnt(8)
    s_add_u32 s41, s41, 4096
    s_add_u32 m0, s47, 69632
    v_mfma_f32_16x16x32_bf16 v[64:67], v[56:59], a[176:179], v[64:67]
    ds_read_b64_tr_b16 v[52:53], v229 offset:50176
    v_mfma_f32_16x16x32_bf16 v[68:71], v[56:59], a[180:183], v[68:71]
    ds_read_b64_tr_b16 v[54:55], v229 offset:52224
    v_mfma_f32_16x16x32_bf16 v[72:75], v[56:59], a[184:187], v[72:75]
    buffer_store_dwordx4 v[232:235], v1, s[28:31], s56 offen sc1
    v_mfma_f32_16x16x32_bf16 v[76:79], v[56:59], a[188:191], v[76:79]
    s_waitcnt lgkmcnt(8)
    buffer_load_dwordx4 v1, s[28:31], s41 offen sc1 lds
    v_mfma_f32_16x16x32_bf16 v[80:83], v[60:63], a[176:179], v[80:83]
    ds_read_b64_tr_b16 v[56:57], v230 offset:49152
    s_add_u32 s41, s41, 4096
    v_mfma_f32_16x16x32_bf16 v[84:87], v[60:63], a[180:183], v[84:87]
    ds_read_b64_tr_b16 v[58:59], v230 offset:51200
    s_add_u32 m0, s47, 81920
    v_mfma_f32_16x16x32_bf16 v[88:91], v[60:63], a[184:187], v[88:91]
    buffer_load_dwordx4 v1, s[28:31], s41 offen sc1 lds
    v_mfma_f32_16x16x32_bf16 v[92:95], v[60:63], a[188:191], v[92:95]
    s_waitcnt lgkmcnt(8)
    s_add_u32 s41, s41, 4096
    s_add_u32 m0, s47, 86016
    v_mfma_f32_16x16x32_bf16 v[96:99], v[40:43], a[176:179], v[96:99]
    ds_read_b64_tr_b16 v[60:61], v230 offset:50176
    v_mfma_f32_16x16x32_bf16 v[100:103], v[40:43], a[180:183], v[100:103]
    ds_read_b64_tr_b16 v[62:63], v230 offset:52224
    v_mfma_f32_16x16x32_bf16 v[104:107], v[40:43], a[184:187], v[104:107]
    buffer_load_dwordx4 v1, s[28:31], s41 offen sc1 lds
    v_mfma_f32_16x16x32_bf16 v[108:111], v[40:43], a[188:191], v[108:111]
    s_waitcnt lgkmcnt(8)
    v_mfma_f32_16x16x32_bf16 v[112:115], v[44:47], a[176:179], v[112:115]
    ds_read_b64_tr_b16 v[40:41], v229 offset:53248
    v_mfma_f32_16x16x32_bf16 v[116:119], v[44:47], a[180:183], v[116:119]
    ds_read_b64_tr_b16 v[42:43], v229 offset:55296
    v_mfma_f32_16x16x32_bf16 v[120:123], v[44:47], a[184:187], v[120:123]
    v_mfma_f32_16x16x32_bf16 v[124:127], v[44:47], a[188:191], v[124:127]
    s_waitcnt lgkmcnt(8)
    v_mfma_f32_16x16x32_bf16 v[64:67], v[48:51], a[192:195], v[64:67]
    ds_read_b64_tr_b16 v[44:45], v229 offset:54272
    v_mfma_f32_16x16x32_bf16 v[68:71], v[48:51], a[196:199], v[68:71]
    ds_read_b64_tr_b16 v[46:47], v229 offset:56320
    v_mfma_f32_16x16x32_bf16 v[72:75], v[48:51], a[200:203], v[72:75]
    v_mfma_f32_16x16x32_bf16 v[76:79], v[48:51], a[204:207], v[76:79]
    s_waitcnt lgkmcnt(8)
    v_mfma_f32_16x16x32_bf16 v[80:83], v[52:55], a[192:195], v[80:83]
    ds_read_b64_tr_b16 v[48:49], v230 offset:53248
    v_mfma_f32_16x16x32_bf16 v[84:87], v[52:55], a[196:199], v[84:87]
    ds_read_b64_tr_b16 v[50:51], v230 offset:55296
    v_mfma_f32_16x16x32_bf16 v[88:91], v[52:55], a[200:203], v[88:91]
    v_mfma_f32_16x16x32_bf16 v[92:95], v[52:55], a[204:207], v[92:95]
    s_waitcnt lgkmcnt(8)
    v_mfma_f32_16x16x32_bf16 v[96:99], v[56:59], a[192:195], v[96:99]
    ds_read_b64_tr_b16 v[52:53], v230 offset:54272
    v_mfma_f32_16x16x32_bf16 v[100:103], v[56:59], a[196:199], v[100:103]
    ds_read_b64_tr_b16 v[54:55], v230 offset:56320
    v_mfma_f32_16x16x32_bf16 v[104:107], v[56:59], a[200:203], v[104:107]
    v_mfma_f32_16x16x32_bf16 v[108:111], v[56:59], a[204:207], v[108:111]
    s_waitcnt lgkmcnt(8)
    v_mfma_f32_16x16x32_bf16 v[112:115], v[60:63], a[192:195], v[112:115]
    v_add_u32 v229, 65536, v229
    v_mfma_f32_16x16x32_bf16 v[116:119], v[60:63], a[196:199], v[116:119]
    ds_read_b64_tr_b16 v[56:57], v229 offset:0
    v_mfma_f32_16x16x32_bf16 v[120:123], v[60:63], a[200:203], v[120:123]
    ds_read_b64_tr_b16 v[58:59], v229 offset:2048
    v_mfma_f32_16x16x32_bf16 v[124:127], v[60:63], a[204:207], v[124:127]
    s_waitcnt lgkmcnt(8)
    v_mfma_f32_16x16x32_bf16 v[64:67], v[40:43], a[208:211], v[64:67]
    ds_read_b64_tr_b16 v[60:61], v229 offset:1024
    v_mfma_f32_16x16x32_bf16 v[68:71], v[40:43], a[212:215], v[68:71]
    ds_read_b64_tr_b16 v[62:63], v229 offset:3072
    v_mfma_f32_16x16x32_bf16 v[72:75], v[40:43], a[216:219], v[72:75]
    v_mfma_f32_16x16x32_bf16 v[76:79], v[40:43], a[220:223], v[76:79]
    s_waitcnt lgkmcnt(8)
    v_mfma_f32_16x16x32_bf16 v[80:83], v[44:47], a[208:211], v[80:83]
    v_add_u32 v230, 65536, v230
    v_mfma_f32_16x16x32_bf16 v[84:87], v[44:47], a[212:215], v[84:87]
    ds_read_b64_tr_b16 v[40:41], v230 offset:0
    v_mfma_f32_16x16x32_bf16 v[88:91], v[44:47], a[216:219], v[88:91]
    ds_read_b64_tr_b16 v[42:43], v230 offset:2048
    v_mfma_f32_16x16x32_bf16 v[92:95], v[44:47], a[220:223], v[92:95]
    s_waitcnt lgkmcnt(8)
    v_mfma_f32_16x16x32_bf16 v[96:99], v[48:51], a[208:211], v[96:99]
    ds_read_b64_tr_b16 v[44:45], v230 offset:1024
    v_mfma_f32_16x16x32_bf16 v[100:103], v[48:51], a[212:215], v[100:103]
    ds_read_b64_tr_b16 v[46:47], v230 offset:3072
    v_mfma_f32_16x16x32_bf16 v[104:107], v[48:51], a[216:219], v[104:107]
    buffer_load_dword v250, v249, s[28:31], s66 offen sc1
    v_mfma_f32_16x16x32_bf16 v[108:111], v[48:51], a[220:223], v[108:111]
    s_waitcnt lgkmcnt(8)
    v_mfma_f32_16x16x32_bf16 v[112:115], v[52:55], a[208:211], v[112:115]
    ds_read_b64_tr_b16 v[48:49], v229 offset:4096
    v_mfma_f32_16x16x32_bf16 v[116:119], v[52:55], a[212:215], v[116:119]
    ds_read_b64_tr_b16 v[50:51], v229 offset:6144
    v_mfma_f32_16x16x32_bf16 v[120:123], v[52:55], a[216:219], v[120:123]
    v_mfma_f32_16x16x32_bf16 v[124:127], v[52:55], a[220:223], v[124:127]
    s_waitcnt lgkmcnt(8)
    v_mfma_f32_16x16x32_bf16 v[64:67], v[56:59], a[224:227], v[64:67]
    ds_read_b64_tr_b16 v[52:53], v229 offset:5120
    v_mfma_f32_16x16x32_bf16 v[68:71], v[56:59], a[228:231], v[68:71]
    ds_read_b64_tr_b16 v[54:55], v229 offset:7168
    v_mfma_f32_16x16x32_bf16 v[72:75], v[56:59], a[232:235], v[72:75]
    v_mfma_f32_16x16x32_bf16 v[76:79], v[56:59], a[236:239], v[76:79]
    s_waitcnt lgkmcnt(8)
    v_mfma_f32_16x16x32_bf16 v[80:83], v[60:63], a[224:227], v[80:83]
    ds_read_b64_tr_b16 v[56:57], v230 offset:4096
    v_mfma_f32_16x16x32_bf16 v[84:87], v[60:63], a[228:231], v[84:87]
    ds_read_b64_tr_b16 v[58:59], v230 offset:6144
    v_mfma_f32_16x16x32_bf16 v[88:91], v[60:63], a[232:235], v[88:91]
    v_mfma_f32_16x16x32_bf16 v[92:95], v[60:63], a[236:239], v[92:95]
    s_waitcnt lgkmcnt(8)
    v_mfma_f32_16x16x32_bf16 v[96:99], v[40:43], a[224:227], v[96:99]
    ds_read_b64_tr_b16 v[60:61], v230 offset:5120
    v_mfma_f32_16x16x32_bf16 v[100:103], v[40:43], a[228:231], v[100:103]
    ds_read_b64_tr_b16 v[62:63], v230 offset:7168
    v_mfma_f32_16x16x32_bf16 v[104:107], v[40:43], a[232:235], v[104:107]
    v_mfma_f32_16x16x32_bf16 v[108:111], v[40:43], a[236:239], v[108:111]
    s_waitcnt lgkmcnt(8)
    s_barrier
    v_mfma_f32_16x16x32_bf16 v[112:115], v[44:47], a[224:227], v[112:115]
    s_add_u32 s41, s41, 4096
    s_add_u32 m0, s47, 98304
    v_add_u32 v229, 4294836224, v229
    v_mfma_f32_16x16x32_bf16 v[116:119], v[44:47], a[228:231], v[116:119]
    ds_read_b64_tr_b16 v[40:41], v229 offset:8192
    v_mfma_f32_16x16x32_bf16 v[120:123], v[44:47], a[232:235], v[120:123]
    ds_read_b64_tr_b16 v[42:43], v229 offset:10240
    v_mfma_f32_16x16x32_bf16 v[124:127], v[44:47], a[236:239], v[124:127]
    s_waitcnt lgkmcnt(8)
    buffer_load_dwordx4 v1, s[28:31], s41 offen sc1 lds
    v_mfma_f32_16x16x32_bf16 v[64:67], v[48:51], a[240:243], v[64:67]
    ds_read_b64_tr_b16 v[44:45], v229 offset:9216
    s_add_u32 s41, s41, 4096
    v_mfma_f32_16x16x32_bf16 v[68:71], v[48:51], a[244:247], v[68:71]
    ds_read_b64_tr_b16 v[46:47], v229 offset:11264
    s_add_u32 m0, s47, 102400
    v_mfma_f32_16x16x32_bf16 v[72:75], v[48:51], a[248:251], v[72:75]
    buffer_load_dwordx4 v1, s[28:31], s41 offen sc1 lds
    v_mfma_f32_16x16x32_bf16 v[76:79], v[48:51], a[252:255], v[76:79]
    s_waitcnt lgkmcnt(8)
    s_add_u32 s41, s41, 4096
    s_add_u32 m0, s47, 114688
    v_mfma_f32_16x16x32_bf16 v[80:83], v[52:55], a[240:243], v[80:83]
    v_add_u32 v230, 4294836224, v230
    v_mfma_f32_16x16x32_bf16 v[84:87], v[52:55], a[244:247], v[84:87]
    ds_read_b64_tr_b16 v[48:49], v230 offset:8192
    v_mfma_f32_16x16x32_bf16 v[88:91], v[52:55], a[248:251], v[88:91]
    ds_read_b64_tr_b16 v[50:51], v230 offset:10240
    v_mfma_f32_16x16x32_bf16 v[92:95], v[52:55], a[252:255], v[92:95]
    s_waitcnt lgkmcnt(8)
    v_mfma_f32_16x16x32_bf16 v[96:99], v[56:59], a[240:243], v[96:99]
    ds_read_b64_tr_b16 v[52:53], v230 offset:9216
    v_mfma_f32_16x16x32_bf16 v[100:103], v[56:59], a[244:247], v[100:103]
    ds_read_b64_tr_b16 v[54:55], v230 offset:11264
    v_mfma_f32_16x16x32_bf16 v[104:107], v[56:59], a[248:251], v[104:107]
    buffer_load_dwordx4 v1, s[28:31], s41 offen sc1 lds
    v_mfma_f32_16x16x32_bf16 v[108:111], v[56:59], a[252:255], v[108:111]
    s_waitcnt lgkmcnt(8)
    s_add_u32 s41, s41, 4096
    s_add_u32 m0, s47, 118784
    v_mfma_f32_16x16x32_bf16 v[112:115], v[60:63], a[240:243], v[112:115]
    ds_read_b64_tr_b16 v[56:57], v229 offset:12288
    v_mfma_f32_16x16x32_bf16 v[116:119], v[60:63], a[244:247], v[116:119]
    ds_read_b64_tr_b16 v[58:59], v229 offset:14336
    v_mfma_f32_16x16x32_bf16 v[120:123], v[60:63], a[248:251], v[120:123]
    buffer_load_dwordx4 v1, s[28:31], s41 offen sc1 lds
    v_mfma_f32_16x16x32_bf16 v[124:127], v[60:63], a[252:255], v[124:127]
    s_waitcnt lgkmcnt(8)
    v_mfma_f32_16x16x32_bf16 v[128:131], v[40:43], v[8:11], 0
    ds_read_b64_tr_b16 v[60:61], v229 offset:13312
    v_mfma_f32_16x16x32_bf16 v[132:135], v[40:43], v[12:15], 0
    ds_read_b64_tr_b16 v[62:63], v229 offset:15360
    v_mfma_f32_16x16x32_bf16 v[136:139], v[40:43], v[16:19], 0
    v_mfma_f32_16x16x32_bf16 v[140:143], v[40:43], v[20:23], 0
    s_waitcnt lgkmcnt(8)
    v_mfma_f32_16x16x32_bf16 v[144:147], v[44:47], v[8:11], 0
    ds_read_b64_tr_b16 v[40:41], v230 offset:12288
    v_mfma_f32_16x16x32_bf16 v[148:151], v[44:47], v[12:15], 0
    ds_read_b64_tr_b16 v[42:43], v230 offset:14336
    v_mfma_f32_16x16x32_bf16 v[152:155], v[44:47], v[16:19], 0
    v_mfma_f32_16x16x32_bf16 v[156:159], v[44:47], v[20:23], 0
    s_waitcnt lgkmcnt(8)
    v_mfma_f32_16x16x32_bf16 v[160:163], v[48:51], v[8:11], 0
    ds_read_b64_tr_b16 v[44:45], v230 offset:13312
    v_max_f32 v64, 0, v64
    v_mfma_f32_16x16x32_bf16 v[164:167], v[48:51], v[12:15], 0
    ds_read_b64_tr_b16 v[46:47], v230 offset:15360
    v_max_f32 v65, 0, v65
    v_mfma_f32_16x16x32_bf16 v[168:171], v[48:51], v[16:19], 0
    v_max_f32 v66, 0, v66
    v_max_f32 v67, 0, v67
    v_mfma_f32_16x16x32_bf16 v[172:175], v[48:51], v[20:23], 0
    s_waitcnt lgkmcnt(8)
    v_mul_f32 v64, v64, v80
    v_mul_f32 v65, v65, v81
    v_mfma_f32_16x16x32_bf16 v[176:179], v[52:55], v[8:11], 0
    ds_read_b64_tr_b16 v[48:49], v229 offset:24576
    v_mul_f32 v66, v66, v82
    v_mfma_f32_16x16x32_bf16 v[180:183], v[52:55], v[12:15], 0
    ds_read_b64_tr_b16 v[50:51], v229 offset:26624
    v_mul_f32 v67, v67, v83
    v_mfma_f32_16x16x32_bf16 v[184:187], v[52:55], v[16:19], 0
    v_max_f32 v96, 0, v96
    v_max_f32 v97, 0, v97
    v_mfma_f32_16x16x32_bf16 v[188:191], v[52:55], v[20:23], 0
    s_waitcnt lgkmcnt(8)
    v_max_f32 v98, 0, v98
    v_max_f32 v99, 0, v99
    v_mfma_f32_16x16x32_bf16 v[128:131], v[56:59], v[24:27], v[128:131]
    ds_read_b64_tr_b16 v[52:53], v229 offset:25600
    v_mul_f32 v96, v96, v112
    v_mfma_f32_16x16x32_bf16 v[132:135], v[56:59], v[28:31], v[132:135]
    ds_read_b64_tr_b16 v[54:55], v229 offset:27648
    v_mul_f32 v97, v97, v113
    v_mfma_f32_16x16x32_bf16 v[136:139], v[56:59], v[32:35], v[136:139]
    v_mul_f32 v98, v98, v114
    v_mul_f32 v99, v99, v115
    v_mfma_f32_16x16x32_bf16 v[140:143], v[56:59], v[36:39], v[140:143]
    s_waitcnt lgkmcnt(8)
    s_add_u32 s19, s42, 2048
    v_cvt_pk_bf16_f32 v80, v64, v65
    v_mfma_f32_16x16x32_bf16 v[144:147], v[60:63], v[24:27], v[144:147]
    ds_read_b64_tr_b16 v[56:57], v230 offset:24576
    v_cvt_pk_bf16_f32 v81, v66, v67
    v_mfma_f32_16x16x32_bf16 v[148:151], v[60:63], v[28:31], v[148:151]
    ds_read_b64_tr_b16 v[58:59], v230 offset:26624
    v_cvt_pk_bf16_f32 v82, v96, v97
    v_mfma_f32_16x16x32_bf16 v[152:155], v[60:63], v[32:35], v[152:155]
    v_cvt_pk_bf16_f32 v83, v98, v99
    v_mfma_f32_16x16x32_bf16 v[156:159], v[60:63], v[36:39], v[156:159]
    s_waitcnt lgkmcnt(8)
    v_mfma_f32_16x16x32_bf16 v[160:163], v[40:43], v[24:27], v[160:163]
    ds_read_b64_tr_b16 v[60:61], v230 offset:25600
    v_mfma_f32_16x16x32_bf16 v[164:167], v[40:43], v[28:31], v[164:167]
    ds_read_b64_tr_b16 v[62:63], v230 offset:27648
    v_mfma_f32_16x16x32_bf16 v[168:171], v[40:43], v[32:35], v[168:171]
    buffer_store_dwordx4 v[80:83], v1, s[28:31], s19 offen sc1
    v_mfma_f32_16x16x32_bf16 v[172:175], v[40:43], v[36:39], v[172:175]
    s_waitcnt lgkmcnt(8)
    v_max_f32 v68, 0, v68
    v_max_f32 v69, 0, v69
    v_mfma_f32_16x16x32_bf16 v[176:179], v[44:47], v[24:27], v[176:179]
    ds_read_b64_tr_b16 v[40:41], v229 offset:28672
    v_max_f32 v70, 0, v70
    v_mfma_f32_16x16x32_bf16 v[180:183], v[44:47], v[28:31], v[180:183]
    ds_read_b64_tr_b16 v[42:43], v229 offset:30720
    v_max_f32 v71, 0, v71
    v_mfma_f32_16x16x32_bf16 v[184:187], v[44:47], v[32:35], v[184:187]
    v_mul_f32 v68, v68, v84
    v_mul_f32 v69, v69, v85
    v_mfma_f32_16x16x32_bf16 v[188:191], v[44:47], v[36:39], v[188:191]
    s_waitcnt lgkmcnt(8)
    v_mul_f32 v70, v70, v86
    v_mul_f32 v71, v71, v87
    v_mfma_f32_16x16x32_bf16 v[128:131], v[48:51], a[0:3], v[128:131]
    ds_read_b64_tr_b16 v[44:45], v229 offset:29696
    v_max_f32 v100, 0, v100
    v_mfma_f32_16x16x32_bf16 v[132:135], v[48:51], a[4:7], v[132:135]
    ds_read_b64_tr_b16 v[46:47], v229 offset:31744
    v_max_f32 v101, 0, v101
    v_mfma_f32_16x16x32_bf16 v[136:139], v[48:51], a[8:11], v[136:139]
    v_max_f32 v102, 0, v102
    v_max_f32 v103, 0, v103
    v_mfma_f32_16x16x32_bf16 v[140:143], v[48:51], a[12:15], v[140:143]
    s_waitcnt lgkmcnt(8)
    v_mul_f32 v100, v100, v116
    v_mul_f32 v101, v101, v117
    v_mfma_f32_16x16x32_bf16 v[144:147], v[52:55], a[0:3], v[144:147]
    ds_read_b64_tr_b16 v[48:49], v230 offset:28672
    v_mul_f32 v102, v102, v118
    v_mfma_f32_16x16x32_bf16 v[148:151], v[52:55], a[4:7], v[148:151]
    ds_read_b64_tr_b16 v[50:51], v230 offset:30720
    v_mul_f32 v103, v103, v119
    v_mfma_f32_16x16x32_bf16 v[152:155], v[52:55], a[8:11], v[152:155]
    s_add_u32 s19, s42, 149504
    v_cvt_pk_bf16_f32 v84, v68, v69
    v_cvt_pk_bf16_f32 v85, v70, v71
    v_mfma_f32_16x16x32_bf16 v[156:159], v[52:55], a[12:15], v[156:159]
    s_waitcnt lgkmcnt(8)
    v_cvt_pk_bf16_f32 v86, v100, v101
    v_cvt_pk_bf16_f32 v87, v102, v103
    v_mfma_f32_16x16x32_bf16 v[160:163], v[56:59], a[0:3], v[160:163]
    ds_read_b64_tr_b16 v[52:53], v230 offset:29696
    s_waitcnt vmcnt(5)
    v_mfma_f32_16x16x32_bf16 v[164:167], v[56:59], a[4:7], v[164:167]
    ds_read_b64_tr_b16 v[54:55], v230 offset:31744
    v_cmp_ne_u32 vcc, s8, v250
    s_nop 0
    s_cbranch_vccnz K4_SLOW2
K4_RET2:
    v_mfma_f32_16x16x32_bf16 v[168:171], v[56:59], a[8:11], v[168:171]
    buffer_store_dwordx4 v[84:87], v1, s[28:31], s19 offen sc1
    v_mfma_f32_16x16x32_bf16 v[172:175], v[56:59], a[12:15], v[172:175]
    s_waitcnt lgkmcnt(8)
    s_barrier
    v_max_f32 v72, 0, v72
    v_mfma_f32_16x16x32_bf16 v[176:179], v[60:63], a[0:3], v[176:179]
    ds_read_b64_tr_b16 v[56:57], v229 offset:40960
    s_add_u32 s41, s41, 4096
    v_mfma_f32_16x16x32_bf16 v[180:183], v[60:63], a[4:7], v[180:183]
    ds_read_b64_tr_b16 v[58:59], v229 offset:43008
    s_add_u32 m0, s47, 131072
    v_mfma_f32_16x16x32_bf16 v[184:187], v[60:63], a[8:11], v[184:187]
    buffer_load_dwordx4 v1, s[28:31], s41 offen sc1 lds
    v_mfma_f32_16x16x32_bf16 v[188:191], v[60:63], a[12:15], v[188:191]
    s_waitcnt lgkmcnt(8)
    s_add_u32 s41, s41, 4096
    s_add_u32 m0, s47, 135168
    v_mfma_f32_16x16x32_bf16 v[128:131], v[40:43], a[16:19], v[128:131]
    ds_read_b64_tr_b16 v[60:61], v229 offset:41984
    v_max_f32 v73, 0, v73
    v_mfma_f32_16x16x32_bf16 v[132:135], v[40:43], a[20:23], v[132:135]
    ds_read_b64_tr_b16 v[62:63], v229 offset:44032
    v_max_f32 v74, 0, v74
    v_mfma_f32_16x16x32_bf16 v[136:139], v[40:43], a[24:27], v[136:139]
    buffer_load_dwordx4 v1, s[28:31], s41 offen sc1 lds
    v_mfma_f32_16x16x32_bf16 v[140:143], v[40:43], a[28:31], v[140:143]
    s_waitcnt lgkmcnt(8)
    s_add_u32 s49, s48, 0
    v_max_f32 v75, 0, v75
    v_mfma_f32_16x16x32_bf16 v[144:147], v[44:47], a[16:19], v[144:147]
    ds_read_b64_tr_b16 v[40:41], v230 offset:40960
    v_mul_f32 v72, v72, v88
    v_mfma_f32_16x16x32_bf16 v[148:151], v[44:47], a[20:23], v[148:151]
    ds_read_b64_tr_b16 v[42:43], v230 offset:43008
    v_mul_f32 v73, v73, v89
    v_mfma_f32_16x16x32_bf16 v[152:155], v[44:47], a[24:27], v[152:155]
    buffer_load_dwordx4 a[0:3], v1, s[28:31], s49 offen offset:0 sc1
    v_mfma_f32_16x16x32_bf16 v[156:159], v[44:47], a[28:31], v[156:159]
    s_waitcnt lgkmcnt(8)
    v_mul_f32 v74, v74, v90
    v_mul_f32 v75, v75, v91
    v_mfma_f32_16x16x32_bf16 v[160:163], v[48:51], a[16:19], v[160:163]
    ds_read_b64_tr_b16 v[44:45], v230 offset:41984
    v_max_f32 v104, 0, v104
    v_mfma_f32_16x16x32_bf16 v[164:167], v[48:51], a[20:23], v[164:167]
    ds_read_b64_tr_b16 v[46:47], v230 offset:44032
    v_max_f32 v105, 0, v105
    v_mfma_f32_16x16x32_bf16 v[168:171], v[48:51], a[24:27], v[168:171]
    buffer_load_dwordx4 a[4:7], v236, s[28:31], s49 offen offset:0 sc1
    v_mfma_f32_16x16x32_bf16 v[172:175], v[48:51], a[28:31], v[172:175]
    s_waitcnt lgkmcnt(8)
    v_max_f32 v106, 0, v106
    v_max_f32 v107, 0, v107
    v_mfma_f32_16x16x32_bf16 v[176:179], v[52:55], a[16:19], v[176:179]
    ds_read_b64_tr_b16 v[48:49], v229 offset:45056
    v_mul_f32 v104, v104, v120
    v_mfma_f32_16x16x32_bf16 v[180:183], v[52:55], a[20:23], v[180:183]
    ds_read_b64_tr_b16 v[50:51], v229 offset:47104
    v_mul_f32 v105, v105, v121
    v_mfma_f32_16x16x32_bf16 v[184:187], v[52:55], a[24:27], v[184:187]
    v_mul_f32 v106, v106, v122
    v_mul_f32 v107, v107, v123
    v_mfma_f32_16x16x32_bf16 v[188:191], v[52:55], a[28:31], v[188:191]
    s_waitcnt lgkmcnt(8)
    s_add_u32 s19, s42, 296960
    v_cvt_pk_bf16_f32 v88, v72, v73
    v_mfma_f32_16x16x32_bf16 v[128:131], v[56:59], a[32:35], v[128:131]
    ds_read_b64_tr_b16 v[52:53], v229 offset:46080
    v_cvt_pk_bf16_f32 v89, v74, v75
    v_mfma_f32_16x16x32_bf16 v[132:135], v[56:59], a[36:39], v[132:135]
    ds_read_b64_tr_b16 v[54:55], v229 offset:48128
    v_cvt_pk_bf16_f32 v90, v104, v105
    v_mfma_f32_16x16x32_bf16 v[136:139], v[56:59], a[40:43], v[136:139]
    buffer_load_dwordx4 a[8:11], v1, s[28:31], s49 offen offset:1024 sc1
    v_mfma_f32_16x16x32_bf16 v[140:143], v[56:59], a[44:47], v[140:143]
    s_waitcnt lgkmcnt(8)
    v_cvt_pk_bf16_f32 v91, v106, v107
    v_mfma_f32_16x16x32_bf16 v[144:147], v[60:63], a[32:35], v[144:147]
    ds_read_b64_tr_b16 v[56:57], v230 offset:45056
    v_mfma_f32_16x16x32_bf16 v[148:151], v[60:63], a[36:39], v[148:151]
    ds_read_b64_tr_b16 v[58:59], v230 offset:47104
    v_mfma_f32_16x16x32_bf16 v[152:155], v[60:63], a[40:43], v[152:155]
    buffer_store_dwordx4 v[88:91], v1, s[28:31], s19 offen sc1
    v_mfma_f32_16x16x32_bf16 v[156:159], v[60:63], a[44:47], v[156:159]
    s_waitcnt lgkmcnt(8)
    buffer_load_dwordx4 a[12:15], v236, s[28:31], s49 offen offset:1024 sc1
    v_mfma_f32_16x16x32_bf16 v[160:163], v[40:43], a[32:35], v[160:163]
    ds_read_b64_tr_b16 v[60:61], v230 offset:46080
    s_add_u32 s49, s48, 4096
    v_mfma_f32_16x16x32_bf16 v[164:167], v[40:43], a[36:39], v[164:167]
    ds_read_b64_tr_b16 v[62:63], v230 offset:48128
    v_max_f32 v76, 0, v76
    v_mfma_f32_16x16x32_bf16 v[168:171], v[40:43], a[40:43], v[168:171]
    buffer_load_dwordx4 a[16:19], v1, s[28:31], s49 offen offset:0 sc1
    v_mfma_f32_16x16x32_bf16 v[172:175], v[40:43], a[44:47], v[172:175]
    s_waitcnt lgkmcnt(8)
    v_max_f32 v77, 0, v77
    v_max_f32 v78, 0, v78
    v_mfma_f32_16x16x32_bf16 v[176:179], v[44:47], a[32:35], v[176:179]
    ds_read_b64_tr_b16 v[40:41], v229 offset:57344
    v_max_f32 v79, 0, v79
    v_mfma_f32_16x16x32_bf16 v[180:183], v[44:47], a[36:39], v[180:183]
    ds_read_b64_tr_b16 v[42:43], v229 offset:59392
    v_mul_f32 v76, v76, v92
    v_mfma_f32_16x16x32_bf16 v[184:187], v[44:47], a[40:43], v[184:187]
    buffer_load_dwordx4 a[20:23], v236, s[28:31], s49 offen offset:0 sc1
    v_mfma_f32_16x16x32_bf16 v[188:191], v[44:47], a[44:47], v[188:191]
    s_waitcnt lgkmcnt(8)
    v_mul_f32 v77, v77, v93
    v_mul_f32 v78, v78, v94
    v_mfma_f32_16x16x32_bf16 v[128:131], v[48:51], a[48:51], v[128:131]
    ds_read_b64_tr_b16 v[44:45], v229 offset:58368
    v_mul_f32 v79, v79, v95
    v_mfma_f32_16x16x32_bf16 v[132:135], v[48:51], a[52:55], v[132:135]
    ds_read_b64_tr_b16 v[46:47], v229 offset:60416
    v_max_f32 v108, 0, v108
    v_mfma_f32_16x16x32_bf16 v[136:139], v[48:51], a[56:59], v[136:139]
    v_max_f32 v109, 0, v109
    v_max_f32 v110, 0, v110
    v_mfma_f32_16x16x32_bf16 v[140:143], v[48:51], a[60:63], v[140:143]
    s_waitcnt lgkmcnt(8)
    v_max_f32 v111, 0, v111
    v_mul_f32 v108, v108, v124
    v_mfma_f32_16x16x32_bf16 v[144:147], v[52:55], a[48:51], v[144:147]
    ds_read_b64_tr_b16 v[48:49], v230 offset:57344
    v_mul_f32 v109, v109, v125
    v_mfma_f32_16x16x32_bf16 v[148:151], v[52:55], a[52:55], v[148:151]
    ds_read_b64_tr_b16 v[50:51], v230 offset:59392
    v_mul_f32 v110, v110, v126
    v_mfma_f32_16x16x32_bf16 v[152:155], v[52:55], a[56:59], v[152:155]
    buffer_load_dwordx4 a[24:27], v1, s[28:31], s49 offen offset:1024 sc1
    v_mfma_f32_16x16x32_bf16 v[156:159], v[52:55], a[60:63], v[156:159]
    s_waitcnt lgkmcnt(8)
    v_mul_f32 v111, v111, v127
    s_add_u32 s19, s42, 444416
    v_mfma_f32_16x16x32_bf16 v[160:163], v[56:59], a[48:51], v[160:163]
    ds_read_b64_tr_b16 v[52:53], v230 offset:58368
    v_cvt_pk_bf16_f32 v92, v76, v77
    v_mfma_f32_16x16x32_bf16 v[164:167], v[56:59], a[52:55], v[164:167]
    ds_read_b64_tr_b16 v[54:55], v230 offset:60416
    v_cvt_pk_bf16_f32 v93, v78, v79
    v_mfma_f32_16x16x32_bf16 v[168:171], v[56:59], a[56:59], v[168:171]
    buffer_load_dwordx4 a[28:31], v236, s[28:31], s49 offen offset:1024 sc1
    v_mfma_f32_16x16x32_bf16 v[172:175], v[56:59], a[60:63], v[172:175]
    s_waitcnt lgkmcnt(8)
    s_add_u32 s49, s48, 8192
    v_cvt_pk_bf16_f32 v94, v108, v109
    v_mfma_f32_16x16x32_bf16 v[176:179], v[60:63], a[48:51], v[176:179]
    ds_read_b64_tr_b16 v[56:57], v229 offset:61440
    v_cvt_pk_bf16_f32 v95, v110, v111
    v_mfma_f32_16x16x32_bf16 v[180:183], v[60:63], a[52:55], v[180:183]
    ds_read_b64_tr_b16 v[58:59], v229 offset:63488
    v_mfma_f32_16x16x32_bf16 v[184:187], v[60:63], a[56:59], v[184:187]
    buffer_store_dwordx4 v[92:95], v1, s[28:31], s19 offen sc1
    v_mfma_f32_16x16x32_bf16 v[188:191], v[60:63], a[60:63], v[188:191]
    s_waitcnt lgkmcnt(8)
    buffer_load_dwordx4 a[32:35], v1, s[28:31], s49 offen offset:0 sc1
    v_mfma_f32_16x16x32_bf16 v[128:131], v[40:43], a[64:67], v[128:131]
    ds_read_b64_tr_b16 v[60:61], v229 offset:62464
    v_mfma_f32_16x16x32_bf16 v[132:135], v[40:43], a[68:71], v[132:135]
    ds_read_b64_tr_b16 v[62:63], v229 offset:64512
    v_mfma_f32_16x16x32_bf16 v[136:139], v[40:43], a[72:75], v[136:139]
    buffer_load_dwordx4 a[36:39], v236, s[28:31], s49 offen offset:0 sc1
    v_mfma_f32_16x16x32_bf16 v[140:143], v[40:43], a[76:79], v[140:143]
    s_waitcnt lgkmcnt(8)
    v_mfma_f32_16x16x32_bf16 v[144:147], v[44:47], a[64:67], v[144:147]
    ds_read_b64_tr_b16 v[40:41], v230 offset:61440
    v_mfma_f32_16x16x32_bf16 v[148:151], v[44:47], a[68:71], v[148:151]
    ds_read_b64_tr_b16 v[42:43], v230 offset:63488
    v_mfma_f32_16x16x32_bf16 v[152:155], v[44:47], a[72:75], v[152:155]
    v_mfma_f32_16x16x32_bf16 v[156:159], v[44:47], a[76:79], v[156:159]
    s_waitcnt lgkmcnt(8)
    v_mfma_f32_16x16x32_bf16 v[160:163], v[48:51], a[64:67], v[160:163]
    ds_read_b64_tr_b16 v[44:45], v230 offset:62464
    v_mfma_f32_16x16x32_bf16 v[164:167], v[48:51], a[68:71], v[164:167]
    ds_read_b64_tr_b16 v[46:47], v230 offset:64512
    v_mfma_f32_16x16x32_bf16 v[168:171], v[48:51], a[72:75], v[168:171]
    buffer_load_dwordx4 a[40:43], v1, s[28:31], s49 offen offset:1024 sc1
    v_mfma_f32_16x16x32_bf16 v[172:175], v[48:51], a[76:79], v[172:175]
    s_waitcnt lgkmcnt(8)
    s_barrier
    v_mfma_f32_16x16x32_bf16 v[176:179], v[52:55], a[64:67], v[176:179]
    v_add_u32 v229, 73728, v229
    v_mfma_f32_16x16x32_bf16 v[180:183], v[52:55], a[68:71], v[180:183]
    ds_read_b64_tr_b16 v[48:49], v229 offset:0
    v_mfma_f32_16x16x32_bf16 v[184:187], v[52:55], a[72:75], v[184:187]
    ds_read_b64_tr_b16 v[50:51], v229 offset:2048
    v_mfma_f32_16x16x32_bf16 v[188:191], v[52:55], a[76:79], v[188:191]
    s_waitcnt lgkmcnt(8)
    buffer_load_dwordx4 a[44:47], v236, s[28:31], s49 offen offset:1024 sc1
    v_mfma_f32_16x16x32_bf16 v[128:131], v[56:59], a[80:83], v[128:131]
    ds_read_b64_tr_b16 v[52:53], v229 offset:1024
    s_add_u32 s49, s48, 12288
    v_mfma_f32_16x16x32_bf16 v[132:135], v[56:59], a[84:87], v[132:135]
    ds_read_b64_tr_b16 v[54:55], v229 offset:3072
    v_mfma_f32_16x16x32_bf16 v[136:139], v[56:59], a[88:91], v[136:139]
    buffer_load_dwordx4 a[48:51], v1, s[28:31], s49 offen offset:0 sc1
    v_mfma_f32_16x16x32_bf16 v[140:143], v[56:59], a[92:95], v[140:143]
    s_waitcnt lgkmcnt(8)
    v_mfma_f32_16x16x32_bf16 v[144:147], v[60:63], a[80:83], v[144:147]
    v_add_u32 v230, 73728, v230
    v_mfma_f32_16x16x32_bf16 v[148:151], v[60:63], a[84:87], v[148:151]
    ds_read_b64_tr_b16 v[56:57], v230 offset:0
    v_mfma_f32_16x16x32_bf16 v[152:155], v[60:63], a[88:91], v[152:155]
    ds_read_b64_tr_b16 v[58:59], v230 offset:2048
    v_mfma_f32_16x16x32_bf16 v[156:159], v[60:63], a[92:95], v[156:159]
    s_waitcnt lgkmcnt(8)
    v_mfma_f32_16x16x32_bf16 v[160:163], v[40:43], a[80:83], v[160:163]
    ds_read_b64_tr_b16 v[60:61], v230 offset:1024
    v_mfma_f32_16x16x32_bf16 v[164:167], v[40:43], a[84:87], v[164:167]
    ds_read_b64_tr_b16 v[62:63], v230 offset:3072
    v_mfma_f32_16x16x32_bf16 v[168:171], v[40:43], a[88:91], v[168:171]
    buffer_load_dwordx4 a[52:55], v236, s[28:31], s49 offen offset:0 sc1
    v_mfma_f32_16x16x32_bf16 v[172:175], v[40:43], a[92:95], v[172:175]
    s_waitcnt lgkmcnt(8)
    v_mfma_f32_16x16x32_bf16 v[176:179], v[44:47], a[80:83], v[176:179]
    ds_read_b64_tr_b16 v[40:41], v229 offset:4096
    v_mfma_f32_16x16x32_bf16 v[180:183], v[44:47], a[84:87], v[180:183]
    ds_read_b64_tr_b16 v[42:43], v229 offset:6144
    v_mfma_f32_16x16x32_bf16 v[184:187], v[44:47], a[88:91], v[184:187]
    buffer_load_dwordx4 a[56:59], v1, s[28:31], s49 offen offset:1024 sc1
    v_mfma_f32_16x16x32_bf16 v[188:191], v[44:47], a[92:95], v[188:191]
    s_waitcnt lgkmcnt(8)
    v_mfma_f32_16x16x32_bf16 v[128:131], v[48:51], a[96:99], v[128:131]
    ds_read_b64_tr_b16 v[44:45], v229 offset:5120
    v_mfma_f32_16x16x32_bf16 v[132:135], v[48:51], a[100:103], v[132:135]
    ds_read_b64_tr_b16 v[46:47], v229 offset:7168
    v_mfma_f32_16x16x32_bf16 v[136:139], v[48:51], a[104:107], v[136:139]
    buffer_load_dwordx4 a[60:63], v236, s[28:31], s49 offen offset:1024 sc1
    v_mfma_f32_16x16x32_bf16 v[140:143], v[48:51], a[108:111], v[140:143]
    s_waitcnt lgkmcnt(8)
    s_add_u32 s49, s48, 18432
    v_mfma_f32_16x16x32_bf16 v[144:147], v[52:55], a[96:99], v[144:147]
    ds_read_b64_tr_b16 v[48:49], v230 offset:4096
    v_mfma_f32_16x16x32_bf16 v[148:151], v[52:55], a[100:103], v[148:151]
    ds_read_b64_tr_b16 v[50:51], v230 offset:6144
    v_mfma_f32_16x16x32_bf16 v[152:155], v[52:55], a[104:107], v[152:155]
    buffer_load_dwordx4 a[64:67], v1, s[28:31], s49 offen offset:0 sc1
    v_mfma_f32_16x16x32_bf16 v[156:159], v[52:55], a[108:111], v[156:159]
    s_waitcnt lgkmcnt(8)
    v_mfma_f32_16x16x32_bf16 v[160:163], v[56:59], a[96:99], v[160:163]
    ds_read_b64_tr_b16 v[52:53], v230 offset:5120
    v_mfma_f32_16x16x32_bf16 v[164:167], v[56:59], a[100:103], v[164:167]
    ds_read_b64_tr_b16 v[54:55], v230 offset:7168
    v_mfma_f32_16x16x32_bf16 v[168:171], v[56:59], a[104:107], v[168:171]
    v_mfma_f32_16x16x32_bf16 v[172:175], v[56:59], a[108:111], v[172:175]
    s_waitcnt lgkmcnt(8)
    v_mfma_f32_16x16x32_bf16 v[176:179], v[60:63], a[96:99], v[176:179]
    ds_read_b64_tr_b16 v[56:57], v229 offset:16384
    v_mfma_f32_16x16x32_bf16 v[180:183], v[60:63], a[100:103], v[180:183]
    ds_read_b64_tr_b16 v[58:59], v229 offset:18432
    v_mfma_f32_16x16x32_bf16 v[184:187], v[60:63], a[104:107], v[184:187]
    buffer_load_dwordx4 a[68:71], v236, s[28:31], s49 offen offset:0 sc1
    v_mfma_f32_16x16x32_bf16 v[188:191], v[60:63], a[108:111], v[188:191]
    s_waitcnt lgkmcnt(8)
    v_mfma_f32_16x16x32_bf16 v[128:131], v[40:43], a[112:115], v[128:131]
    ds_read_b64_tr_b16 v[60:61], v229 offset:17408
    v_mfma_f32_16x16x32_bf16 v[132:135], v[40:43], a[116:119], v[132:135]
    ds_read_b64_tr_b16 v[62:63], v229 offset:19456
    v_mfma_f32_16x16x32_bf16 v[136:139], v[40:43], a[120:123], v[136:139]
    buffer_load_dwordx4 a[72:75], v1, s[28:31], s49 offen offset:1024 sc1
    v_mfma_f32_16x16x32_bf16 v[140:143], v[40:43], a[124:127], v[140:143]
    s_waitcnt lgkmcnt(8)
    v_mfma_f32_16x16x32_bf16 v[144:147], v[44:47], a[112:115], v[144:147]
    ds_read_b64_tr_b16 v[40:41], v230 offset:16384
    v_mfma_f32_16x16x32_bf16 v[148:151], v[44:47], a[116:119], v[148:151]
    ds_read_b64_tr_b16 v[42:43], v230 offset:18432
    v_mfma_f32_16x16x32_bf16 v[152:155], v[44:47], a[120:123], v[152:155]
    buffer_load_dwordx4 a[76:79], v236, s[28:31], s49 offen offset:1024 sc1
    v_mfma_f32_16x16x32_bf16 v[156:159], v[44:47], a[124:127], v[156:159]
    s_waitcnt lgkmcnt(8)
    s_add_u32 s49, s48, 22528
    v_mfma_f32_16x16x32_bf16 v[160:163], v[48:51], a[112:115], v[160:163]
    ds_read_b64_tr_b16 v[44:45], v230 offset:17408
    v_mfma_f32_16x16x32_bf16 v[164:167], v[48:51], a[116:119], v[164:167]
    ds_read_b64_tr_b16 v[46:47], v230 offset:19456
    v_mfma_f32_16x16x32_bf16 v[168:171], v[48:51], a[120:123], v[168:171]
    buffer_load_dwordx4 a[80:83], v1, s[28:31], s49 offen offset:0 sc1
    v_mfma_f32_16x16x32_bf16 v[172:175], v[48:51], a[124:127], v[172:175]
    s_waitcnt lgkmcnt(8)
    v_mfma_f32_16x16x32_bf16 v[176:179], v[52:55], a[112:115], v[176:179]
    ds_read_b64_tr_b16 v[48:49], v229 offset:20480
    v_mfma_f32_16x16x32_bf16 v[180:183], v[52:55], a[116:119], v[180:183]
    ds_read_b64_tr_b16 v[50:51], v229 offset:22528
    v_mfma_f32_16x16x32_bf16 v[184:187], v[52:55], a[120:123], v[184:187]
    v_mfma_f32_16x16x32_bf16 v[188:191], v[52:55], a[124:127], v[188:191]
    s_waitcnt lgkmcnt(8)
    v_mfma_f32_16x16x32_bf16 v[128:131], v[56:59], a[128:131], v[128:131]
    ds_read_b64_tr_b16 v[52:53], v229 offset:21504
    v_mfma_f32_16x16x32_bf16 v[132:135], v[56:59], a[132:135], v[132:135]
    ds_read_b64_tr_b16 v[54:55], v229 offset:23552
    v_mfma_f32_16x16x32_bf16 v[136:139], v[56:59], a[136:139], v[136:139]
    buffer_load_dwordx4 a[84:87], v236, s[28:31], s49 offen offset:0 sc1
    v_mfma_f32_16x16x32_bf16 v[140:143], v[56:59], a[140:143], v[140:143]
    s_waitcnt lgkmcnt(8)
    v_mfma_f32_16x16x32_bf16 v[144:147], v[60:63], a[128:131], v[144:147]
    ds_read_b64_tr_b16 v[56:57], v230 offset:20480
    v_mfma_f32_16x16x32_bf16 v[148:151], v[60:63], a[132:135], v[148:151]
    ds_read_b64_tr_b16 v[58:59], v230 offset:22528
    v_mfma_f32_16x16x32_bf16 v[152:155], v[60:63], a[136:139], v[152:155]
    buffer_load_dwordx4 a[88:91], v1, s[28:31], s49 offen offset:1024 sc1
    v_mfma_f32_16x16x32_bf16 v[156:159], v[60:63], a[140:143], v[156:159]
    s_waitcnt lgkmcnt(8)
    v_mfma_f32_16x16x32_bf16 v[160:163], v[40:43], a[128:131], v[160:163]
    ds_read_b64_tr_b16 v[60:61], v230 offset:21504
    s_waitcnt vmcnt(15)
    v_mfma_f32_16x16x32_bf16 v[164:167], v[40:43], a[132:135], v[164:167]
    ds_read_b64_tr_b16 v[62:63], v230 offset:23552
    v_mfma_f32_16x16x32_bf16 v[168:171], v[40:43], a[136:139], v[168:171]
    buffer_store_dword v252, v251, s[28:31], s60 offen sc1
    v_mfma_f32_16x16x32_bf16 v[172:175], v[40:43], a[140:143], v[172:175]
    s_waitcnt lgkmcnt(8)
    s_barrier
    buffer_load_dwordx4 a[92:95], v236, s[28:31], s49 offen offset:1024 sc1
    v_mfma_f32_16x16x32_bf16 v[176:179], v[44:47], a[128:131], v[176:179]
    ds_read_b64_tr_b16 v[40:41], v229 offset:32768
    s_add_u32 s49, s48, 26624
    v_mfma_f32_16x16x32_bf16 v[180:183], v[44:47], a[132:135], v[180:183]
    ds_read_b64_tr_b16 v[42:43], v229 offset:34816
    s_add_u32 s60, s60, 131072
    v_mfma_f32_16x16x32_bf16 v[184:187], v[44:47], a[136:139], v[184:187]
    buffer_load_dwordx4 a[96:99], v1, s[28:31], s49 offen offset:0 sc1
    v_mfma_f32_16x16x32_bf16 v[188:191], v[44:47], a[140:143], v[188:191]
    s_waitcnt lgkmcnt(8)
    v_mfma_f32_16x16x32_bf16 v[128:131], v[48:51], a[144:147], v[128:131]
    ds_read_b64_tr_b16 v[44:45], v229 offset:33792
    v_mfma_f32_16x16x32_bf16 v[132:135], v[48:51], a[148:151], v[132:135]
    ds_read_b64_tr_b16 v[46:47], v229 offset:35840
    v_mfma_f32_16x16x32_bf16 v[136:139], v[48:51], a[152:155], v[136:139]
    buffer_store_dword v252, v251, s[28:31], s59 offen sc1
    v_mfma_f32_16x16x32_bf16 v[140:143], v[48:51], a[156:159], v[140:143]
    s_waitcnt lgkmcnt(8)
    v_mfma_f32_16x16x32_bf16 v[144:147], v[52:55], a[144:147], v[144:147]
    ds_read_b64_tr_b16 v[48:49], v230 offset:32768
    v_mfma_f32_16x16x32_bf16 v[148:151], v[52:55], a[148:151], v[148:151]
    ds_read_b64_tr_b16 v[50:51], v230 offset:34816
    v_mfma_f32_16x16x32_bf16 v[152:155], v[52:55], a[152:155], v[152:155]
    buffer_load_dwordx4 a[100:103], v236, s[28:31], s49 offen offset:0 sc1
    v_mfma_f32_16x16x32_bf16 v[156:159], v[52:55], a[156:159], v[156:159]
    s_waitcnt lgkmcnt(8)
    v_mfma_f32_16x16x32_bf16 v[160:163], v[56:59], a[144:147], v[160:163]
    ds_read_b64_tr_b16 v[52:53], v230 offset:33792
    v_mfma_f32_16x16x32_bf16 v[164:167], v[56:59], a[148:151], v[164:167]
    ds_read_b64_tr_b16 v[54:55], v230 offset:35840
    v_mfma_f32_16x16x32_bf16 v[168:171], v[56:59], a[152:155], v[168:171]
    buffer_load_dwordx4 a[104:107], v1, s[28:31], s49 offen offset:1024 sc1
    v_mfma_f32_16x16x32_bf16 v[172:175], v[56:59], a[156:159], v[172:175]
    s_waitcnt lgkmcnt(8)
    v_mfma_f32_16x16x32_bf16 v[176:179], v[60:63], a[144:147], v[176:179]
    ds_read_b64_tr_b16 v[56:57], v229 offset:36864
    v_mfma_f32_16x16x32_bf16 v[180:183], v[60:63], a[148:151], v[180:183]
    ds_read_b64_tr_b16 v[58:59], v229 offset:38912
    v_mfma_f32_16x16x32_bf16 v[184:187], v[60:63], a[152:155], v[184:187]
    buffer_load_dwordx4 a[108:111], v236, s[28:31], s49 offen offset:1024 sc1
    v_mfma_f32_16x16x32_bf16 v[188:191], v[60:63], a[156:159], v[188:191]
    s_waitcnt lgkmcnt(8)
    s_add_u32 s41, s41, 4096
    s_add_u32 m0, s47, 8192
    v_mfma_f32_16x16x32_bf16 v[128:131], v[40:43], a[160:163], v[128:131]
    ds_read_b64_tr_b16 v[60:61], v229 offset:37888
    v_mfma_f32_16x16x32_bf16 v[132:135], v[40:43], a[164:167], v[132:135]
    ds_read_b64_tr_b16 v[62:63], v229 offset:39936
    v_mfma_f32_16x16x32_bf16 v[136:139], v[40:43], a[168:171], v[136:139]
    buffer_load_dwordx4 v1, s[28:31], s41 offen sc1 lds
    v_mfma_f32_16x16x32_bf16 v[140:143], v[40:43], a[172:175], v[140:143]
    s_waitcnt lgkmcnt(8)
    s_add_u32 s41, s41, 4096
    s_add_u32 m0, s47, 12288
    v_mfma_f32_16x16x32_bf16 v[144:147], v[44:47], a[160:163], v[144:147]
    ds_read_b64_tr_b16 v[40:41], v230 offset:36864
    v_mfma_f32_16x16x32_bf16 v[148:151], v[44:47], a[164:167], v[148:151]
    ds_read_b64_tr_b16 v[42:43], v230 offset:38912
    v_mfma_f32_16x16x32_bf16 v[152:155], v[44:47], a[168:171], v[152:155]
    v_mfma_f32_16x16x32_bf16 v[156:159], v[44:47], a[172:175], v[156:159]
    s_waitcnt lgkmcnt(8)
    v_mfma_f32_16x16x32_bf16 v[160:163], v[48:51], a[160:163], v[160:163]
    ds_read_b64_tr_b16 v[44:45], v230 offset:37888
    v_mfma_f32_16x16x32_bf16 v[164:167], v[48:51], a[164:167], v[164:167]
    ds_read_b64_tr_b16 v[46:47], v230 offset:39936
    v_mfma_f32_16x16x32_bf16 v[168:171], v[48:51], a[168:171], v[168:171]
    buffer_load_dwordx4 v1, s[28:31], s41 offen sc1 lds
    v_mfma_f32_16x16x32_bf16 v[172:175], v[48:51], a[172:175], v[172:175]
    s_waitcnt lgkmcnt(8)
    s_add_u32 s49, s48, 30720
    v_mfma_f32_16x16x32_bf16 v[176:179], v[52:55], a[160:163], v[176:179]
    ds_read_b64_tr_b16 v[48:49], v229 offset:49152
    v_mfma_f32_16x16x32_bf16 v[180:183], v[52:55], a[164:167], v[180:183]
    ds_read_b64_tr_b16 v[50:51], v229 offset:51200
    v_mfma_f32_16x16x32_bf16 v[184:187], v[52:55], a[168:171], v[184:187]
    buffer_load_dwordx4 a[112:115], v1, s[28:31], s49 offen offset:0 sc1
    v_mfma_f32_16x16x32_bf16 v[188:191], v[52:55], a[172:175], v[188:191]
    s_waitcnt lgkmcnt(8)
    v_mfma_f32_16x16x32_bf16 v[128:131], v[56:59], a[176:179], v[128:131]
    ds_read_b64_tr_b16 v[52:53], v229 offset:50176
    v_mfma_f32_16x16x32_bf16 v[132:135], v[56:59], a[180:183], v[132:135]
    ds_read_b64_tr_b16 v[54:55], v229 offset:52224
    v_mfma_f32_16x16x32_bf16 v[136:139], v[56:59], a[184:187], v[136:139]
    buffer_load_dwordx4 a[116:119], v236, s[28:31], s49 offen offset:0 sc1
    v_mfma_f32_16x16x32_bf16 v[140:143], v[56:59], a[188:191], v[140:143]
    s_waitcnt lgkmcnt(8)
    v_mfma_f32_16x16x32_bf16 v[144:147], v[60:63], a[176:179], v[144:147]
    ds_read_b64_tr_b16 v[56:57], v230 offset:49152
    v_mfma_f32_16x16x32_bf16 v[148:151], v[60:63], a[180:183], v[148:151]
    ds_read_b64_tr_b16 v[58:59], v230 offset:51200
    v_mfma_f32_16x16x32_bf16 v[152:155], v[60:63], a[184:187], v[152:155]
    buffer_load_dwordx4 a[120:123], v1, s[28:31], s49 offen offset:1024 sc1
    v_mfma_f32_16x16x32_bf16 v[156:159], v[60:63], a[188:191], v[156:159]
    s_waitcnt lgkmcnt(8)
    v_mfma_f32_16x16x32_bf16 v[160:163], v[40:43], a[176:179], v[160:163]
    ds_read_b64_tr_b16 v[60:61], v230 offset:50176
    v_mfma_f32_16x16x32_bf16 v[164:167], v[40:43], a[180:183], v[164:167]
    ds_read_b64_tr_b16 v[62:63], v230 offset:52224
    v_mfma_f32_16x16x32_bf16 v[168:171], v[40:43], a[184:187], v[168:171]
    v_mfma_f32_16x16x32_bf16 v[172:175], v[40:43], a[188:191], v[172:175]
    s_waitcnt lgkmcnt(8)
    v_mfma_f32_16x16x32_bf16 v[176:179], v[44:47], a[176:179], v[176:179]
    ds_read_b64_tr_b16 v[40:41], v229 offset:53248
    v_mfma_f32_16x16x32_bf16 v[180:183], v[44:47], a[180:183], v[180:183]
    ds_read_b64_tr_b16 v[42:43], v229 offset:55296
    v_mfma_f32_16x16x32_bf16 v[184:187], v[44:47], a[184:187], v[184:187]
    buffer_load_dwordx4 a[124:127], v236, s[28:31], s49 offen offset:1024 sc1
    v_mfma_f32_16x16x32_bf16 v[188:191], v[44:47], a[188:191], v[188:191]
    s_waitcnt lgkmcnt(8)
    s_add_u32 s41, s41, 4096
    s_add_u32 m0, s47, 24576
    v_mfma_f32_16x16x32_bf16 v[128:131], v[48:51], a[192:195], v[128:131]
    ds_read_b64_tr_b16 v[44:45], v229 offset:54272
    v_mfma_f32_16x16x32_bf16 v[132:135], v[48:51], a[196:199], v[132:135]
    ds_read_b64_tr_b16 v[46:47], v229 offset:56320
    v_mfma_f32_16x16x32_bf16 v[136:139], v[48:51], a[200:203], v[136:139]
    buffer_load_dwordx4 v1, s[28:31], s41 offen sc1 lds
    v_mfma_f32_16x16x32_bf16 v[140:143], v[48:51], a[204:207], v[140:143]
    s_waitcnt lgkmcnt(8)
    s_add_u32 s41, s41, 4096
    s_add_u32 m0, s47, 28672
    v_mfma_f32_16x16x32_bf16 v[144:147], v[52:55], a[192:195], v[144:147]
    ds_read_b64_tr_b16 v[48:49], v230 offset:53248
    v_mfma_f32_16x16x32_bf16 v[148:151], v[52:55], a[196:199], v[148:151]
    ds_read_b64_tr_b16 v[50:51], v230 offset:55296
    v_mfma_f32_16x16x32_bf16 v[152:155], v[52:55], a[200:203], v[152:155]
    buffer_load_dwordx4 v1, s[28:31], s41 offen sc1 lds
    v_mfma_f32_16x16x32_bf16 v[156:159], v[52:55], a[204:207], v[156:159]
    s_waitcnt lgkmcnt(8)
    s_add_u32 s41, s41, 4096
    s_add_u32 m0, s47, 40960
    v_mfma_f32_16x16x32_bf16 v[160:163], v[56:59], a[192:195], v[160:163]
    ds_read_b64_tr_b16 v[52:53], v230 offset:54272
    v_mfma_f32_16x16x32_bf16 v[164:167], v[56:59], a[196:199], v[164:167]
    ds_read_b64_tr_b16 v[54:55], v230 offset:56320
    v_mfma_f32_16x16x32_bf16 v[168:171], v[56:59], a[200:203], v[168:171]
    buffer_load_dwordx4 v1, s[28:31], s41 offen sc1 lds
    v_mfma_f32_16x16x32_bf16 v[172:175], v[56:59], a[204:207], v[172:175]
    s_waitcnt lgkmcnt(8)
    s_add_u32 s41, s41, 4096
    s_add_u32 m0, s47, 45056
    v_mfma_f32_16x16x32_bf16 v[176:179], v[60:63], a[192:195], v[176:179]
    v_add_u32 v229, 65536, v229
    v_mfma_f32_16x16x32_bf16 v[180:183], v[60:63], a[196:199], v[180:183]
    ds_read_b64_tr_b16 v[56:57], v229 offset:0
    v_mfma_f32_16x16x32_bf16 v[184:187], v[60:63], a[200:203], v[184:187]
    ds_read_b64_tr_b16 v[58:59], v229 offset:2048
    v_mfma_f32_16x16x32_bf16 v[188:191], v[60:63], a[204:207], v[188:191]
    s_waitcnt lgkmcnt(8)
    v_mfma_f32_16x16x32_bf16 v[128:131], v[40:43], a[208:211], v[128:131]
    ds_read_b64_tr_b16 v[60:61], v229 offset:1024
    v_mfma_f32_16x16x32_bf16 v[132:135], v[40:43], a[212:215], v[132:135]
    ds_read_b64_tr_b16 v[62:63], v229 offset:3072
    v_mfma_f32_16x16x32_bf16 v[136:139], v[40:43], a[216:219], v[136:139]
    buffer_load_dwordx4 v1, s[28:31], s41 offen sc1 lds
    v_mfma_f32_16x16x32_bf16 v[140:143], v[40:43], a[220:223], v[140:143]
    s_waitcnt lgkmcnt(8)
    s_add_u32 s41, s41, 4096
    s_add_u32 m0, s47, 57344
    v_mfma_f32_16x16x32_bf16 v[144:147], v[44:47], a[208:211], v[144:147]
    v_add_u32 v230, 65536, v230
    v_mfma_f32_16x16x32_bf16 v[148:151], v[44:47], a[212:215], v[148:151]
    ds_read_b64_tr_b16 v[40:41], v230 offset:0
    v_mfma_f32_16x16x32_bf16 v[152:155], v[44:47], a[216:219], v[152:155]
    ds_read_b64_tr_b16 v[42:43], v230 offset:2048
    v_mfma_f32_16x16x32_bf16 v[156:159], v[44:47], a[220:223], v[156:159]
    s_waitcnt lgkmcnt(8)
    buffer_load_dwordx4 v1, s[28:31], s41 offen sc1 lds
    v_mfma_f32_16x16x32_bf16 v[160:163], v[48:51], a[208:211], v[160:163]
    ds_read_b64_tr_b16 v[44:45], v230 offset:1024
    v_mfma_f32_16x16x32_bf16 v[164:167], v[48:51], a[212:215], v[164:167]
    ds_read_b64_tr_b16 v[46:47], v230 offset:3072
    v_mfma_f32_16x16x32_bf16 v[168:171], v[48:51], a[216:219], v[168:171]
    buffer_load_dword v250, v249, s[28:31], s67 offen sc1
    v_mfma_f32_16x16x32_bf16 v[172:175], v[48:51], a[220:223], v[172:175]
    s_waitcnt lgkmcnt(8)
    s_add_u32 s41, s41, 4096
    s_add_u32 m0, s47, 61440
    v_mfma_f32_16x16x32_bf16 v[176:179], v[52:55], a[208:211], v[176:179]
    ds_read_b64_tr_b16 v[48:49], v229 offset:4096
    v_mfma_f32_16x16x32_bf16 v[180:183], v[52:55], a[212:215], v[180:183]
    ds_read_b64_tr_b16 v[50:51], v229 offset:6144
    v_mfma_f32_16x16x32_bf16 v[184:187], v[52:55], a[216:219], v[184:187]
    buffer_load_dwordx4 v1, s[28:31], s41 offen sc1 lds
    v_mfma_f32_16x16x32_bf16 v[188:191], v[52:55], a[220:223], v[188:191]
    s_waitcnt lgkmcnt(8)
    s_add_u32 s41, s41, 4096
    s_add_u32 m0, s47, 73728
    v_mfma_f32_16x16x32_bf16 v[128:131], v[56:59], a[224:227], v[128:131]
    ds_read_b64_tr_b16 v[52:53], v229 offset:5120
    v_mfma_f32_16x16x32_bf16 v[132:135], v[56:59], a[228:231], v[132:135]
    ds_read_b64_tr_b16 v[54:55], v229 offset:7168
    v_mfma_f32_16x16x32_bf16 v[136:139], v[56:59], a[232:235], v[136:139]
    buffer_load_dwordx4 v1, s[28:31], s41 offen sc1 lds
    v_mfma_f32_16x16x32_bf16 v[140:143], v[56:59], a[236:239], v[140:143]
    s_waitcnt lgkmcnt(8)
    s_add_u32 s41, s41, 4096
    s_add_u32 m0, s47, 77824
    v_mfma_f32_16x16x32_bf16 v[144:147], v[60:63], a[224:227], v[144:147]
    ds_read_b64_tr_b16 v[56:57], v230 offset:4096
    v_mfma_f32_16x16x32_bf16 v[148:151], v[60:63], a[228:231], v[148:151]
    ds_read_b64_tr_b16 v[58:59], v230 offset:6144
    v_mfma_f32_16x16x32_bf16 v[152:155], v[60:63], a[232:235], v[152:155]
    v_mfma_f32_16x16x32_bf16 v[156:159], v[60:63], a[236:239], v[156:159]
    s_waitcnt lgkmcnt(8)
    v_mfma_f32_16x16x32_bf16 v[160:163], v[40:43], a[224:227], v[160:163]
    ds_read_b64_tr_b16 v[60:61], v230 offset:5120
    v_mfma_f32_16x16x32_bf16 v[164:167], v[40:43], a[228:231], v[164:167]
    ds_read_b64_tr_b16 v[62:63], v230 offset:7168
    v_mfma_f32_16x16x32_bf16 v[168:171], v[40:43], a[232:235], v[168:171]
    buffer_load_dwordx4 v1, s[28:31], s41 offen sc1 lds
    v_mfma_f32_16x16x32_bf16 v[172:175], v[40:43], a[236:239], v[172:175]
    s_waitcnt lgkmcnt(8)
    s_barrier
    v_mfma_f32_16x16x32_bf16 v[176:179], v[44:47], a[224:227], v[176:179]
    ds_read_b128 v[40:43], v239 offset:16384
    s_add_u32 s41, s41, 4096
    v_mfma_f32_16x16x32_bf16 v[180:183], v[44:47], a[228:231], v[180:183]
    s_add_u32 m0, s47, 90112
    v_mfma_f32_16x16x32_bf16 v[184:187], v[44:47], a[232:235], v[184:187]
    buffer_load_dwordx4 v1, s[28:31], s41 offen sc1 lds
    v_mfma_f32_16x16x32_bf16 v[188:191], v[44:47], a[236:239], v[188:191]
    s_waitcnt lgkmcnt(7)
    s_add_u32 s41, s41, 4096
    s_add_u32 m0, s47, 94208
    v_mfma_f32_16x16x32_bf16 v[128:131], v[48:51], a[240:243], v[128:131]
    ds_read_b128 v[44:47], v239 offset:17408
    v_mfma_f32_16x16x32_bf16 v[132:135], v[48:51], a[244:247], v[132:135]
    buffer_load_dwordx4 v1, s[28:31], s41 offen sc1 lds
    v_mfma_f32_16x16x32_bf16 v[136:139], v[48:51], a[248:251], v[136:139]
    s_add_u32 s41, s41, 4096
    s_add_u32 m0, s47, 106496
    v_mfma_f32_16x16x32_bf16 v[140:143], v[48:51], a[252:255], v[140:143]
    s_waitcnt lgkmcnt(6)
    v_mfma_f32_16x16x32_bf16 v[144:147], v[52:55], a[240:243], v[144:147]
    ds_read_b128 v[48:51], v239 offset:18432
    v_mfma_f32_16x16x32_bf16 v[148:151], v[52:55], a[244:247], v[148:151]
    v_mfma_f32_16x16x32_bf16 v[152:155], v[52:55], a[248:251], v[152:155]
    buffer_load_dwordx4 v1, s[28:31], s41 offen sc1 lds
    v_mfma_f32_16x16x32_bf16 v[156:159], v[52:55], a[252:255], v[156:159]
    s_waitcnt lgkmcnt(5)
    s_add_u32 s41, s41, 4096
    s_add_u32 m0, s47, 110592
    v_mfma_f32_16x16x32_bf16 v[160:163], v[56:59], a[240:243], v[160:163]
    ds_read_b128 v[52:55], v239 offset:19456
    v_mfma_f32_16x16x32_bf16 v[164:167], v[56:59], a[244:247], v[164:167]
    v_mfma_f32_16x16x32_bf16 v[168:171], v[56:59], a[248:251], v[168:171]
    v_mfma_f32_16x16x32_bf16 v[172:175], v[56:59], a[252:255], v[172:175]
    s_waitcnt lgkmcnt(4)
    v_mfma_f32_16x16x32_bf16 v[176:179], v[60:63], a[240:243], v[176:179]
    ds_read_b128 v[56:59], v239 offset:28672
    v_mfma_f32_16x16x32_bf16 v[180:183], v[60:63], a[244:247], v[180:183]
    buffer_load_dwordx4 v1, s[28:31], s41 offen sc1 lds
    v_mfma_f32_16x16x32_bf16 v[184:187], v[60:63], a[248:251], v[184:187]
    s_add_u32 s41, s41, 4096
    s_add_u32 m0, s47, 122880
    v_mfma_f32_16x16x32_bf16 v[188:191], v[60:63], a[252:255], v[188:191]
    s_waitcnt lgkmcnt(3)
    v_mfma_f32_16x16x32_bf16 v[64:67], v[40:43], a[0:3], 0
    ds_read_b128 v[60:63], v239 offset:29696
    v_mfma_f32_16x16x32_bf16 v[68:71], v[40:43], a[4:7], 0
    buffer_load_dwordx4 v1, s[28:31], s41 offen sc1 lds
    v_mfma_f32_16x16x32_bf16 v[72:75], v[44:47], a[0:3], 0
    ds_read_b128 v[40:43], v239 offset:30720
    s_add_u32 s41, s41, 4096
    v_mfma_f32_16x16x32_bf16 v[76:79], v[44:47], a[4:7], 0
    s_waitcnt lgkmcnt(3)
    s_add_u32 m0, s47, 126976
    v_mfma_f32_16x16x32_bf16 v[80:83], v[48:51], a[0:3], 0
    ds_read_b128 v[44:47], v239 offset:31744
    v_mfma_f32_16x16x32_bf16 v[84:87], v[48:51], a[4:7], 0
    v_mfma_f32_16x16x32_bf16 v[88:91], v[52:55], a[0:3], 0
    ds_read_b128 v[48:51], v239 offset:20480
    v_mfma_f32_16x16x32_bf16 v[92:95], v[52:55], a[4:7], 0
    s_waitcnt lgkmcnt(3)
    v_mfma_f32_16x16x32_bf16 v[96:99], v[56:59], a[0:3], 0
    ds_read_b128 v[52:55], v239 offset:21504
    v_max_f32 v128, 0, v128
    v_mfma_f32_16x16x32_bf16 v[100:103], v[56:59], a[4:7], 0
    v_max_f32 v129, 0, v129
    v_max_f32 v130, 0, v130
    v_mfma_f32_16x16x32_bf16 v[64:67], v[60:63], a[8:11], v[64:67]
    ds_read_b128 v[56:59], v239 offset:22528
    v_max_f32 v131, 0, v131
    v_mfma_f32_16x16x32_bf16 v[68:71], v[60:63], a[12:15], v[68:71]
    s_waitcnt lgkmcnt(3)
    v_mul_f32 v128, v128, v144
    v_mul_f32 v129, v129, v145
    v_mfma_f32_16x16x32_bf16 v[72:75], v[40:43], a[8:11], v[72:75]
    ds_read_b128 v[60:63], v239 offset:23552
    v_mul_f32 v130, v130, v146
    v_mfma_f32_16x16x32_bf16 v[76:79], v[40:43], a[12:15], v[76:79]
    buffer_load_dwordx4 v1, s[28:31], s41 offen sc1 lds
    v_mfma_f32_16x16x32_bf16 v[80:83], v[44:47], a[8:11], v[80:83]
    ds_read_b128 v[40:43], v239 offset:24576
    v_mul_f32 v131, v131, v147
    v_mfma_f32_16x16x32_bf16 v[84:87], v[44:47], a[12:15], v[84:87]
    s_waitcnt lgkmcnt(3)
    v_max_f32 v160, 0, v160
    v_max_f32 v161, 0, v161
    v_mfma_f32_16x16x32_bf16 v[88:91], v[48:51], a[8:11], v[88:91]
    ds_read_b128 v[44:47], v239 offset:25600
    v_max_f32 v162, 0, v162
    v_mfma_f32_16x16x32_bf16 v[92:95], v[48:51], a[12:15], v[92:95]
    v_max_f32 v163, 0, v163
    v_mul_f32 v160, v160, v176
    v_mfma_f32_16x16x32_bf16 v[96:99], v[52:55], a[8:11], v[96:99]
    ds_read_b128 v[48:51], v239 offset:26624
    v_mul_f32 v161, v161, v177
    v_mfma_f32_16x16x32_bf16 v[100:103], v[52:55], a[12:15], v[100:103]
    s_waitcnt lgkmcnt(3)
    v_mul_f32 v162, v162, v178
    v_mul_f32 v163, v163, v179
    v_mfma_f32_16x16x32_bf16 v[64:67], v[56:59], a[16:19], v[64:67]
    ds_read_b128 v[52:55], v239 offset:27648
    s_add_u32 s19, s42, 3072
    v_mfma_f32_16x16x32_bf16 v[68:71], v[56:59], a[20:23], v[68:71]
    v_cvt_pk_bf16_f32 v144, v128, v129
    v_cvt_pk_bf16_f32 v145, v130, v131
    v_mfma_f32_16x16x32_bf16 v[72:75], v[60:63], a[16:19], v[72:75]
    ds_read_b128 v[56:59], v237 offset:0
    v_cvt_pk_bf16_f32 v146, v160, v161
    v_mfma_f32_16x16x32_bf16 v[76:79], v[60:63], a[20:23], v[76:79]
    s_waitcnt lgkmcnt(3)
    v_cvt_pk_bf16_f32 v147, v162, v163
    v_mfma_f32_16x16x32_bf16 v[80:83], v[40:43], a[16:19], v[80:83]
    ds_read_b128 v[60:63], v237 offset:1024
    v_mfma_f32_16x16x32_bf16 v[84:87], v[40:43], a[20:23], v[84:87]
    buffer_store_dwordx4 v[144:147], v1, s[28:31], s19 offen sc1
    v_mfma_f32_16x16x32_bf16 v[88:91], v[44:47], a[16:19], v[88:91]
    ds_read_b128 v[40:43], v237 offset:2048
    v_max_f32 v132, 0, v132
    v_mfma_f32_16x16x32_bf16 v[92:95], v[44:47], a[20:23], v[92:95]
    s_waitcnt lgkmcnt(3)
    v_max_f32 v133, 0, v133
    v_max_f32 v134, 0, v134
    v_mfma_f32_16x16x32_bf16 v[96:99], v[48:51], a[16:19], v[96:99]
    ds_read_b128 v[44:47], v237 offset:3072
    v_max_f32 v135, 0, v135
    v_mfma_f32_16x16x32_bf16 v[100:103], v[48:51], a[20:23], v[100:103]
    v_mul_f32 v132, v132, v148
    v_mul_f32 v133, v133, v149
    v_mfma_f32_16x16x32_bf16 v[64:67], v[52:55], a[24:27], v[64:67]
    ds_read_b128 v[48:51], v237 offset:4096
    v_mul_f32 v134, v134, v150
    v_mfma_f32_16x16x32_bf16 v[68:71], v[52:55], a[28:31], v[68:71]
    s_waitcnt lgkmcnt(3)
    v_mul_f32 v135, v135, v151
    v_max_f32 v164, 0, v164
    v_mfma_f32_16x16x32_bf16 v[72:75], v[56:59], a[24:27], v[72:75]
    ds_read_b128 v[52:55], v237 offset:5120
    v_max_f32 v165, 0, v165
    v_mfma_f32_16x16x32_bf16 v[76:79], v[56:59], a[28:31], v[76:79]
    v_max_f32 v166, 0, v166
    v_max_f32 v167, 0, v167
    v_mfma_f32_16x16x32_bf16 v[80:83], v[60:63], a[24:27], v[80:83]
    ds_read_b128 v[56:59], v237 offset:6144
    v_mul_f32 v164, v164, v180
    v_mfma_f32_16x16x32_bf16 v[84:87], v[60:63], a[28:31], v[84:87]
    s_waitcnt lgkmcnt(3)
    v_mul_f32 v165, v165, v181
    v_mul_f32 v166, v166, v182
    v_mfma_f32_16x16x32_bf16 v[88:91], v[40:43], a[24:27], v[88:91]
    ds_read_b128 v[60:63], v237 offset:7168
    v_mul_f32 v167, v167, v183
    v_mfma_f32_16x16x32_bf16 v[92:95], v[40:43], a[28:31], v[92:95]
    s_barrier
    s_add_u32 s19, s42, 150528
    v_cvt_pk_bf16_f32 v148, v132, v133
    v_mfma_f32_16x16x32_bf16 v[96:99], v[44:47], a[24:27], v[96:99]
    ds_read_b128 v[40:43], v237 offset:16384
    s_add_u32 s41, s41, 4096
    v_mfma_f32_16x16x32_bf16 v[100:103], v[44:47], a[28:31], v[100:103]
    s_waitcnt vmcnt(42)
    s_waitcnt lgkmcnt(3)
    s_add_u32 m0, s47, 139264
    v_mfma_f32_16x16x32_bf16 v[64:67], v[48:51], a[32:35], v[64:67]
    ds_read_b128 v[44:47], v237 offset:17408
    v_cvt_pk_bf16_f32 v149, v134, v135
    v_mfma_f32_16x16x32_bf16 v[68:71], v[48:51], a[36:39], v[68:71]
    buffer_load_dwordx4 v1, s[28:31], s41 offen sc1 lds
    v_mfma_f32_16x16x32_bf16 v[72:75], v[52:55], a[32:35], v[72:75]
    ds_read_b128 v[48:51], v237 offset:18432
    s_waitcnt vmcnt(11)
    v_mfma_f32_16x16x32_bf16 v[76:79], v[52:55], a[36:39], v[76:79]
    s_waitcnt lgkmcnt(3)
    v_cmp_ne_u32 vcc, s8, v250
    s_nop 0
    s_cbranch_vccnz K4_SLOW3
K4_RET3:
    v_cvt_pk_bf16_f32 v150, v164, v165
    v_mfma_f32_16x16x32_bf16 v[80:83], v[56:59], a[32:35], v[80:83]
    ds_read_b128 v[52:55], v237 offset:19456
    v_cvt_pk_bf16_f32 v151, v166, v167
    v_mfma_f32_16x16x32_bf16 v[84:87], v[56:59], a[36:39], v[84:87]
    buffer_store_dwordx4 v[148:151], v1, s[28:31], s19 offen sc1
    v_mfma_f32_16x16x32_bf16 v[88:91], v[60:63], a[32:35], v[88:91]
    ds_read_b128 v[56:59], v237 offset:20480
    v_max_f32 v136, 0, v136
    v_mfma_f32_16x16x32_bf16 v[92:95], v[60:63], a[36:39], v[92:95]
    s_waitcnt lgkmcnt(3)
    v_max_f32 v137, 0, v137
    v_max_f32 v138, 0, v138
    v_mfma_f32_16x16x32_bf16 v[96:99], v[40:43], a[32:35], v[96:99]
    ds_read_b128 v[60:63], v237 offset:21504
    v_max_f32 v139, 0, v139
    v_mfma_f32_16x16x32_bf16 v[100:103], v[40:43], a[36:39], v[100:103]
    v_mul_f32 v136, v136, v152
    v_mul_f32 v137, v137, v153
    v_mfma_f32_16x16x32_bf16 v[64:67], v[44:47], a[40:43], v[64:67]
    ds_read_b128 v[40:43], v237 offset:22528
    v_mul_f32 v138, v138, v154
    v_mfma_f32_16x16x32_bf16 v[68:71], v[44:47], a[44:47], v[68:71]
    s_waitcnt lgkmcnt(3)
    v_mul_f32 v139, v139, v155
    v_max_f32 v168, 0, v168
    v_mfma_f32_16x16x32_bf16 v[72:75], v[48:51], a[40:43], v[72:75]
    ds_read_b128 v[44:47], v237 offset:23552
    v_max_f32 v169, 0, v169
    v_mfma_f32_16x16x32_bf16 v[76:79], v[48:51], a[44:47], v[76:79]
    buffer_load_dwordx4 v[8:11], v1, s[28:31], s7 offen offset:0 sc1
    v_mfma_f32_16x16x32_bf16 v[80:83], v[52:55], a[40:43], v[80:83]
    ds_read_b128 v[48:51], v237 offset:32768
    v_max_f32 v170, 0, v170
    v_mfma_f32_16x16x32_bf16 v[84:87], v[52:55], a[44:47], v[84:87]
    s_waitcnt lgkmcnt(3)
    v_max_f32 v171, 0, v171
    v_mul_f32 v168, v168, v184
    v_mfma_f32_16x16x32_bf16 v[88:91], v[56:59], a[40:43], v[88:91]
    ds_read_b128 v[52:55], v237 offset:33792
    v_mul_f32 v169, v169, v185
    v_mfma_f32_16x16x32_bf16 v[92:95], v[56:59], a[44:47], v[92:95]
    v_mul_f32 v170, v170, v186
    v_mul_f32 v171, v171, v187
    v_mfma_f32_16x16x32_bf16 v[96:99], v[60:63], a[40:43], v[96:99]
    ds_read_b128 v[56:59], v237 offset:34816
    s_add_u32 s19, s42, 297984
    v_mfma_f32_16x16x32_bf16 v[100:103], v[60:63], a[44:47], v[100:103]
    s_waitcnt lgkmcnt(3)
    v_cvt_pk_bf16_f32 v152, v136, v137
    v_cvt_pk_bf16_f32 v153, v138, v139
    v_mfma_f32_16x16x32_bf16 v[64:67], v[40:43], a[48:51], v[64:67]
    ds_read_b128 v[60:63], v237 offset:35840
    v_cvt_pk_bf16_f32 v154, v168, v169
    v_mfma_f32_16x16x32_bf16 v[68:71], v[40:43], a[52:55], v[68:71]
    v_cvt_pk_bf16_f32 v155, v170, v171
    v_mfma_f32_16x16x32_bf16 v[72:75], v[44:47], a[48:51], v[72:75]
    ds_read_b128 v[40:43], v237 offset:36864
    v_mfma_f32_16x16x32_bf16 v[76:79], v[44:47], a[52:55], v[76:79]
    s_waitcnt lgkmcnt(3)
    v_mfma_f32_16x16x32_bf16 v[80:83], v[48:51], a[48:51], v[80:83]
    ds_read_b128 v[44:47], v237 offset:37888
    v_mfma_f32_16x16x32_bf16 v[84:87], v[48:51], a[52:55], v[84:87]
    buffer_store_dwordx4 v[152:155], v1, s[28:31], s19 offen sc1
    v_mfma_f32_16x16x32_bf16 v[88:91], v[52:55], a[48:51], v[88:91]
    ds_read_b128 v[48:51], v237 offset:38912
    v_max_f32 v140, 0, v140
    v_mfma_f32_16x16x32_bf16 v[92:95], v[52:55], a[52:55], v[92:95]
    s_waitcnt lgkmcnt(3)
    buffer_load_dwordx4 v[12:15], v1, s[28:31], s7 offen offset:1024 sc1
    v_mfma_f32_16x16x32_bf16 v[96:99], v[56:59], a[48:51], v[96:99]
    ds_read_b128 v[52:55], v237 offset:39936
    v_max_f32 v141, 0, v141
    v_mfma_f32_16x16x32_bf16 v[100:103], v[56:59], a[52:55], v[100:103]
    buffer_load_dwordx4 v[16:19], v1, s[28:31], s7 offen offset:2048 sc1
    v_mfma_f32_16x16x32_bf16 v[64:67], v[60:63], a[56:59], v[64:67]
    ds_read_b128 v[56:59], v237 offset:49152
    v_max_f32 v142, 0, v142
    v_mfma_f32_16x16x32_bf16 v[68:71], v[60:63], a[60:63], v[68:71]
    s_waitcnt lgkmcnt(3)
    v_max_f32 v143, 0, v143
    v_mul_f32 v140, v140, v156
    v_mfma_f32_16x16x32_bf16 v[72:75], v[40:43], a[56:59], v[72:75]
    ds_read_b128 v[60:63], v237 offset:50176
    v_mul_f32 v141, v141, v157
    v_mfma_f32_16x16x32_bf16 v[76:79], v[40:43], a[60:63], v[76:79]
    v_mul_f32 v142, v142, v158
    v_mul_f32 v143, v143, v159
    v_mfma_f32_16x16x32_bf16 v[80:83], v[44:47], a[56:59], v[80:83]
    ds_read_b128 v[40:43], v237 offset:51200
    v_max_f32 v172, 0, v172
    v_mfma_f32_16x16x32_bf16 v[84:87], v[44:47], a[60:63], v[84:87]
    s_waitcnt lgkmcnt(3)
    v_max_f32 v173, 0, v173
    v_max_f32 v174, 0, v174
    v_mfma_f32_16x16x32_bf16 v[88:91], v[48:51], a[56:59], v[88:91]
    ds_read_b128 v[44:47], v237 offset:52224
    v_max_f32 v175, 0, v175
    v_mfma_f32_16x16x32_bf16 v[92:95], v[48:51], a[60:63], v[92:95]
    v_mul_f32 v172, v172, v188
    v_mul_f32 v173, v173, v189
    v_mfma_f32_16x16x32_bf16 v[96:99], v[52:55], a[56:59], v[96:99]
    ds_read_b128 v[48:51], v237 offset:53248
    v_mul_f32 v174, v174, v190
    v_mfma_f32_16x16x32_bf16 v[100:103], v[52:55], a[60:63], v[100:103]
    s_waitcnt lgkmcnt(3)
    v_mul_f32 v175, v175, v191
    s_add_u32 s19, s42, 445440
    v_mfma_f32_16x16x32_bf16 v[64:67], v[56:59], a[64:67], v[64:67]
    ds_read_b128 v[52:55], v237 offset:54272
    v_cvt_pk_bf16_f32 v156, v140, v141
    v_mfma_f32_16x16x32_bf16 v[68:71], v[56:59], a[68:71], v[68:71]
    buffer_load_dwordx4 v[20:23], v1, s[28:31], s7 offen offset:3072 sc1
    v_mfma_f32_16x16x32_bf16 v[72:75], v[60:63], a[64:67], v[72:75]
    ds_read_b128 v[56:59], v237 offset:55296
    s_add_u32 s7, s7, 4096
    v_mfma_f32_16x16x32_bf16 v[76:79], v[60:63], a[68:71], v[76:79]
    s_waitcnt lgkmcnt(3)
    v_cvt_pk_bf16_f32 v157, v142, v143
    v_cvt_pk_bf16_f32 v158, v172, v173
    v_mfma_f32_16x16x32_bf16 v[80:83], v[40:43], a[64:67], v[80:83]
    ds_read_b128 v[60:63], v237 offset:56320
    v_cvt_pk_bf16_f32 v159, v174, v175
    v_mfma_f32_16x16x32_bf16 v[84:87], v[40:43], a[68:71], v[84:87]
    s_barrier
    v_mfma_f32_16x16x32_bf16 v[88:91], v[44:47], a[64:67], v[88:91]
    ds_read_b128 v[40:43], v238 offset:0
    v_mfma_f32_16x16x32_bf16 v[92:95], v[44:47], a[68:71], v[92:95]
    s_waitcnt lgkmcnt(3)
    buffer_load_dwordx4 v[24:27], v1, s[28:31], s7 offen offset:0 sc1
    v_mfma_f32_16x16x32_bf16 v[96:99], v[48:51], a[64:67], v[96:99]
    ds_read_b128 v[44:47], v238 offset:1024
    v_mfma_f32_16x16x32_bf16 v[100:103], v[48:51], a[68:71], v[100:103]
    buffer_store_dwordx4 v[156:159], v1, s[28:31], s19 offen sc1
    v_mfma_f32_16x16x32_bf16 v[64:67], v[52:55], a[72:75], v[64:67]
    ds_read_b128 v[48:51], v238 offset:2048
    v_mfma_f32_16x16x32_bf16 v[68:71], v[52:55], a[76:79], v[68:71]
    s_waitcnt lgkmcnt(3)
    buffer_load_dwordx4 v[28:31], v1, s[28:31], s7 offen offset:1024 sc1
    v_mfma_f32_16x16x32_bf16 v[72:75], v[56:59], a[72:75], v[72:75]
    ds_read_b128 v[52:55], v238 offset:3072
    v_mfma_f32_16x16x32_bf16 v[76:79], v[56:59], a[76:79], v[76:79]
    buffer_load_dwordx4 v[32:35], v1, s[28:31], s7 offen offset:2048 sc1
    v_mfma_f32_16x16x32_bf16 v[80:83], v[60:63], a[72:75], v[80:83]
    ds_read_b128 v[56:59], v238 offset:4096
    v_mfma_f32_16x16x32_bf16 v[84:87], v[60:63], a[76:79], v[84:87]
    s_waitcnt lgkmcnt(3)
    v_mfma_f32_16x16x32_bf16 v[88:91], v[40:43], a[72:75], v[88:91]
    ds_read_b128 v[60:63], v238 offset:5120
    v_mfma_f32_16x16x32_bf16 v[92:95], v[40:43], a[76:79], v[92:95]
    buffer_load_dwordx4 v[36:39], v1, s[28:31], s7 offen offset:3072 sc1
    v_mfma_f32_16x16x32_bf16 v[96:99], v[44:47], a[72:75], v[96:99]
    ds_read_b128 v[40:43], v238 offset:6144
    s_add_u32 s49, s48, 2048
    v_mfma_f32_16x16x32_bf16 v[100:103], v[44:47], a[76:79], v[100:103]
    s_waitcnt lgkmcnt(3)
    v_mfma_f32_16x16x32_bf16 v[64:67], v[48:51], a[80:83], v[64:67]
    ds_read_b128 v[44:47], v238 offset:7168
    v_mfma_f32_16x16x32_bf16 v[68:71], v[48:51], a[84:87], v[68:71]
    buffer_load_dwordx4 a[128:131], v1, s[28:31], s49 offen offset:0 sc1
    v_mfma_f32_16x16x32_bf16 v[72:75], v[52:55], a[80:83], v[72:75]
    ds_read_b128 v[48:51], v238 offset:16384
    v_mfma_f32_16x16x32_bf16 v[76:79], v[52:55], a[84:87], v[76:79]
    s_waitcnt lgkmcnt(3)
    v_mfma_f32_16x16x32_bf16 v[80:83], v[56:59], a[80:83], v[80:83]
    ds_read_b128 v[52:55], v238 offset:17408
    v_mfma_f32_16x16x32_bf16 v[84:87], v[56:59], a[84:87], v[84:87]
    buffer_load_dwordx4 a[132:135], v236, s[28:31], s49 offen offset:0 sc1
    v_mfma_f32_16x16x32_bf16 v[88:91], v[60:63], a[80:83], v[88:91]
    ds_read_b128 v[56:59], v238 offset:18432
    s_add_u32 s49, s48, 6144
    v_mfma_f32_16x16x32_bf16 v[92:95], v[60:63], a[84:87], v[92:95]
    s_waitcnt lgkmcnt(3)
    v_mfma_f32_16x16x32_bf16 v[96:99], v[40:43], a[80:83], v[96:99]
    ds_read_b128 v[60:63], v238 offset:19456
    v_mfma_f32_16x16x32_bf16 v[100:103], v[40:43], a[84:87], v[100:103]
    buffer_load_dwordx4 a[136:139], v1, s[28:31], s49 offen offset:0 sc1
    v_mfma_f32_16x16x32_bf16 v[64:67], v[44:47], a[88:91], v[64:67]
    ds_read_b128 v[40:43], v238 offset:20480
    v_mfma_f32_16x16x32_bf16 v[68:71], v[44:47], a[92:95], v[68:71]
    s_waitcnt lgkmcnt(3)
    v_mfma_f32_16x16x32_bf16 v[72:75], v[48:51], a[88:91], v[72:75]
    ds_read_b128 v[44:47], v238 offset:21504
    v_mfma_f32_16x16x32_bf16 v[76:79], v[48:51], a[92:95], v[76:79]
    buffer_load_dwordx4 a[140:143], v236, s[28:31], s49 offen offset:0 sc1
    v_mfma_f32_16x16x32_bf16 v[80:83], v[52:55], a[88:91], v[80:83]
    ds_read_b128 v[48:51], v238 offset:22528
    s_add_u32 s49, s48, 10240
    v_mfma_f32_16x16x32_bf16 v[84:87], v[52:55], a[92:95], v[84:87]
    s_waitcnt lgkmcnt(3)
    v_mfma_f32_16x16x32_bf16 v[88:91], v[56:59], a[88:91], v[88:91]
    ds_read_b128 v[52:55], v238 offset:23552
    v_mfma_f32_16x16x32_bf16 v[92:95], v[56:59], a[92:95], v[92:95]
    buffer_load_dwordx4 a[144:147], v1, s[28:31], s49 offen offset:0 sc1
    v_mfma_f32_16x16x32_bf16 v[96:99], v[60:63], a[88:91], v[96:99]
    ds_read_b128 v[56:59], v238 offset:32768
    v_mfma_f32_16x16x32_bf16 v[100:103], v[60:63], a[92:95], v[100:103]
    s_waitcnt lgkmcnt(3)
    v_mfma_f32_16x16x32_bf16 v[64:67], v[40:43], a[96:99], v[64:67]
    ds_read_b128 v[60:63], v238 offset:33792
    v_mfma_f32_16x16x32_bf16 v[68:71], v[40:43], a[100:103], v[68:71]
    v_mfma_f32_16x16x32_bf16 v[72:75], v[44:47], a[96:99], v[72:75]
    ds_read_b128 v[40:43], v238 offset:34816
    v_mfma_f32_16x16x32_bf16 v[76:79], v[44:47], a[100:103], v[76:79]
    s_waitcnt lgkmcnt(3)
    v_mfma_f32_16x16x32_bf16 v[80:83], v[48:51], a[96:99], v[80:83]
    ds_read_b128 v[44:47], v238 offset:35840
    v_mfma_f32_16x16x32_bf16 v[84:87], v[48:51], a[100:103], v[84:87]
    buffer_load_dwordx4 a[148:151], v236, s[28:31], s49 offen offset:0 sc1
    v_mfma_f32_16x16x32_bf16 v[88:91], v[52:55], a[96:99], v[88:91]
    ds_read_b128 v[48:51], v238 offset:36864
    s_add_u32 s49, s48, 14336
    v_mfma_f32_16x16x32_bf16 v[92:95], v[52:55], a[100:103], v[92:95]
    s_waitcnt lgkmcnt(3)
    v_mfma_f32_16x16x32_bf16 v[96:99], v[56:59], a[96:99], v[96:99]
    ds_read_b128 v[52:55], v238 offset:37888
    v_mfma_f32_16x16x32_bf16 v[100:103], v[56:59], a[100:103], v[100:103]
    buffer_load_dwordx4 a[152:155], v1, s[28:31], s49 offen offset:0 sc1
    v_mfma_f32_16x16x32_bf16 v[64:67], v[60:63], a[104:107], v[64:67]
    ds_read_b128 v[56:59], v238 offset:38912
    v_mfma_f32_16x16x32_bf16 v[68:71], v[60:63], a[108:111], v[68:71]
    s_waitcnt lgkmcnt(3)
    v_mfma_f32_16x16x32_bf16 v[72:75], v[40:43], a[104:107], v[72:75]
    ds_read_b128 v[60:63], v238 offset:39936
    v_mfma_f32_16x16x32_bf16 v[76:79], v[40:43], a[108:111], v[76:79]
    s_barrier
    buffer_load_dwordx4 a[156:159], v236, s[28:31], s49 offen offset:0 sc1
    v_mfma_f32_16x16x32_bf16 v[80:83], v[44:47], a[104:107], v[80:83]
    ds_read_b128 v[40:43], v238 offset:49152
    s_add_u32 s49, s48, 20480
    v_mfma_f32_16x16x32_bf16 v[84:87], v[44:47], a[108:111], v[84:87]
    s_waitcnt lgkmcnt(3)
    v_mfma_f32_16x16x32_bf16 v[88:91], v[48:51], a[104:107], v[88:91]
    ds_read_b128 v[44:47], v238 offset:50176
    v_mfma_f32_16x16x32_bf16 v[92:95], v[48:51], a[108:111], v[92:95]
    buffer_load_dwordx4 a[160:163], v1, s[28:31], s49 offen offset:0 sc1
    v_mfma_f32_16x16x32_bf16 v[96:99], v[52:55], a[104:107], v[96:99]
    ds_read_b128 v[48:51], v238 offset:51200
    v_mfma_f32_16x16x32_bf16 v[100:103], v[52:55], a[108:111], v[100:103]
    s_waitcnt lgkmcnt(3)
    v_mfma_f32_16x16x32_bf16 v[64:67], v[56:59], a[112:115], v[64:67]
    ds_read_b128 v[52:55], v238 offset:52224
    v_mfma_f32_16x16x32_bf16 v[68:71], v[56:59], a[116:119], v[68:71]
    buffer_load_dwordx4 a[164:167], v236, s[28:31], s49 offen offset:0 sc1
    v_mfma_f32_16x16x32_bf16 v[72:75], v[60:63], a[112:115], v[72:75]
    ds_read_b128 v[56:59], v238 offset:53248
    s_add_u32 s49, s48, 24576
    v_mfma_f32_16x16x32_bf16 v[76:79], v[60:63], a[116:119], v[76:79]
    s_waitcnt lgkmcnt(3)
    v_mfma_f32_16x16x32_bf16 v[80:83], v[40:43], a[112:115], v[80:83]
    ds_read_b128 v[60:63], v238 offset:54272
    v_mfma_f32_16x16x32_bf16 v[84:87], v[40:43], a[116:119], v[84:87]
    buffer_load_dwordx4 a[168:171], v1, s[28:31], s49 offen offset:0 sc1
    v_mfma_f32_16x16x32_bf16 v[88:91], v[44:47], a[112:115], v[88:91]
    ds_read_b128 v[40:43], v238 offset:55296
    v_mfma_f32_16x16x32_bf16 v[92:95], v[44:47], a[116:119], v[92:95]
    s_waitcnt lgkmcnt(3)
    v_mfma_f32_16x16x32_bf16 v[96:99], v[48:51], a[112:115], v[96:99]
    ds_read_b128 v[44:47], v238 offset:56320
    v_mfma_f32_16x16x32_bf16 v[100:103], v[48:51], a[116:119], v[100:103]
    buffer_load_dwordx4 a[172:175], v236, s[28:31], s49 offen offset:0 sc1
    v_mfma_f32_16x16x32_bf16 v[64:67], v[52:55], a[120:123], v[64:67]
    ds_read_b128 v[48:51], v239 offset:0
    s_add_u32 s49, s48, 28672
    v_mfma_f32_16x16x32_bf16 v[68:71], v[52:55], a[124:127], v[68:71]
    s_waitcnt lgkmcnt(3)
    v_mfma_f32_16x16x32_bf16 v[72:75], v[56:59], a[120:123], v[72:75]
    ds_read_b128 v[52:55], v239 offset:1024
    v_mfma_f32_16x16x32_bf16 v[76:79], v[56:59], a[124:127], v[76:79]
    v_mfma_f32_16x16x32_bf16 v[80:83], v[60:63], a[120:123], v[80:83]
    ds_read_b128 v[56:59], v239 offset:2048
    v_mfma_f32_16x16x32_bf16 v[84:87], v[60:63], a[124:127], v[84:87]
    s_waitcnt lgkmcnt(3)
    v_mfma_f32_16x16x32_bf16 v[88:91], v[40:43], a[120:123], v[88:91]
    ds_read_b128 v[60:63], v239 offset:3072
    v_mfma_f32_16x16x32_bf16 v[92:95], v[40:43], a[124:127], v[92:95]
    buffer_load_dwordx4 a[176:179], v1, s[28:31], s49 offen offset:0 sc1
    v_mfma_f32_16x16x32_bf16 v[96:99], v[44:47], a[120:123], v[96:99]
    ds_read_b128 v[40:43], v239 offset:4096
    v_mfma_f32_16x16x32_bf16 v[100:103], v[44:47], a[124:127], v[100:103]
    s_waitcnt vmcnt(20)
    v_swap_b32 v10, v12
    v_swap_b32 v11, v13
    s_waitcnt lgkmcnt(3)
    s_nop 0
    v_mfma_f32_16x16x32_bf16 v[64:67], v[48:51], v[8:11], v[64:67]
    ds_read_b128 v[44:47], v239 offset:5120
    v_mfma_f32_16x16x32_bf16 v[68:71], v[48:51], v[12:15], v[68:71]
    buffer_load_dwordx4 a[180:183], v236, s[28:31], s49 offen offset:0 sc1
    v_mfma_f32_16x16x32_bf16 v[72:75], v[52:55], v[8:11], v[72:75]
    ds_read_b128 v[48:51], v239 offset:6144
    s_add_u32 s49, s48, 32768
    v_mfma_f32_16x16x32_bf16 v[76:79], v[52:55], v[12:15], v[76:79]
    s_waitcnt lgkmcnt(3)
    v_mfma_f32_16x16x32_bf16 v[80:83], v[56:59], v[8:11], v[80:83]
    ds_read_b128 v[52:55], v239 offset:7168
    v_mfma_f32_16x16x32_bf16 v[84:87], v[56:59], v[12:15], v[84:87]
    buffer_load_dwordx4 a[184:187], v1, s[28:31], s49 offen offset:0 sc1
    v_mfma_f32_16x16x32_bf16 v[88:91], v[60:63], v[8:11], v[88:91]
    ds_read_b128 v[56:59], v237 offset:8192
    v_mfma_f32_16x16x32_bf16 v[92:95], v[60:63], v[12:15], v[92:95]
    s_waitcnt lgkmcnt(3)
    v_mfma_f32_16x16x32_bf16 v[96:99], v[40:43], v[8:11], v[96:99]
    ds_read_b128 v[60:63], v237 offset:9216
    s_waitcnt vmcnt(18)
    v_mfma_f32_16x16x32_bf16 v[100:103], v[40:43], v[12:15], v[100:103]
    v_swap_b32 v18, v20
    v_swap_b32 v19, v21
    s_nop 1
    v_mfma_f32_16x16x32_bf16 v[64:67], v[44:47], v[16:19], v[64:67]
    ds_read_b128 v[40:43], v237 offset:10240
    v_mfma_f32_16x16x32_bf16 v[68:71], v[44:47], v[20:23], v[68:71]
    s_waitcnt lgkmcnt(3)
    buffer_load_dwordx4 a[188:191], v236, s[28:31], s49 offen offset:0 sc1
    v_mfma_f32_16x16x32_bf16 v[72:75], v[48:51], v[16:19], v[72:75]
    ds_read_b128 v[44:47], v237 offset:11264
    s_add_u32 s41, s41, 4096
    v_mfma_f32_16x16x32_bf16 v[76:79], v[48:51], v[20:23], v[76:79]
    buffer_store_dword v252, v251, s[28:31], s60 offen sc1
    v_mfma_f32_16x16x32_bf16 v[80:83], v[52:55], v[16:19], v[80:83]
    ds_read_b128 v[48:51], v237 offset:12288
    s_add_u32 m0, s47, 143360
    v_mfma_f32_16x16x32_bf16 v[84:87], v[52:55], v[20:23], v[84:87]
    s_waitcnt lgkmcnt(3)
    buffer_load_dwordx4 v1, s[28:31], s41 offen sc1 lds
    v_mfma_f32_16x16x32_bf16 v[88:91], v[56:59], v[16:19], v[88:91]
    ds_read_b128 v[52:55], v237 offset:13312
    s_add_u32 s41, s41, 4096
    v_mfma_f32_16x16x32_bf16 v[92:95], v[56:59], v[20:23], v[92:95]
    s_add_u32 m0, s47, 147456
    s_add_u32 s60, s60, 131072
    v_mfma_f32_16x16x32_bf16 v[96:99], v[60:63], v[16:19], v[96:99]
    ds_read_b128 v[56:59], v237 offset:14336
    v_mfma_f32_16x16x32_bf16 v[100:103], v[60:63], v[20:23], v[100:103]
    s_waitcnt vmcnt(20)
    v_swap_b32 v26, v28
    v_swap_b32 v27, v29
    s_waitcnt lgkmcnt(3)
    buffer_load_dwordx4 v1, s[28:31], s41 offen sc1 lds
    v_mfma_f32_16x16x32_bf16 v[64:67], v[40:43], v[24:27], v[64:67]
    ds_read_b128 v[60:63], v237 offset:15360
    s_add_u32 s41, s41, 4096
    v_mfma_f32_16x16x32_bf16 v[68:71], v[40:43], v[28:31], v[68:71]
    s_barrier
    s_add_u32 m0, s47, 151552
    v_mfma_f32_16x16x32_bf16 v[72:75], v[44:47], v[24:27], v[72:75]
    ds_read_b128 v[40:43], v237 offset:24576
    v_mfma_f32_16x16x32_bf16 v[76:79], v[44:47], v[28:31], v[76:79]
    s_waitcnt lgkmcnt(3)
    buffer_load_dwordx4 v1, s[28:31], s41 offen sc1 lds
    v_mfma_f32_16x16x32_bf16 v[80:83], v[48:51], v[24:27], v[80:83]
    ds_read_b128 v[44:47], v237 offset:25600
    s_add_u32 s41, s41, 4096
    v_mfma_f32_16x16x32_bf16 v[84:87], v[48:51], v[28:31], v[84:87]
    s_add_u32 m0, s47, 155648
    v_mfma_f32_16x16x32_bf16 v[88:91], v[52:55], v[24:27], v[88:91]
    ds_read_b128 v[48:51], v237 offset:26624
    v_mfma_f32_16x16x32_bf16 v[92:95], v[52:55], v[28:31], v[92:95]
    s_waitcnt lgkmcnt(3)
    buffer_load_dwordx4 v1, s[28:31], s41 offen sc1 lds
    v_mfma_f32_16x16x32_bf16 v[96:99], v[56:59], v[24:27], v[96:99]
    ds_read_b128 v[52:55], v237 offset:27648
    s_add_u32 s41, s41, 4096
    v_mfma_f32_16x16x32_bf16 v[100:103], v[56:59], v[28:31], v[100:103]
    s_waitcnt vmcnt(21)
    v_swap_b32 v34, v36
    v_swap_b32 v35, v37
    s_nop 1
    v_mfma_f32_16x16x32_bf16 v[64:67], v[60:63], v[32:35], v[64:67]
    ds_read_b128 v[56:59], v237 offset:28672
    s_add_u32 m0, s47, 159744
    v_mfma_f32_16x16x32_bf16 v[68:71], v[60:63], v[36:39], v[68:71]
    s_waitcnt lgkmcnt(3)
    v_mfma_f32_16x16x32_bf16 v[72:75], v[40:43], v[32:35], v[72:75]
    ds_read_b128 v[60:63], v237 offset:29696
    v_mfma_f32_16x16x32_bf16 v[76:79], v[40:43], v[36:39], v[76:79]
    buffer_load_dwordx4 v1, s[28:31], s41 offen sc1 lds
    v_mfma_f32_16x16x32_bf16 v[80:83], v[44:47], v[32:35], v[80:83]
    ds_read_b128 v[40:43], v237 offset:30720
    s_add_u32 s41, s41, 4096
    v_mfma_f32_16x16x32_bf16 v[84:87], v[44:47], v[36:39], v[84:87]
    s_waitcnt lgkmcnt(3)
    s_add_u32 m0, s47, 0
    v_mfma_f32_16x16x32_bf16 v[88:91], v[48:51], v[32:35], v[88:91]
    ds_read_b128 v[44:47], v237 offset:31744
    v_mfma_f32_16x16x32_bf16 v[92:95], v[48:51], v[36:39], v[92:95]
    buffer_load_dwordx4 v1, s[28:31], s41 offen sc1 lds
    v_mfma_f32_16x16x32_bf16 v[96:99], v[52:55], v[32:35], v[96:99]
    ds_read_b128 v[48:51], v237 offset:40960
    s_add_u32 s41, s41, 4096
    v_mfma_f32_16x16x32_bf16 v[100:103], v[52:55], v[36:39], v[100:103]
    s_waitcnt vmcnt(21)
    s_waitcnt lgkmcnt(3)
    s_add_u32 m0, s47, 4096
    v_mfma_f32_16x16x32_bf16 v[64:67], v[56:59], a[128:131], v[64:67]
    ds_read_b128 v[52:55], v237 offset:41984
    v_mfma_f32_16x16x32_bf16 v[68:71], v[56:59], a[132:135], v[68:71]
    buffer_load_dwordx4 v1, s[28:31], s41 offen sc1 lds
    v_mfma_f32_16x16x32_bf16 v[72:75], v[60:63], a[128:131], v[72:75]
    ds_read_b128 v[56:59], v237 offset:43008
    s_add_u32 s41, s41, 4096
    v_mfma_f32_16x16x32_bf16 v[76:79], v[60:63], a[132:135], v[76:79]
    s_waitcnt lgkmcnt(3)
    s_add_u32 m0, s47, 16384
    v_mfma_f32_16x16x32_bf16 v[80:83], v[40:43], a[128:131], v[80:83]
    ds_read_b128 v[60:63], v237 offset:44032
    v_mfma_f32_16x16x32_bf16 v[84:87], v[40:43], a[132:135], v[84:87]
    buffer_load_dwordx4 v1, s[28:31], s41 offen sc1 lds
    v_mfma_f32_16x16x32_bf16 v[88:91], v[44:47], a[128:131], v[88:91]
    ds_read_b128 v[40:43], v237 offset:45056
    s_add_u32 s41, s41, 4096
    v_mfma_f32_16x16x32_bf16 v[92:95], v[44:47], a[132:135], v[92:95]
    s_waitcnt lgkmcnt(3)
    s_add_u32 m0, s47, 20480
    v_mfma_f32_16x16x32_bf16 v[96:99], v[48:51], a[128:131], v[96:99]
    ds_read_b128 v[44:47], v237 offset:46080
    v_mfma_f32_16x16x32_bf16 v[100:103], v[48:51], a[132:135], v[100:103]
    s_waitcnt vmcnt(21)
    v_mfma_f32_16x16x32_bf16 v[64:67], v[52:55], a[136:139], v[64:67]
    ds_read_b128 v[48:51], v237 offset:47104
    v_mfma_f32_16x16x32_bf16 v[68:71], v[52:55], a[140:143], v[68:71]
    s_waitcnt lgkmcnt(3)
    v_mfma_f32_16x16x32_bf16 v[72:75], v[56:59], a[136:139], v[72:75]
    ds_read_b128 v[52:55], v237 offset:48128
    v_mfma_f32_16x16x32_bf16 v[76:79], v[56:59], a[140:143], v[76:79]
    buffer_load_dwordx4 v1, s[28:31], s41 offen sc1 lds
    v_mfma_f32_16x16x32_bf16 v[80:83], v[60:63], a[136:139], v[80:83]
    ds_read_b128 v[56:59], v237 offset:57344
    s_add_u32 s41, s41, 4096
    v_mfma_f32_16x16x32_bf16 v[84:87], v[60:63], a[140:143], v[84:87]
    s_waitcnt lgkmcnt(3)
    s_add_u32 m0, s47, 32768
    v_mfma_f32_16x16x32_bf16 v[88:91], v[40:43], a[136:139], v[88:91]
    ds_read_b128 v[60:63], v237 offset:58368
    v_mfma_f32_16x16x32_bf16 v[92:95], v[40:43], a[140:143], v[92:95]
    buffer_load_dwordx4 v1, s[28:31], s41 offen sc1 lds
    v_mfma_f32_16x16x32_bf16 v[96:99], v[44:47], a[136:139], v[96:99]
    ds_read_b128 v[40:43], v237 offset:59392
    s_add_u32 s41, s41, 4096
    v_mfma_f32_16x16x32_bf16 v[100:103], v[44:47], a[140:143], v[100:103]
    s_waitcnt vmcnt(21)
    s_waitcnt lgkmcnt(3)
    s_add_u32 m0, s47, 36864
    v_mfma_f32_16x16x32_bf16 v[64:67], v[48:51], a[144:147], v[64:67]
    ds_read_b128 v[44:47], v237 offset:60416
    v_mfma_f32_16x16x32_bf16 v[68:71], v[48:51], a[148:151], v[68:71]
    buffer_load_dwordx4 v1, s[28:31], s41 offen sc1 lds
    v_mfma_f32_16x16x32_bf16 v[72:75], v[52:55], a[144:147], v[72:75]
    ds_read_b128 v[48:51], v237 offset:61440
    s_add_u32 s41, s41, 4096
    v_mfma_f32_16x16x32_bf16 v[76:79], v[52:55], a[148:151], v[76:79]
    s_waitcnt lgkmcnt(3)
    s_add_u32 m0, s47, 49152
    v_mfma_f32_16x16x32_bf16 v[80:83], v[56:59], a[144:147], v[80:83]
    ds_read_b128 v[52:55], v237 offset:62464
    v_mfma_f32_16x16x32_bf16 v[84:87], v[56:59], a[148:151], v[84:87]
    buffer_load_dwordx4 v1, s[28:31], s41 offen sc1 lds
    v_mfma_f32_16x16x32_bf16 v[88:91], v[60:63], a[144:147], v[88:91]
    ds_read_b128 v[56:59], v237 offset:63488
    s_add_u32 s41, s41, 4096
    v_mfma_f32_16x16x32_bf16 v[92:95], v[60:63], a[148:151], v[92:95]
    s_waitcnt lgkmcnt(3)
    s_add_u32 m0, s47, 53248
    v_mfma_f32_16x16x32_bf16 v[96:99], v[40:43], a[144:147], v[96:99]
    ds_read_b128 v[60:63], v237 offset:64512
    v_mfma_f32_16x16x32_bf16 v[100:103], v[40:43], a[148:151], v[100:103]
    s_waitcnt vmcnt(21)
    s_barrier
    v_mfma_f32_16x16x32_bf16 v[64:67], v[44:47], a[152:155], v[64:67]
    ds_read_b128 v[40:43], v238 offset:8192
    v_mfma_f32_16x16x32_bf16 v[68:71], v[44:47], a[156:159], v[68:71]
    s_waitcnt lgkmcnt(3)
    v_mfma_f32_16x16x32_bf16 v[72:75], v[48:51], a[152:155], v[72:75]
    ds_read_b128 v[44:47], v238 offset:9216
    v_mfma_f32_16x16x32_bf16 v[76:79], v[48:51], a[156:159], v[76:79]
    buffer_load_dwordx4 v1, s[28:31], s41 offen sc1 lds
    v_mfma_f32_16x16x32_bf16 v[80:83], v[52:55], a[152:155], v[80:83]
    ds_read_b128 v[48:51], v238 offset:10240
    v_mfma_f32_16x16x32_bf16 v[84:87], v[52:55], a[156:159], v[84:87]
    s_waitcnt lgkmcnt(3)
    v_mfma_f32_16x16x32_bf16 v[88:91], v[56:59], a[152:155], v[88:91]
    ds_read_b128 v[52:55], v238 offset:11264
    v_mfma_f32_16x16x32_bf16 v[92:95], v[56:59], a[156:159], v[92:95]
    buffer_load_dword v250, v249, s[28:31], s68 offen sc1
    v_mfma_f32_16x16x32_bf16 v[96:99], v[60:63], a[152:155], v[96:99]
    ds_read_b128 v[56:59], v238 offset:12288
    s_add_u32 s41, s41, 4096
    v_mfma_f32_16x16x32_bf16 v[100:103], v[60:63], a[156:159], v[100:103]
    s_waitcnt vmcnt(21)
    s_waitcnt lgkmcnt(3)
    s_add_u32 m0, s47, 65536
    v_mfma_f32_16x16x32_bf16 v[64:67], v[40:43], a[160:163], v[64:67]
    ds_read_b128 v[60:63], v238 offset:13312
    v_mfma_f32_16x16x32_bf16 v[68:71], v[40:43], a[164:167], v[68:71]
    buffer_load_dwordx4 v1, s[28:31], s41 offen sc1 lds
    v_mfma_f32_16x16x32_bf16 v[72:75], v[44:47], a[160:163], v[72:75]
    ds_read_b128 v[40:43], v238 offset:14336
    s_add_u32 s41, s41, 4096
    v_mfma_f32_16x16x32_bf16 v[76:79], v[44:47], a[164:167], v[76:79]
    s_waitcnt lgkmcnt(3)
    s_add_u32 m0, s47, 69632
    v_mfma_f32_16x16x32_bf16 v[80:83], v[48:51], a[160:163], v[80:83]
    ds_read_b128 v[44:47], v238 offset:15360
    v_mfma_f32_16x16x32_bf16 v[84:87], v[48:51], a[164:167], v[84:87]
    buffer_load_dwordx4 v1, s[28:31], s41 offen sc1 lds
    v_mfma_f32_16x16x32_bf16 v[88:91], v[52:55], a[160:163], v[88:91]
    ds_read_b128 v[48:51], v238 offset:24576
    s_add_u32 s41, s41, 4096
    v_mfma_f32_16x16x32_bf16 v[92:95], v[52:55], a[164:167], v[92:95]
    s_waitcnt lgkmcnt(3)
    s_add_u32 m0, s47, 81920
    v_mfma_f32_16x16x32_bf16 v[96:99], v[56:59], a[160:163], v[96:99]
    ds_read_b128 v[52:55], v238 offset:25600
    v_mfma_f32_16x16x32_bf16 v[100:103], v[56:59], a[164:167], v[100:103]
    s_waitcnt vmcnt(21)
    v_mfma_f32_16x16x32_bf16 v[64:67], v[60:63], a[168:171], v[64:67]
    ds_read_b128 v[56:59], v238 offset:26624
    v_mfma_f32_16x16x32_bf16 v[68:71], v[60:63], a[172:175], v[68:71]
    s_waitcnt lgkmcnt(3)
    buffer_load_dwordx4 v1, s[28:31], s41 offen sc1 lds
    v_mfma_f32_16x16x32_bf16 v[72:75], v[40:43], a[168:171], v[72:75]
    ds_read_b128 v[60:63], v238 offset:27648
    s_add_u32 s41, s41, 4096
    v_mfma_f32_16x16x32_bf16 v[76:79], v[40:43], a[172:175], v[76:79]
    s_add_u32 m0, s47, 86016
    v_mfma_f32_16x16x32_bf16 v[80:83], v[44:47], a[168:171], v[80:83]
    ds_read_b128 v[40:43], v238 offset:28672
    v_mfma_f32_16x16x32_bf16 v[84:87], v[44:47], a[172:175], v[84:87]
    s_waitcnt lgkmcnt(3)
    v_mfma_f32_16x16x32_bf16 v[88:91], v[48:51], a[168:171], v[88:91]
    ds_read_b128 v[44:47], v238 offset:29696
    v_mfma_f32_16x16x32_bf16 v[92:95], v[48:51], a[172:175], v[92:95]
    buffer_load_dwordx4 v1, s[28:31], s41 offen sc1 lds
    v_mfma_f32_16x16x32_bf16 v[96:99], v[52:55], a[168:171], v[96:99]
    ds_read_b128 v[48:51], v238 offset:30720
    s_add_u32 s41, s41, 4096
    v_mfma_f32_16x16x32_bf16 v[100:103], v[52:55], a[172:175], v[100:103]
    s_waitcnt vmcnt(21)
    s_waitcnt lgkmcnt(3)
    s_add_u32 m0, s47, 98304
    v_mfma_f32_16x16x32_bf16 v[64:67], v[56:59], a[176:179], v[64:67]
    ds_read_b128 v[52:55], v238 offset:31744
    v_mfma_f32_16x16x32_bf16 v[68:71], v[56:59], a[180:183], v[68:71]
    buffer_load_dwordx4 v1, s[28:31], s41 offen sc1 lds
    v_mfma_f32_16x16x32_bf16 v[72:75], v[60:63], a[176:179], v[72:75]
    ds_read_b128 v[56:59], v238 offset:40960
    s_add_u32 s41, s41, 4096
    v_mfma_f32_16x16x32_bf16 v[76:79], v[60:63], a[180:183], v[76:79]
    s_waitcnt lgkmcnt(3)
    s_add_u32 m0, s47, 102400
    v_mfma_f32_16x16x32_bf16 v[80:83], v[40:43], a[176:179], v[80:83]
    ds_read_b128 v[60:63], v238 offset:41984
    v_mfma_f32_16x16x32_bf16 v[84:87], v[40:43], a[180:183], v[84:87]
    buffer_load_dwordx4 v1, s[28:31], s41 offen sc1 lds
    v_mfma_f32_16x16x32_bf16 v[88:91], v[44:47], a[176:179], v[88:91]
    ds_read_b128 v[40:43], v238 offset:43008
    s_add_u32 s41, s41, 4096
    v_mfma_f32_16x16x32_bf16 v[92:95], v[44:47], a[180:183], v[92:95]
    s_waitcnt lgkmcnt(3)
    s_add_u32 m0, s47, 114688
    v_mfma_f32_16x16x32_bf16 v[96:99], v[48:51], a[176:179], v[96:99]
    ds_read_b128 v[44:47], v238 offset:44032
    v_mfma_f32_16x16x32_bf16 v[100:103], v[48:51], a[180:183], v[100:103]
    s_waitcnt vmcnt(21)
    v_mfma_f32_16x16x32_bf16 v[64:67], v[52:55], a[184:187], v[64:67]
    ds_read_b128 v[48:51], v238 offset:45056
    v_mfma_f32_16x16x32_bf16 v[68:71], v[52:55], a[188:191], v[68:71]
    s_waitcnt lgkmcnt(3)
    buffer_load_dwordx4 v1, s[28:31], s41 offen sc1 lds
    v_mfma_f32_16x16x32_bf16 v[72:75], v[56:59], a[184:187], v[72:75]
    ds_read_b128 v[52:55], v238 offset:46080
    s_add_u32 s41, s41, 4096
    v_mfma_f32_16x16x32_bf16 v[76:79], v[56:59], a[188:191], v[76:79]
    s_add_u32 m0, s47, 118784
    v_mfma_f32_16x16x32_bf16 v[80:83], v[60:63], a[184:187], v[80:83]
    ds_read_b128 v[56:59], v238 offset:47104
    v_mfma_f32_16x16x32_bf16 v[84:87], v[60:63], a[188:191], v[84:87]
    s_waitcnt lgkmcnt(3)
    v_mfma_f32_16x16x32_bf16 v[88:91], v[40:43], a[184:187], v[88:91]
    ds_read_b128 v[60:63], v238 offset:48128
    v_mfma_f32_16x16x32_bf16 v[92:95], v[40:43], a[188:191], v[92:95]
    s_waitcnt vmcnt(18)
    s_barrier
    buffer_load_dwordx4 v1, s[28:31], s41 offen sc1 lds
    v_mfma_f32_16x16x32_bf16 v[96:99], v[44:47], a[184:187], v[96:99]
    ds_read_b128 v[40:43], v238 offset:57344
    s_add_u32 s41, s41, 4096
    v_mfma_f32_16x16x32_bf16 v[100:103], v[44:47], a[188:191], v[100:103]
    s_waitcnt lgkmcnt(3)
    s_add_u32 m0, s47, 131072
    v_mfma_f32_16x16x32_bf16 v[104:107], v[48:51], a[0:3], 0
    ds_read_b128 v[44:47], v238 offset:58368
    v_mfma_f32_16x16x32_bf16 v[108:111], v[48:51], a[4:7], 0
    buffer_load_dwordx4 v1, s[28:31], s41 offen sc1 lds
    v_mfma_f32_16x16x32_bf16 v[112:115], v[52:55], a[0:3], 0
    ds_read_b128 v[48:51], v238 offset:59392
    s_add_u32 s41, s41, 4096
    v_mfma_f32_16x16x32_bf16 v[116:119], v[52:55], a[4:7], 0
    s_waitcnt lgkmcnt(3)
    s_add_u32 m0, s47, 135168
    v_mfma_f32_16x16x32_bf16 v[104:107], v[56:59], a[8:11], v[104:107]
    ds_read_b128 v[52:55], v238 offset:60416
    v_mfma_f32_16x16x32_bf16 v[108:111], v[56:59], a[12:15], v[108:111]
    buffer_load_dwordx4 v1, s[28:31], s41 offen sc1 lds
    v_mfma_f32_16x16x32_bf16 v[112:115], v[60:63], a[8:11], v[112:115]
    ds_read_b128 v[56:59], v238 offset:61440
    s_add_u32 s41, s41, 4096
    v_mfma_f32_16x16x32_bf16 v[116:119], v[60:63], a[12:15], v[116:119]
    s_waitcnt lgkmcnt(3)
    s_add_u32 m0, s47, 8192
    v_mfma_f32_16x16x32_bf16 v[104:107], v[40:43], a[16:19], v[104:107]
    ds_read_b128 v[60:63], v238 offset:62464
    v_mfma_f32_16x16x32_bf16 v[108:111], v[40:43], a[20:23], v[108:111]
    buffer_load_dwordx4 v1, s[28:31], s41 offen sc1 lds
    v_mfma_f32_16x16x32_bf16 v[112:115], v[44:47], a[16:19], v[112:115]
    ds_read_b128 v[40:43], v238 offset:63488
    s_add_u32 s41, s41, 4096
    v_mfma_f32_16x16x32_bf16 v[116:119], v[44:47], a[20:23], v[116:119]
    s_waitcnt lgkmcnt(3)
    s_add_u32 m0, s47, 12288
    v_mfma_f32_16x16x32_bf16 v[104:107], v[48:51], a[24:27], v[104:107]
    ds_read_b128 v[44:47], v238 offset:64512
    v_mfma_f32_16x16x32_bf16 v[108:111], v[48:51], a[28:31], v[108:111]
    v_mfma_f32_16x16x32_bf16 v[112:115], v[52:55], a[24:27], v[112:115]
    ds_read_b128 v[48:51], v239 offset:8192
    v_mfma_f32_16x16x32_bf16 v[116:119], v[52:55], a[28:31], v[116:119]
    s_waitcnt lgkmcnt(3)
    v_mfma_f32_16x16x32_bf16 v[104:107], v[56:59], a[32:35], v[104:107]
    ds_read_b128 v[52:55], v239 offset:9216
    v_mfma_f32_16x16x32_bf16 v[108:111], v[56:59], a[36:39], v[108:111]
    buffer_load_dwordx4 v1, s[28:31], s41 offen sc1 lds
    v_mfma_f32_16x16x32_bf16 v[112:115], v[60:63], a[32:35], v[112:115]
    ds_read_b128 v[56:59], v239 offset:10240
    s_waitcnt vmcnt(12)
    v_mfma_f32_16x16x32_bf16 v[116:119], v[60:63], a[36:39], v[116:119]
    s_waitcnt lgkmcnt(3)
    v_cmp_ne_u32 vcc, s8, v250
    s_nop 0
    s_cbranch_vccnz K4_SLOW4
K4_RET4:
    v_mfma_f32_16x16x32_bf16 v[104:107], v[40:43], a[40:43], v[104:107]
    ds_read_b128 v[60:63], v239 offset:11264
    s_add_u32 s49, s48, 3072
    v_mfma_f32_16x16x32_bf16 v[108:111], v[40:43], a[44:47], v[108:111]
    buffer_load_dwordx4 a[192:195], v1, s[28:31], s49 offen offset:0 sc1
    v_mfma_f32_16x16x32_bf16 v[112:115], v[44:47], a[40:43], v[112:115]
    ds_read_b128 v[40:43], v239 offset:12288
    v_mfma_f32_16x16x32_bf16 v[116:119], v[44:47], a[44:47], v[116:119]
    s_waitcnt lgkmcnt(3)
    v_mfma_f32_16x16x32_bf16 v[104:107], v[48:51], a[48:51], v[104:107]
    ds_read_b128 v[44:47], v239 offset:13312
    v_mfma_f32_16x16x32_bf16 v[108:111], v[48:51], a[52:55], v[108:111]
    buffer_load_dwordx4 a[196:199], v236, s[28:31], s49 offen offset:0 sc1
    v_mfma_f32_16x16x32_bf16 v[112:115], v[52:55], a[48:51], v[112:115]
    ds_read_b128 v[48:51], v239 offset:14336
    s_add_u32 s49, s48, 7168
    v_mfma_f32_16x16x32_bf16 v[116:119], v[52:55], a[52:55], v[116:119]
    s_waitcnt lgkmcnt(3)
    v_mfma_f32_16x16x32_bf16 v[104:107], v[56:59], a[56:59], v[104:107]
    ds_read_b128 v[52:55], v239 offset:15360
    v_mfma_f32_16x16x32_bf16 v[108:111], v[56:59], a[60:63], v[108:111]
    buffer_load_dwordx4 a[200:203], v1, s[28:31], s49 offen offset:0 sc1
    v_mfma_f32_16x16x32_bf16 v[112:115], v[60:63], a[56:59], v[112:115]
    ds_read_b128 v[56:59], v239 offset:16384
    v_mfma_f32_16x16x32_bf16 v[116:119], v[60:63], a[60:63], v[116:119]
    s_waitcnt lgkmcnt(3)
    v_mfma_f32_16x16x32_bf16 v[104:107], v[40:43], a[64:67], v[104:107]
    ds_read_b128 v[60:63], v239 offset:17408
    v_mfma_f32_16x16x32_bf16 v[108:111], v[40:43], a[68:71], v[108:111]
    buffer_load_dwordx4 a[204:207], v236, s[28:31], s49 offen offset:0 sc1
    v_mfma_f32_16x16x32_bf16 v[112:115], v[44:47], a[64:67], v[112:115]
    ds_read_b128 v[40:43], v239 offset:18432
    s_add_u32 s49, s48, 11264
    v_mfma_f32_16x16x32_bf16 v[116:119], v[44:47], a[68:71], v[116:119]
    s_waitcnt lgkmcnt(3)
    v_mfma_f32_16x16x32_bf16 v[104:107], v[48:51], a[72:75], v[104:107]
    ds_read_b128 v[44:47], v239 offset:19456
    v_mfma_f32_16x16x32_bf16 v[108:111], v[48:51], a[76:79], v[108:111]
    buffer_load_dwordx4 a[208:211], v1, s[28:31], s49 offen offset:0 sc1
    v_mfma_f32_16x16x32_bf16 v[112:115], v[52:55], a[72:75], v[112:115]
    ds_read_b128 v[48:51], v239 offset:20480
    v_mfma_f32_16x16x32_bf16 v[116:119], v[52:55], a[76:79], v[116:119]
    s_waitcnt lgkmcnt(3)
    v_mfma_f32_16x16x32_bf16 v[104:107], v[56:59], a[80:83], v[104:107]
    ds_read_b128 v[52:55], v239 offset:21504
    v_mfma_f32_16x16x32_bf16 v[108:111], v[56:59], a[84:87], v[108:111]
    buffer_load_dwordx4 a[212:215], v236, s[28:31], s49 offen offset:0 sc1
    v_mfma_f32_16x16x32_bf16 v[112:115], v[60:63], a[80:83], v[112:115]
    ds_read_b128 v[56:59], v239 offset:22528
    s_add_u32 s49, s48, 15360
    v_mfma_f32_16x16x32_bf16 v[116:119], v[60:63], a[84:87], v[116:119]
    s_waitcnt lgkmcnt(3)
    v_mfma_f32_16x16x32_bf16 v[104:107], v[40:43], a[88:91], v[104:107]
    ds_read_b128 v[60:63], v239 offset:23552
    v_mfma_f32_16x16x32_bf16 v[108:111], v[40:43], a[92:95], v[108:111]
    s_barrier
    buffer_load_dwordx4 a[216:219], v1, s[28:31], s49 offen offset:0 sc1
    v_mfma_f32_16x16x32_bf16 v[112:115], v[44:47], a[88:91], v[112:115]
    ds_read_b128 v[40:43], v239 offset:24576
    v_mfma_f32_16x16x32_bf16 v[116:119], v[44:47], a[92:95], v[116:119]
    s_waitcnt lgkmcnt(3)
    v_mfma_f32_16x16x32_bf16 v[104:107], v[48:51], a[96:99], v[104:107]
    ds_read_b128 v[44:47], v239 offset:25600
    v_mfma_f32_16x16x32_bf16 v[108:111], v[48:51], a[100:103], v[108:111]
    buffer_load_dwordx4 a[220:223], v236, s[28:31], s49 offen offset:0 sc1
    v_mfma_f32_16x16x32_bf16 v[112:115], v[52:55], a[96:99], v[112:115]
    ds_read_b128 v[48:51], v239 offset:26624
    s_add_u32 s49, s48, 21504
    v_mfma_f32_16x16x32_bf16 v[116:119], v[52:55], a[100:103], v[116:119]
    s_waitcnt lgkmcnt(3)
    v_mfma_f32_16x16x32_bf16 v[104:107], v[56:59], a[104:107], v[104:107]
    ds_read_b128 v[52:55], v239 offset:27648
    v_mfma_f32_16x16x32_bf16 v[108:111], v[56:59], a[108:111], v[108:111]
    buffer_load_dwordx4 a[224:227], v1, s[28:31], s49 offen offset:0 sc1
    v_mfma_f32_16x16x32_bf16 v[112:115], v[60:63], a[104:107], v[112:115]
    ds_read_b128 v[56:59], v239 offset:28672
    v_mfma_f32_16x16x32_bf16 v[116:119], v[60:63], a[108:111], v[116:119]
    s_waitcnt lgkmcnt(3)
    v_mfma_f32_16x16x32_bf16 v[104:107], v[40:43], a[112:115], v[104:107]
    ds_read_b128 v[60:63], v239 offset:29696
    v_mfma_f32_16x16x32_bf16 v[108:111], v[40:43], a[116:119], v[108:111]
    buffer_load_dwordx4 a[228:231], v236, s[28:31], s49 offen offset:0 sc1
    v_mfma_f32_16x16x32_bf16 v[112:115], v[44:47], a[112:115], v[112:115]
    ds_read_b128 v[40:43], v239 offset:30720
    s_add_u32 s49, s48, 25600
    v_mfma_f32_16x16x32_bf16 v[116:119], v[44:47], a[116:119], v[116:119]
    s_waitcnt lgkmcnt(3)
    v_mfma_f32_16x16x32_bf16 v[104:107], v[48:51], a[120:123], v[104:107]
    ds_read_b128 v[44:47], v239 offset:31744
    v_mfma_f32_16x16x32_bf16 v[108:111], v[48:51], a[124:127], v[108:111]
    buffer_load_dwordx4 a[232:235], v1, s[28:31], s49 offen offset:0 sc1
    v_mfma_f32_16x16x32_bf16 v[112:115], v[52:55], a[120:123], v[112:115]
    ds_read_b128 v[48:51], v237 offset:0
    v_mfma_f32_16x16x32_bf16 v[116:119], v[52:55], a[124:127], v[116:119]
    s_waitcnt lgkmcnt(3)
    v_mfma_f32_16x16x32_bf16 v[104:107], v[56:59], v[8:11], v[104:107]
    ds_read_b128 v[52:55], v237 offset:1024
    v_mfma_f32_16x16x32_bf16 v[108:111], v[56:59], v[12:15], v[108:111]
    buffer_load_dwordx4 a[236:239], v236, s[28:31], s49 offen offset:0 sc1
    v_mfma_f32_16x16x32_bf16 v[112:115], v[60:63], v[8:11], v[112:115]
    ds_read_b128 v[56:59], v237 offset:2048
    s_add_u32 s49, s48, 29696
    v_mfma_f32_16x16x32_bf16 v[116:119], v[60:63], v[12:15], v[116:119]
    s_waitcnt lgkmcnt(3)
    v_mfma_f32_16x16x32_bf16 v[104:107], v[40:43], v[16:19], v[104:107]
    ds_read_b128 v[60:63], v237 offset:3072
    v_mfma_f32_16x16x32_bf16 v[108:111], v[40:43], v[20:23], v[108:111]
    buffer_load_dwordx4 a[240:243], v1, s[28:31], s49 offen offset:0 sc1
    v_mfma_f32_16x16x32_bf16 v[112:115], v[44:47], v[16:19], v[112:115]
    ds_read_b128 v[40:43], v237 offset:4096
    v_mfma_f32_16x16x32_bf16 v[116:119], v[44:47], v[20:23], v[116:119]
    s_waitcnt lgkmcnt(3)
    v_mfma_f32_16x16x32_bf16 v[104:107], v[48:51], v[24:27], v[104:107]
    ds_read_b128 v[44:47], v237 offset:5120
    v_mfma_f32_16x16x32_bf16 v[108:111], v[48:51], v[28:31], v[108:111]
    buffer_load_dwordx4 a[244:247], v236, s[28:31], s49 offen offset:0 sc1
    v_mfma_f32_16x16x32_bf16 v[112:115], v[52:55], v[24:27], v[112:115]
    ds_read_b128 v[48:51], v237 offset:6144
    s_add_u32 s49, s48, 33792
    v_mfma_f32_16x16x32_bf16 v[116:119], v[52:55], v[28:31], v[116:119]
    s_waitcnt lgkmcnt(3)
    v_mfma_f32_16x16x32_bf16 v[104:107], v[56:59], v[32:35], v[104:107]
    ds_read_b128 v[52:55], v237 offset:7168
    v_mfma_f32_16x16x32_bf16 v[108:111], v[56:59], v[36:39], v[108:111]
    buffer_load_dwordx4 a[248:251], v1, s[28:31], s49 offen offset:0 sc1
    v_mfma_f32_16x16x32_bf16 v[112:115], v[60:63], v[32:35], v[112:115]
    ds_read_b128 v[56:59], v237 offset:16384
    v_mfma_f32_16x16x32_bf16 v[116:119], v[60:63], v[36:39], v[116:119]
    s_waitcnt vmcnt(13)
    s_waitcnt lgkmcnt(3)
    v_mfma_f32_16x16x32_bf16 v[64:67], v[40:43], a[192:195], v[64:67]
    ds_read_b128 v[60:63], v237 offset:17408
    v_mfma_f32_16x16x32_bf16 v[68:71], v[40:43], a[196:199], v[68:71]
    buffer_load_dwordx4 a[252:255], v236, s[28:31], s49 offen offset:0 sc1
    v_mfma_f32_16x16x32_bf16 v[72:75], v[44:47], a[192:195], v[72:75]
    ds_read_b128 v[40:43], v237 offset:18432
    v_mfma_f32_16x16x32_bf16 v[76:79], v[44:47], a[196:199], v[76:79]
    s_waitcnt lgkmcnt(3)
    v_mfma_f32_16x16x32_bf16 v[80:83], v[48:51], a[192:195], v[80:83]
    ds_read_b128 v[44:47], v237 offset:19456
    v_mfma_f32_16x16x32_bf16 v[84:87], v[48:51], a[196:199], v[84:87]
    buffer_load_dword v250, v245, s[28:31], 0 offen sc1
    v_mfma_f32_16x16x32_bf16 v[88:91], v[52:55], a[192:195], v[88:91]
    ds_read_b128 v[48:51], v237 offset:20480
    s_add_u32 s41, s41, 4096
    v_mfma_f32_16x16x32_bf16 v[92:95], v[52:55], a[196:199], v[92:95]
    s_waitcnt lgkmcnt(3)
    s_add_u32 m0, s47, 24576
    v_mfma_f32_16x16x32_bf16 v[96:99], v[56:59], a[192:195], v[96:99]
    ds_read_b128 v[52:55], v237 offset:21504
    v_mfma_f32_16x16x32_bf16 v[100:103], v[56:59], a[196:199], v[100:103]
    s_waitcnt vmcnt(13)
    buffer_load_dwordx4 v1, s[28:31], s41 offen sc1 lds
    v_mfma_f32_16x16x32_bf16 v[64:67], v[60:63], a[200:203], v[64:67]
    ds_read_b128 v[56:59], v237 offset:22528
    s_add_u32 s41, s41, 4096
    v_mfma_f32_16x16x32_bf16 v[68:71], v[60:63], a[204:207], v[68:71]
    s_waitcnt lgkmcnt(3)
    s_add_u32 m0, s47, 28672
    v_mfma_f32_16x16x32_bf16 v[72:75], v[40:43], a[200:203], v[72:75]
    ds_read_b128 v[60:63], v237 offset:23552
    v_mfma_f32_16x16x32_bf16 v[76:79], v[40:43], a[204:207], v[76:79]
    s_barrier
    v_mfma_f32_16x16x32_bf16 v[80:83], v[44:47], a[200:203], v[80:83]
    ds_read_b128 v[40:43], v237 offset:32768
    v_mfma_f32_16x16x32_bf16 v[84:87], v[44:47], a[204:207], v[84:87]
    s_waitcnt lgkmcnt(3)
    buffer_load_dwordx4 v1, s[28:31], s41 offen sc1 lds
    v_mfma_f32_16x16x32_bf16 v[88:91], v[48:51], a[200:203], v[88:91]
    ds_read_b128 v[44:47], v237 offset:33792
    s_add_u32 s41, s41, 4096
    v_mfma_f32_16x16x32_bf16 v[92:95], v[48:51], a[204:207], v[92:95]
    s_add_u32 m0, s47, 40960
    v_mfma_f32_16x16x32_bf16 v[96:99], v[52:55], a[200:203], v[96:99]
    ds_read_b128 v[48:51], v237 offset:34816
    v_mfma_f32_16x16x32_bf16 v[100:103], v[52:55], a[204:207], v[100:103]
    s_waitcnt vmcnt(13)
    s_waitcnt lgkmcnt(3)
    buffer_load_dwordx4 v1, s[28:31], s41 offen sc1 lds
    v_mfma_f32_16x16x32_bf16 v[64:67], v[56:59], a[208:211], v[64:67]
    ds_read_b128 v[52:55], v237 offset:35840
    s_add_u32 s41, s41, 4096
    v_mfma_f32_16x16x32_bf16 v[68:71], v[56:59], a[212:215], v[68:71]
    s_add_u32 m0, s47, 45056
    v_mfma_f32_16x16x32_bf16 v[72:75], v[60:63], a[208:211], v[72:75]
    ds_read_b128 v[56:59], v237 offset:36864
    v_mfma_f32_16x16x32_bf16 v[76:79], v[60:63], a[212:215], v[76:79]
    s_waitcnt lgkmcnt(3)
    buffer_load_dwordx4 v1, s[28:31], s41 offen sc1 lds
    v_mfma_f32_16x16x32_bf16 v[80:83], v[40:43], a[208:211], v[80:83]
    ds_read_b128 v[60:63], v237 offset:37888
    s_add_u32 s41, s41, 4096
    v_mfma_f32_16x16x32_bf16 v[84:87], v[40:43], a[212:215], v[84:87]
    s_add_u32 m0, s47, 57344
    v_mfma_f32_16x16x32_bf16 v[88:91], v[44:47], a[208:211], v[88:91]
    ds_read_b128 v[40:43], v237 offset:38912
    v_mfma_f32_16x16x32_bf16 v[92:95], v[44:47], a[212:215], v[92:95]
    s_waitcnt lgkmcnt(3)
    v_mfma_f32_16x16x32_bf16 v[96:99], v[48:51], a[208:211], v[96:99]
    ds_read_b128 v[44:47], v237 offset:39936
    v_mfma_f32_16x16x32_bf16 v[100:103], v[48:51], a[212:215], v[100:103]
    s_waitcnt vmcnt(13)
    buffer_load_dwordx4 v1, s[28:31], s41 offen sc1 lds
    v_mfma_f32_16x16x32_bf16 v[64:67], v[52:55], a[216:219], v[64:67]
    ds_read_b128 v[48:51], v237 offset:49152
    s_add_u32 s41, s41, 4096
    v_mfma_f32_16x16x32_bf16 v[68:71], v[52:55], a[220:223], v[68:71]
    s_waitcnt lgkmcnt(3)
    s_add_u32 m0, s47, 61440
    v_mfma_f32_16x16x32_bf16 v[72:75], v[56:59], a[216:219], v[72:75]
    ds_read_b128 v[52:55], v237 offset:50176
    v_mfma_f32_16x16x32_bf16 v[76:79], v[56:59], a[220:223], v[76:79]
    buffer_load_dwordx4 v1, s[28:31], s41 offen sc1 lds
    v_mfma_f32_16x16x32_bf16 v[80:83], v[60:63], a[216:219], v[80:83]
    ds_read_b128 v[56:59], v237 offset:51200
    s_add_u32 s41, s41, 4096
    v_mfma_f32_16x16x32_bf16 v[84:87], v[60:63], a[220:223], v[84:87]
    s_waitcnt lgkmcnt(3)
    s_add_u32 m0, s47, 73728
    v_mfma_f32_16x16x32_bf16 v[88:91], v[40:43], a[216:219], v[88:91]
    ds_read_b128 v[60:63], v237 offset:52224
    v_mfma_f32_16x16x32_bf16 v[92:95], v[40:43], a[220:223], v[92:95]
    buffer_load_dwordx4 v1, s[28:31], s41 offen sc1 lds
    v_mfma_f32_16x16x32_bf16 v[96:99], v[44:47], a[216:219], v[96:99]
    ds_read_b128 v[40:43], v237 offset:53248
    s_add_u32 s41, s41, 4096
    v_mfma_f32_16x16x32_bf16 v[100:103], v[44:47], a[220:223], v[100:103]
    s_waitcnt vmcnt(14)
    s_waitcnt lgkmcnt(3)
    s_add_u32 m0, s47, 77824
    v_mfma_f32_16x16x32_bf16 v[64:67], v[48:51], a[224:227], v[64:67]
    ds_read_b128 v[44:47], v237 offset:54272
    v_mfma_f32_16x16x32_bf16 v[68:71], v[48:51], a[228:231], v[68:71]
    buffer_load_dwordx4 v1, s[28:31], s41 offen sc1 lds
    v_mfma_f32_16x16x32_bf16 v[72:75], v[52:55], a[224:227], v[72:75]
    ds_read_b128 v[48:51], v237 offset:55296
    s_add_u32 s41, s41, 4096
    v_mfma_f32_16x16x32_bf16 v[76:79], v[52:55], a[228:231], v[76:79]
    s_waitcnt lgkmcnt(3)
    s_add_u32 m0, s47, 90112
    v_mfma_f32_16x16x32_bf16 v[80:83], v[56:59], a[224:227], v[80:83]
    ds_read_b128 v[52:55], v237 offset:56320
    v_mfma_f32_16x16x32_bf16 v[84:87], v[56:59], a[228:231], v[84:87]
    v_mfma_f32_16x16x32_bf16 v[88:91], v[60:63], a[224:227], v[88:91]
    ds_read_b128 v[56:59], v238 offset:0
    v_mfma_f32_16x16x32_bf16 v[92:95], v[60:63], a[228:231], v[92:95]
    s_waitcnt lgkmcnt(3)
    v_mfma_f32_16x16x32_bf16 v[96:99], v[40:43], a[224:227], v[96:99]
    ds_read_b128 v[60:63], v238 offset:1024
    v_mfma_f32_16x16x32_bf16 v[100:103], v[40:43], a[228:231], v[100:103]
    s_waitcnt vmcnt(13)
    buffer_load_dwordx4 v1, s[28:31], s41 offen sc1 lds
    v_mfma_f32_16x16x32_bf16 v[64:67], v[44:47], a[232:235], v[64:67]
    ds_read_b128 v[40:43], v238 offset:2048
    s_waitcnt vmcnt(9)
    v_mfma_f32_16x16x32_bf16 v[68:71], v[44:47], a[236:239], v[68:71]
    s_waitcnt lgkmcnt(3)
    v_cmp_ne_u32 vcc, s8, v250
    s_nop 0
    s_cbranch_vccnz K4_SLOW5
K4_RET5:
    v_mfma_f32_16x16x32_bf16 v[72:75], v[48:51], a[232:235], v[72:75]
    ds_read_b128 v[44:47], v238 offset:3072
    v_mfma_f32_16x16x32_bf16 v[76:79], v[48:51], a[236:239], v[76:79]
    buffer_load_dwordx2 v[200:201], v240, s[28:31], s51 offen offset:0 sc1
    v_mfma_f32_16x16x32_bf16 v[80:83], v[52:55], a[232:235], v[80:83]
    ds_read_b128 v[48:51], v238 offset:4096
    v_mfma_f32_16x16x32_bf16 v[84:87], v[52:55], a[236:239], v[84:87]
    s_waitcnt lgkmcnt(3)
    v_mfma_f32_16x16x32_bf16 v[88:91], v[56:59], a[232:235], v[88:91]
    ds_read_b128 v[52:55], v238 offset:5120
    v_mfma_f32_16x16x32_bf16 v[92:95], v[56:59], a[236:239], v[92:95]
    buffer_load_dwordx2 v[202:203], v240, s[28:31], s51 offen offset:256 sc1
    v_mfma_f32_16x16x32_bf16 v[96:99], v[60:63], a[232:235], v[96:99]
    ds_read_b128 v[56:59], v238 offset:6144
    v_mfma_f32_16x16x32_bf16 v[100:103], v[60:63], a[236:239], v[100:103]
    s_waitcnt lgkmcnt(3)
    v_mfma_f32_16x16x32_bf16 v[64:67], v[40:43], a[240:243], v[64:67]
    ds_read_b128 v[60:63], v238 offset:7168
    v_mfma_f32_16x16x32_bf16 v[68:71], v[40:43], a[244:247], v[68:71]
    s_barrier
    buffer_load_dwordx2 v[208:209], v1, s[28:31], s52 offen sc1
    v_mfma_f32_16x16x32_bf16 v[72:75], v[44:47], a[240:243], v[72:75]
    ds_read_b128 v[40:43], v238 offset:16384
    s_add_u32 s51, s51, 18432
    v_mfma_f32_16x16x32_bf16 v[76:79], v[44:47], a[244:247], v[76:79]
    s_waitcnt lgkmcnt(3)
    s_add_u32 s52, s52, 18432
    v_mfma_f32_16x16x32_bf16 v[80:83], v[48:51], a[240:243], v[80:83]
    ds_read_b128 v[44:47], v238 offset:17408
    v_mfma_f32_16x16x32_bf16 v[84:87], v[48:51], a[244:247], v[84:87]
    buffer_load_dwordx2 v[204:205], v240, s[28:31], s51 offen offset:0 sc1
    v_mfma_f32_16x16x32_bf16 v[88:91], v[52:55], a[240:243], v[88:91]
    ds_read_b128 v[48:51], v238 offset:18432
    v_mfma_f32_16x16x32_bf16 v[92:95], v[52:55], a[244:247], v[92:95]
    s_waitcnt lgkmcnt(3)
    v_mfma_f32_16x16x32_bf16 v[96:99], v[56:59], a[240:243], v[96:99]
    ds_read_b128 v[52:55], v238 offset:19456
    v_mfma_f32_16x16x32_bf16 v[100:103], v[56:59], a[244:247], v[100:103]
    buffer_load_dwordx2 v[206:207], v240, s[28:31], s51 offen offset:256 sc1
    v_mfma_f32_16x16x32_bf16 v[64:67], v[60:63], a[248:251], v[64:67]
    ds_read_b128 v[56:59], v238 offset:20480
    v_mfma_f32_16x16x32_bf16 v[68:71], v[60:63], a[252:255], v[68:71]
    s_waitcnt lgkmcnt(3)
    v_mfma_f32_16x16x32_bf16 v[72:75], v[40:43], a[248:251], v[72:75]
    ds_read_b128 v[60:63], v238 offset:21504
    v_mfma_f32_16x16x32_bf16 v[76:79], v[40:43], a[252:255], v[76:79]
    buffer_load_dwordx2 v[210:211], v1, s[28:31], s52 offen sc1
    v_mfma_f32_16x16x32_bf16 v[80:83], v[44:47], a[248:251], v[80:83]
    ds_read_b128 v[40:43], v238 offset:22528
    v_mfma_f32_16x16x32_bf16 v[84:87], v[44:47], a[252:255], v[84:87]
    s_waitcnt lgkmcnt(3)
    v_mfma_f32_16x16x32_bf16 v[88:91], v[48:51], a[248:251], v[88:91]
    ds_read_b128 v[44:47], v238 offset:23552
    v_mfma_f32_16x16x32_bf16 v[92:95], v[48:51], a[252:255], v[92:95]
    buffer_load_dwordx4 v[164:167], v241, s[28:31], 0 offen sc1
    v_mfma_f32_16x16x32_bf16 v[96:99], v[52:55], a[248:251], v[96:99]
    ds_read_b128 v[48:51], v238 offset:32768
    v_mfma_f32_16x16x32_bf16 v[100:103], v[52:55], a[252:255], v[100:103]
    s_waitcnt lgkmcnt(3)
    v_mfma_f32_16x16x32_bf16 v[104:107], v[56:59], a[128:131], v[104:107]
    ds_read_b128 v[52:55], v238 offset:33792
    v_mfma_f32_16x16x32_bf16 v[108:111], v[56:59], a[132:135], v[108:111]
    buffer_load_dwordx4 v[168:171], v241, s[28:31], 0 offen offset:16 sc1
    v_mfma_f32_16x16x32_bf16 v[112:115], v[60:63], a[128:131], v[112:115]
    ds_read_b128 v[56:59], v238 offset:34816
    v_mfma_f32_16x16x32_bf16 v[116:119], v[60:63], a[132:135], v[116:119]
    s_waitcnt lgkmcnt(3)
    v_mfma_f32_16x16x32_bf16 v[104:107], v[40:43], a[136:139], v[104:107]
    ds_read_b128 v[60:63], v238 offset:35840
    v_mfma_f32_16x16x32_bf16 v[108:111], v[40:43], a[140:143], v[108:111]
    buffer_load_dwordx4 v[172:175], v242, s[28:31], 0 offen sc1
    v_mfma_f32_16x16x32_bf16 v[112:115], v[44:47], a[136:139], v[112:115]
    ds_read_b128 v[40:43], v238 offset:36864
    s_add_u32 s41, s41, 4096
    v_mfma_f32_16x16x32_bf16 v[116:119], v[44:47], a[140:143], v[116:119]
    s_waitcnt lgkmcnt(3)
    s_add_u32 m0, s47, 94208
    v_cvt_pk_bf16_f32 v64, v64, v65
    v_mfma_f32_16x16x32_bf16 v[104:107], v[48:51], a[144:147], v[104:107]
    ds_read_b128 v[44:47], v238 offset:37888
    v_cvt_pk_bf16_f32 v65, v66, v67
    v_mfma_f32_16x16x32_bf16 v[108:111], v[48:51], a[148:151], v[108:111]
    buffer_load_dwordx4 v1, s[28:31], s41 offen sc1 lds
    v_mfma_f32_16x16x32_bf16 v[112:115], v[52:55], a[144:147], v[112:115]
    ds_read_b128 v[48:51], v238 offset:38912
    s_add_u32 s41, s41, 4096
    v_mfma_f32_16x16x32_bf16 v[116:119], v[52:55], a[148:151], v[116:119]
    s_waitcnt lgkmcnt(3)
    s_add_u32 m0, s47, 106496
    v_cvt_pk_bf16_f32 v66, v72, v73
    v_mfma_f32_16x16x32_bf16 v[104:107], v[56:59], a[152:155], v[104:107]
    ds_read_b128 v[52:55], v238 offset:39936
    v_cvt_pk_bf16_f32 v67, v74, v75
    v_mfma_f32_16x16x32_bf16 v[108:111], v[56:59], a[156:159], v[108:111]
    buffer_store_dwordx4 v[64:67], v1, s[28:31], s53 offen offset:0 sc1
    v_mfma_f32_16x16x32_bf16 v[112:115], v[60:63], a[152:155], v[112:115]
    ds_read_b128 v[56:59], v238 offset:49152
    v_cvt_pk_bf16_f32 v68, v68, v69
    v_mfma_f32_16x16x32_bf16 v[116:119], v[60:63], a[156:159], v[116:119]
    s_waitcnt lgkmcnt(3)
    buffer_load_dwordx4 v1, s[28:31], s41 offen sc1 lds
    v_mfma_f32_16x16x32_bf16 v[104:107], v[40:43], a[160:163], v[104:107]
    ds_read_b128 v[60:63], v238 offset:50176
    s_add_u32 s41, s41, 4096
    v_mfma_f32_16x16x32_bf16 v[108:111], v[40:43], a[164:167], v[108:111]
    s_add_u32 m0, s47, 110592
    v_cvt_pk_bf16_f32 v69, v70, v71
    v_cvt_pk_bf16_f32 v70, v76, v77
    v_mfma_f32_16x16x32_bf16 v[112:115], v[44:47], a[160:163], v[112:115]
    ds_read_b128 v[40:43], v238 offset:51200
    v_cvt_pk_bf16_f32 v71, v78, v79
    v_mfma_f32_16x16x32_bf16 v[116:119], v[44:47], a[164:167], v[116:119]
    s_waitcnt lgkmcnt(3)
    buffer_load_dwordx4 v1, s[28:31], s41 offen sc1 lds
    v_mfma_f32_16x16x32_bf16 v[104:107], v[48:51], a[168:171], v[104:107]
    ds_read_b128 v[44:47], v238 offset:52224
    s_add_u32 s41, s41, 4096
    v_mfma_f32_16x16x32_bf16 v[108:111], v[48:51], a[172:175], v[108:111]
    buffer_store_dwordx4 v[68:71], v1, s[28:31], s53 offen offset:1024 sc1
    v_mfma_f32_16x16x32_bf16 v[112:115], v[52:55], a[168:171], v[112:115]
    ds_read_b128 v[48:51], v238 offset:53248
    s_add_u32 m0, s47, 122880
    v_mfma_f32_16x16x32_bf16 v[116:119], v[52:55], a[172:175], v[116:119]
    s_waitcnt lgkmcnt(3)
    v_cvt_pk_bf16_f32 v80, v80, v81
    v_cvt_pk_bf16_f32 v81, v82, v83
    v_mfma_f32_16x16x32_bf16 v[104:107], v[56:59], a[176:179], v[104:107]
    ds_read_b128 v[52:55], v238 offset:54272
    v_cvt_pk_bf16_f32 v82, v88, v89
    v_mfma_f32_16x16x32_bf16 v[108:111], v[56:59], a[180:183], v[108:111]
    buffer_load_dwordx4 v1, s[28:31], s41 offen sc1 lds
    v_mfma_f32_16x16x32_bf16 v[112:115], v[60:63], a[176:179], v[112:115]
    ds_read_b128 v[56:59], v238 offset:55296
    s_add_u32 s41, s41, 4096
    v_mfma_f32_16x16x32_bf16 v[116:119], v[60:63], a[180:183], v[116:119]
    s_waitcnt lgkmcnt(3)
    s_add_u32 m0, s47, 126976
    v_cvt_pk_bf16_f32 v83, v90, v91
    v_mfma_f32_16x16x32_bf16 v[104:107], v[40:43], a[184:187], v[104:107]
    ds_read_b128 v[60:63], v238 offset:56320
    v_mfma_f32_16x16x32_bf16 v[108:111], v[40:43], a[188:191], v[108:111]
    s_waitcnt vmcnt(22)
    s_barrier
    buffer_load_dwordx4 v1, s[28:31], s41 offen sc1 lds
    v_mfma_f32_16x16x32_bf16 v[112:115], v[44:47], a[184:187], v[112:115]
    ds_read_b128 v[40:43], v239 offset:0
    s_add_u32 s41, s41, 4096
    v_mfma_f32_16x16x32_bf16 v[116:119], v[44:47], a[188:191], v[116:119]
    s_waitcnt lgkmcnt(3)
    s_add_u32 m0, s47, 139264
    v_mfma_f32_16x16x32_bf16 v[104:107], v[48:51], a[192:195], v[104:107]
    ds_read_b128 v[44:47], v239 offset:1024
    v_mfma_f32_16x16x32_bf16 v[108:111], v[48:51], a[196:199], v[108:111]
    buffer_store_dwordx4 v[80:83], v1, s[28:31], s54 offen offset:0 sc1
    v_mfma_f32_16x16x32_bf16 v[112:115], v[52:55], a[192:195], v[112:115]
    ds_read_b128 v[48:51], v239 offset:2048
    v_cvt_pk_bf16_f32 v84, v84, v85
    v_mfma_f32_16x16x32_bf16 v[116:119], v[52:55], a[196:199], v[116:119]
    s_waitcnt lgkmcnt(3)
    buffer_load_dwordx4 v1, s[28:31], s41 offen sc1 lds
    v_mfma_f32_16x16x32_bf16 v[104:107], v[56:59], a[200:203], v[104:107]
    ds_read_b128 v[52:55], v239 offset:3072
    s_add_u32 s41, s41, 4096
    v_mfma_f32_16x16x32_bf16 v[108:111], v[56:59], a[204:207], v[108:111]
    s_add_u32 m0, s47, 143360
    v_cvt_pk_bf16_f32 v85, v86, v87
    v_cvt_pk_bf16_f32 v86, v92, v93
    v_mfma_f32_16x16x32_bf16 v[112:115], v[60:63], a[200:203], v[112:115]
    ds_read_b128 v[56:59], v239 offset:4096
    v_cvt_pk_bf16_f32 v87, v94, v95
    v_mfma_f32_16x16x32_bf16 v[116:119], v[60:63], a[204:207], v[116:119]
    s_waitcnt lgkmcnt(3)
    buffer_load_dwordx4 v1, s[28:31], s41 offen sc1 lds
    v_mfma_f32_16x16x32_bf16 v[104:107], v[40:43], a[208:211], v[104:107]
    ds_read_b128 v[60:63], v239 offset:5120
    s_add_u32 s41, s41, 4096
    v_mfma_f32_16x16x32_bf16 v[108:111], v[40:43], a[212:215], v[108:111]
    buffer_store_dwordx4 v[84:87], v1, s[28:31], s54 offen offset:1024 sc1
    v_mfma_f32_16x16x32_bf16 v[112:115], v[44:47], a[208:211], v[112:115]
    ds_read_b128 v[40:43], v239 offset:6144
    s_add_u32 m0, s47, 147456
    v_mfma_f32_16x16x32_bf16 v[116:119], v[44:47], a[212:215], v[116:119]
    s_waitcnt lgkmcnt(3)
    v_cvt_pk_bf16_f32 v176, v96, v97
    v_cvt_pk_bf16_f32 v177, v98, v99
    v_mfma_f32_16x16x32_bf16 v[104:107], v[48:51], a[216:219], v[104:107]
    ds_read_b128 v[44:47], v239 offset:7168
    v_cvt_pk_bf16_f32 v178, v100, v101
    v_mfma_f32_16x16x32_bf16 v[108:111], v[48:51], a[220:223], v[108:111]
    buffer_load_dwordx4 v1, s[28:31], s41 offen sc1 lds
    v_mfma_f32_16x16x32_bf16 v[112:115], v[52:55], a[216:219], v[112:115]
    ds_read_b128 v[48:51], v237 offset:8192
    v_cvt_pk_bf16_f32 v179, v102, v103
    v_mfma_f32_16x16x32_bf16 v[116:119], v[52:55], a[220:223], v[116:119]
    s_waitcnt lgkmcnt(3)
    v_mfma_f32_16x16x32_bf16 v[104:107], v[56:59], a[224:227], v[104:107]
    ds_read_b128 v[52:55], v237 offset:9216
    v_mfma_f32_16x16x32_bf16 v[108:111], v[56:59], a[228:231], v[108:111]
    buffer_store_dwordx4 v[176:179], v1, s[28:31], s56 offen sc1
    v_mfma_f32_16x16x32_bf16 v[112:115], v[60:63], a[224:227], v[112:115]
    ds_read_b128 v[56:59], v237 offset:10240
    v_mfma_f32_16x16x32_bf16 v[116:119], v[60:63], a[228:231], v[116:119]
    s_waitcnt lgkmcnt(3)
    v_mfma_f32_16x16x32_bf16 v[104:107], v[40:43], a[232:235], v[104:107]
    ds_read_b128 v[60:63], v237 offset:11264
    v_mfma_f32_16x16x32_bf16 v[108:111], v[40:43], a[236:239], v[108:111]
    v_mfma_f32_16x16x32_bf16 v[112:115], v[44:47], a[232:235], v[112:115]
    ds_read_b128 v[40:43], v237 offset:12288
    v_mfma_f32_16x16x32_bf16 v[116:119], v[44:47], a[236:239], v[116:119]
    s_waitcnt lgkmcnt(3)
    v_mfma_f32_16x16x32_bf16 v[104:107], v[48:51], a[240:243], v[104:107]
    ds_read_b128 v[44:47], v237 offset:13312
    v_mfma_f32_16x16x32_bf16 v[108:111], v[48:51], a[244:247], v[108:111]
    v_mfma_f32_16x16x32_bf16 v[112:115], v[52:55], a[240:243], v[112:115]
    ds_read_b128 v[48:51], v237 offset:14336
    v_mfma_f32_16x16x32_bf16 v[116:119], v[52:55], a[244:247], v[116:119]
    s_waitcnt lgkmcnt(3)
    v_mfma_f32_16x16x32_bf16 v[104:107], v[56:59], a[248:251], v[104:107]
    ds_read_b128 v[52:55], v237 offset:15360
    v_mfma_f32_16x16x32_bf16 v[108:111], v[56:59], a[252:255], v[108:111]
    v_mfma_f32_16x16x32_bf16 v[112:115], v[60:63], a[248:251], v[112:115]
    ds_read_b128 v[56:59], v237 offset:24576
    v_mfma_f32_16x16x32_bf16 v[116:119], v[60:63], a[252:255], v[116:119]
    s_waitcnt lgkmcnt(3)
    v_mfma_f32_16x16x32_bf16 v[120:123], v[40:43], a[0:3], 0
    ds_read_b128 v[60:63], v237 offset:25600
    v_mfma_f32_16x16x32_bf16 v[124:127], v[40:43], a[4:7], 0
    v_mfma_f32_16x16x32_bf16 v[192:195], v[44:47], a[0:3], 0
    ds_read_b128 v[40:43], v237 offset:26624
    v_mfma_f32_16x16x32_bf16 v[196:199], v[44:47], a[4:7], 0
    s_waitcnt lgkmcnt(3)
    v_mfma_f32_16x16x32_bf16 v[120:123], v[48:51], a[8:11], v[120:123]
    ds_read_b128 v[44:47], v237 offset:27648
    v_mfma_f32_16x16x32_bf16 v[124:127], v[48:51], a[12:15], v[124:127]
    v_mfma_f32_16x16x32_bf16 v[192:195], v[52:55], a[8:11], v[192:195]
    ds_read_b128 v[48:51], v237 offset:28672
    v_cvt_pk_bf16_f32 v104, v104, v105
    v_mfma_f32_16x16x32_bf16 v[196:199], v[52:55], a[12:15], v[196:199]
    s_waitcnt lgkmcnt(3)
    v_cvt_pk_bf16_f32 v105, v106, v107
    v_cvt_pk_bf16_f32 v106, v112, v113
    v_mfma_f32_16x16x32_bf16 v[120:123], v[56:59], a[16:19], v[120:123]
    ds_read_b128 v[52:55], v237 offset:29696
    v_cvt_pk_bf16_f32 v107, v114, v115
    v_mfma_f32_16x16x32_bf16 v[124:127], v[56:59], a[20:23], v[124:127]
    buffer_store_dwordx4 v[104:107], v1, s[28:31], s55 offen offset:0 sc1
    v_mfma_f32_16x16x32_bf16 v[192:195], v[60:63], a[16:19], v[192:195]
    ds_read_b128 v[56:59], v237 offset:30720
    v_cvt_pk_bf16_f32 v108, v108, v109
    v_mfma_f32_16x16x32_bf16 v[196:199], v[60:63], a[20:23], v[196:199]
    s_waitcnt lgkmcnt(3)
    v_cvt_pk_bf16_f32 v109, v110, v111
    v_cvt_pk_bf16_f32 v110, v116, v117
    v_mfma_f32_16x16x32_bf16 v[120:123], v[40:43], a[24:27], v[120:123]
    ds_read_b128 v[60:63], v237 offset:31744
    v_cvt_pk_bf16_f32 v111, v118, v119
    v_mfma_f32_16x16x32_bf16 v[124:127], v[40:43], a[28:31], v[124:127]
    s_waitcnt vmcnt(24)
    s_barrier
    v_mfma_f32_16x16x32_bf16 v[192:195], v[44:47], a[24:27], v[192:195]
    ds_read_b128 v[40:43], v237 offset:40960
    v_mfma_f32_16x16x32_bf16 v[196:199], v[44:47], a[28:31], v[196:199]
    s_waitcnt lgkmcnt(3)
    v_mfma_f32_16x16x32_bf16 v[120:123], v[48:51], a[32:35], v[120:123]
    ds_read_b128 v[44:47], v237 offset:41984
    v_mfma_f32_16x16x32_bf16 v[124:127], v[48:51], a[36:39], v[124:127]
    buffer_store_dwordx4 v[108:111], v1, s[28:31], s55 offen offset:1024 sc1
    v_mfma_f32_16x16x32_bf16 v[192:195], v[52:55], a[32:35], v[192:195]
    ds_read_b128 v[48:51], v237 offset:43008
    s_waitcnt vmcnt(15)
    v_mfma_f32_16x16x32_bf16 v[196:199], v[52:55], a[36:39], v[196:199]
    s_waitcnt lgkmcnt(3)
    s_mov_b32 s17, 0xffff0000
    v_lshlrev_b32 v64, 16, v200
    v_mfma_f32_16x16x32_bf16 v[120:123], v[56:59], a[40:43], v[120:123]
    ds_read_b128 v[52:55], v237 offset:44032
    v_and_b32 v65, s17, v200
    v_mfma_f32_16x16x32_bf16 v[124:127], v[56:59], a[44:47], v[124:127]
    v_lshlrev_b32 v66, 16, v201
    v_and_b32 v67, s17, v201
    v_mfma_f32_16x16x32_bf16 v[192:195], v[60:63], a[40:43], v[192:195]
    ds_read_b128 v[56:59], v237 offset:45056
    v_lshlrev_b32 v68, 16, v202
    v_mfma_f32_16x16x32_bf16 v[196:199], v[60:63], a[44:47], v[196:199]
    s_waitcnt lgkmcnt(3)
    v_and_b32 v69, s17, v202
    v_lshlrev_b32 v70, 16, v203
    v_mfma_f32_16x16x32_bf16 v[120:123], v[40:43], a[48:51], v[120:123]
    ds_read_b128 v[60:63], v237 offset:46080
    v_and_b32 v71, s17, v203
    v_mfma_f32_16x16x32_bf16 v[124:127], v[40:43], a[52:55], v[124:127]
    v_lshlrev_b32 v72, 16, v204
    v_and_b32 v73, s17, v204
    v_mfma_f32_16x16x32_bf16 v[192:195], v[44:47], a[48:51], v[192:195]
    ds_read_b128 v[40:43], v237 offset:47104
    v_lshlrev_b32 v74, 16, v205
    v_mfma_f32_16x16x32_bf16 v[196:199], v[44:47], a[52:55], v[196:199]
    s_waitcnt lgkmcnt(3)
    v_and_b32 v75, s17, v205
    v_lshlrev_b32 v76, 16, v206
    v_mfma_f32_16x16x32_bf16 v[120:123], v[48:51], a[56:59], v[120:123]
    ds_read_b128 v[44:47], v237 offset:48128
    v_and_b32 v77, s17, v206
    v_mfma_f32_16x16x32_bf16 v[124:127], v[48:51], a[60:63], v[124:127]
    v_lshlrev_b32 v78, 16, v207
    v_and_b32 v79, s17, v207
    v_mfma_f32_16x16x32_bf16 v[192:195], v[52:55], a[56:59], v[192:195]
    ds_read_b128 v[48:51], v237 offset:57344
    v_lshlrev_b32 v80, 16, v208
    v_mfma_f32_16x16x32_bf16 v[196:199], v[52:55], a[60:63], v[196:199]
    s_waitcnt lgkmcnt(3)
    v_and_b32 v81, s17, v208
    v_lshlrev_b32 v82, 16, v209
    v_mfma_f32_16x16x32_bf16 v[120:123], v[56:59], a[64:67], v[120:123]
    ds_read_b128 v[52:55], v237 offset:58368
    v_and_b32 v83, s17, v209
    v_mfma_f32_16x16x32_bf16 v[124:127], v[56:59], a[68:71], v[124:127]
    v_lshlrev_b32 v84, 16, v210
    v_and_b32 v85, s17, v210
    v_mfma_f32_16x16x32_bf16 v[192:195], v[60:63], a[64:67], v[192:195]
    ds_read_b128 v[56:59], v237 offset:59392
    v_lshlrev_b32 v86, 16, v211
    v_mfma_f32_16x16x32_bf16 v[196:199], v[60:63], a[68:71], v[196:199]
    s_waitcnt lgkmcnt(3)
    v_and_b32 v87, s17, v211
    v_and_b32 v2, 15, v0
    v_mfma_f32_16x16x32_bf16 v[120:123], v[40:43], a[72:75], v[120:123]
    ds_read_b128 v[60:63], v237 offset:60416
    v_mul_u32_u24 v2, 1152, v2
    v_mfma_f32_16x16x32_bf16 v[124:127], v[40:43], a[76:79], v[124:127]
    v_lshl_add_u32 v3, v244, 4, v2
    v_lshl_add_u32 v4, v244, 3, v2
    v_mfma_f32_16x16x32_bf16 v[192:195], v[44:47], a[72:75], v[192:195]
    ds_read_b128 v[40:43], v237 offset:61440
    s_lshl_b32 s9, s15, 1
    v_mfma_f32_16x16x32_bf16 v[196:199], v[44:47], a[76:79], v[196:199]
    s_waitcnt lgkmcnt(3)
    s_add_u32 s45, s62, s9
    s_lshl_b32 s9, s14, 1
    v_mfma_f32_16x16x32_bf16 v[120:123], v[48:51], a[80:83], v[120:123]
    ds_read_b128 v[44:47], v237 offset:62464
    s_add_u32 s46, s62, s9
    v_mfma_f32_16x16x32_bf16 v[124:127], v[48:51], a[84:87], v[124:127]
    v_mfma_f32_16x16x32_bf16 v[192:195], v[52:55], a[80:83], v[192:195]
    ds_read_b128 v[48:51], v237 offset:63488
    v_mfma_f32_16x16x32_bf16 v[196:199], v[52:55], a[84:87], v[196:199]
    s_waitcnt lgkmcnt(3)
    v_mfma_f32_16x16x32_bf16 v[120:123], v[56:59], a[88:91], v[120:123]
    ds_read_b128 v[52:55], v237 offset:64512
    v_mfma_f32_16x16x32_bf16 v[124:127], v[56:59], a[92:95], v[124:127]
    v_mfma_f32_16x16x32_bf16 v[192:195], v[60:63], a[88:91], v[192:195]
    ds_read_b128 v[56:59], v238 offset:8192
    v_mfma_f32_16x16x32_bf16 v[196:199], v[60:63], a[92:95], v[196:199]
    s_waitcnt lgkmcnt(3)
    v_mfma_f32_16x16x32_bf16 v[120:123], v[40:43], a[96:99], v[120:123]
    ds_read_b128 v[60:63], v238 offset:9216
    v_mfma_f32_16x16x32_bf16 v[124:127], v[40:43], a[100:103], v[124:127]
    v_mfma_f32_16x16x32_bf16 v[192:195], v[44:47], a[96:99], v[192:195]
    ds_read_b128 v[40:43], v238 offset:10240
    v_mfma_f32_16x16x32_bf16 v[196:199], v[44:47], a[100:103], v[196:199]
    s_waitcnt lgkmcnt(3)
    v_mfma_f32_16x16x32_bf16 v[120:123], v[48:51], a[104:107], v[120:123]
    ds_read_b128 v[44:47], v238 offset:11264
    v_mfma_f32_16x16x32_bf16 v[124:127], v[48:51], a[108:111], v[124:127]
    v_mfma_f32_16x16x32_bf16 v[192:195], v[52:55], a[104:107], v[192:195]
    ds_read_b128 v[48:51], v238 offset:12288
    v_mfma_f32_16x16x32_bf16 v[196:199], v[52:55], a[108:111], v[196:199]
    s_waitcnt lgkmcnt(3)
    v_mfma_f32_16x16x32_bf16 v[120:123], v[56:59], a[112:115], v[120:123]
    ds_read_b128 v[52:55], v238 offset:13312
    v_mfma_f32_16x16x32_bf16 v[124:127], v[56:59], a[116:119], v[124:127]
    v_mfma_f32_16x16x32_bf16 v[192:195], v[60:63], a[112:115], v[192:195]
    ds_read_b128 v[56:59], v238 offset:14336
    v_mfma_f32_16x16x32_bf16 v[196:199], v[60:63], a[116:119], v[196:199]
    s_waitcnt lgkmcnt(3)
    v_mfma_f32_16x16x32_bf16 v[120:123], v[40:43], a[120:123], v[120:123]
    ds_read_b128 v[60:63], v238 offset:15360
    v_mfma_f32_16x16x32_bf16 v[124:127], v[40:43], a[124:127], v[124:127]
    s_waitcnt vmcnt(8)
    s_barrier
    buffer_load_dwordx4 v[128:131], v1, s[28:31], s57 offen offset:0 sc1
    v_mfma_f32_16x16x32_bf16 v[192:195], v[44:47], a[120:123], v[192:195]
    ds_read_b128 v[40:43], v238 offset:24576
    v_mfma_f32_16x16x32_bf16 v[196:199], v[44:47], a[124:127], v[196:199]
    s_waitcnt lgkmcnt(3)
    buffer_load_dwordx4 v[132:135], v1, s[28:31], s57 offen offset:1024 sc1
    v_mfma_f32_16x16x32_bf16 v[120:123], v[48:51], v[8:11], v[120:123]
    ds_read_b128 v[44:47], v238 offset:25600
    v_mfma_f32_16x16x32_bf16 v[124:127], v[48:51], v[12:15], v[124:127]
    buffer_load_dwordx4 v[136:139], v1, s[28:31], s57 offen offset:2048 sc1
    v_mfma_f32_16x16x32_bf16 v[192:195], v[52:55], v[8:11], v[192:195]
    ds_read_b128 v[48:51], v238 offset:26624
    v_mfma_f32_16x16x32_bf16 v[196:199], v[52:55], v[12:15], v[196:199]
    s_waitcnt lgkmcnt(3)
    v_mfma_f32_16x16x32_bf16 v[120:123], v[56:59], v[16:19], v[120:123]
    ds_read_b128 v[52:55], v238 offset:27648
    v_mfma_f32_16x16x32_bf16 v[124:127], v[56:59], v[20:23], v[124:127]
    buffer_load_dwordx4 v[140:143], v1, s[28:31], s57 offen offset:3072 sc1
    v_mfma_f32_16x16x32_bf16 v[192:195], v[60:63], v[16:19], v[192:195]
    ds_read_b128 v[56:59], v238 offset:28672
    v_mfma_f32_16x16x32_bf16 v[196:199], v[60:63], v[20:23], v[196:199]
    s_waitcnt lgkmcnt(3)
    v_mfma_f32_16x16x32_bf16 v[120:123], v[40:43], v[24:27], v[120:123]
    ds_read_b128 v[60:63], v238 offset:29696
    v_mfma_f32_16x16x32_bf16 v[124:127], v[40:43], v[28:31], v[124:127]
    buffer_load_dwordx4 v[152:155], v1, s[28:31], s38 offen sc1
    v_mfma_f32_16x16x32_bf16 v[192:195], v[44:47], v[24:27], v[192:195]
    ds_read_b128 v[40:43], v238 offset:30720
    v_mfma_f32_16x16x32_bf16 v[196:199], v[44:47], v[28:31], v[196:199]
    s_waitcnt lgkmcnt(3)
    buffer_load_dwordx4 v[156:159], v1, s[28:31], s39 offen sc1
    v_mfma_f32_16x16x32_bf16 v[120:123], v[48:51], v[32:35], v[120:123]
    ds_read_b128 v[44:47], v238 offset:31744
    v_mfma_f32_16x16x32_bf16 v[124:127], v[48:51], v[36:39], v[124:127]
    buffer_load_dwordx4 v[160:163], v1, s[28:31], s40 offen sc1
    v_mfma_f32_16x16x32_bf16 v[192:195], v[52:55], v[32:35], v[192:195]
    ds_read_b128 v[48:51], v238 offset:40960
    v_mfma_f32_16x16x32_bf16 v[196:199], v[52:55], v[36:39], v[196:199]
    s_waitcnt lgkmcnt(3)
    v_mfma_f32_16x16x32_bf16 v[120:123], v[56:59], a[128:131], v[120:123]
    ds_read_b128 v[52:55], v238 offset:41984
    v_mfma_f32_16x16x32_bf16 v[124:127], v[56:59], a[132:135], v[124:127]
    v_mfma_f32_16x16x32_bf16 v[192:195], v[60:63], a[128:131], v[192:195]
    ds_read_b128 v[56:59], v238 offset:43008
    v_mfma_f32_16x16x32_bf16 v[196:199], v[60:63], a[132:135], v[196:199]
    s_waitcnt lgkmcnt(3)
    v_mfma_f32_16x16x32_bf16 v[120:123], v[40:43], a[136:139], v[120:123]
    ds_read_b128 v[60:63], v238 offset:44032
    v_mfma_f32_16x16x32_bf16 v[124:127], v[40:43], a[140:143], v[124:127]
    v_mfma_f32_16x16x32_bf16 v[192:195], v[44:47], a[136:139], v[192:195]
    ds_read_b128 v[40:43], v238 offset:45056
    v_mfma_f32_16x16x32_bf16 v[196:199], v[44:47], a[140:143], v[196:199]
    s_waitcnt lgkmcnt(3)
    v_mfma_f32_16x16x32_bf16 v[120:123], v[48:51], a[144:147], v[120:123]
    ds_read_b128 v[44:47], v238 offset:46080
    v_mfma_f32_16x16x32_bf16 v[124:127], v[48:51], a[148:151], v[124:127]
    v_mfma_f32_16x16x32_bf16 v[192:195], v[52:55], a[144:147], v[192:195]
    ds_read_b128 v[48:51], v238 offset:47104
    v_mfma_f32_16x16x32_bf16 v[196:199], v[52:55], a[148:151], v[196:199]
    s_waitcnt lgkmcnt(3)
    v_mfma_f32_16x16x32_bf16 v[120:123], v[56:59], a[152:155], v[120:123]
    ds_read_b128 v[52:55], v238 offset:48128
    v_mfma_f32_16x16x32_bf16 v[124:127], v[56:59], a[156:159], v[124:127]
    v_mfma_f32_16x16x32_bf16 v[192:195], v[60:63], a[152:155], v[192:195]
    ds_read_b128 v[56:59], v238 offset:57344
    v_mfma_f32_16x16x32_bf16 v[196:199], v[60:63], a[156:159], v[196:199]
    s_waitcnt lgkmcnt(3)
    v_mfma_f32_16x16x32_bf16 v[120:123], v[40:43], a[160:163], v[120:123]
    ds_read_b128 v[60:63], v238 offset:58368
    v_mfma_f32_16x16x32_bf16 v[124:127], v[40:43], a[164:167], v[124:127]
    v_mfma_f32_16x16x32_bf16 v[192:195], v[44:47], a[160:163], v[192:195]
    ds_read_b128 v[40:43], v238 offset:59392
    v_mfma_f32_16x16x32_bf16 v[196:199], v[44:47], a[164:167], v[196:199]
    s_waitcnt lgkmcnt(3)
    v_mfma_f32_16x16x32_bf16 v[120:123], v[48:51], a[168:171], v[120:123]
    ds_read_b128 v[44:47], v238 offset:60416
    v_mfma_f32_16x16x32_bf16 v[124:127], v[48:51], a[172:175], v[124:127]
    v_mfma_f32_16x16x32_bf16 v[192:195], v[52:55], a[168:171], v[192:195]
    ds_read_b128 v[48:51], v238 offset:61440
    v_mfma_f32_16x16x32_bf16 v[196:199], v[52:55], a[172:175], v[196:199]
    s_waitcnt lgkmcnt(3)
    v_mfma_f32_16x16x32_bf16 v[120:123], v[56:59], a[176:179], v[120:123]
    ds_read_b128 v[52:55], v238 offset:62464
    v_mfma_f32_16x16x32_bf16 v[124:127], v[56:59], a[180:183], v[124:127]
    v_mfma_f32_16x16x32_bf16 v[192:195], v[60:63], a[176:179], v[192:195]
    ds_read_b128 v[56:59], v238 offset:63488
    v_mfma_f32_16x16x32_bf16 v[196:199], v[60:63], a[180:183], v[196:199]
    s_waitcnt lgkmcnt(3)
    v_mfma_f32_16x16x32_bf16 v[120:123], v[40:43], a[184:187], v[120:123]
    ds_read_b128 v[60:63], v238 offset:64512
    s_add_u32 s57, s57, 4096
    v_mfma_f32_16x16x32_bf16 v[124:127], v[40:43], a[188:191], v[124:127]
    s_waitcnt vmcnt(10)
    s_barrier
    buffer_load_dwordx4 v[144:147], v1, s[28:31], s57 offen offset:0 sc1
    v_mfma_f32_16x16x32_bf16 v[192:195], v[44:47], a[184:187], v[192:195]
    ds_read_b128 v[40:43], v239 offset:8192
    v_mfma_f32_16x16x32_bf16 v[196:199], v[44:47], a[188:191], v[196:199]
    s_waitcnt lgkmcnt(3)
    buffer_load_dwordx4 v[148:151], v1, s[28:31], s57 offen offset:1024 sc1
    v_mfma_f32_16x16x32_bf16 v[120:123], v[48:51], a[192:195], v[120:123]
    ds_read_b128 v[44:47], v239 offset:9216
    v_mfma_f32_16x16x32_bf16 v[124:127], v[48:51], a[196:199], v[124:127]
    v_mfma_f32_16x16x32_bf16 v[192:195], v[52:55], a[192:195], v[192:195]
    ds_read_b128 v[48:51], v239 offset:10240
    v_mfma_f32_16x16x32_bf16 v[196:199], v[52:55], a[196:199], v[196:199]
    s_waitcnt lgkmcnt(3)
    v_mfma_f32_16x16x32_bf16 v[120:123], v[56:59], a[200:203], v[120:123]
    ds_read_b128 v[52:55], v239 offset:11264
    v_mfma_f32_16x16x32_bf16 v[124:127], v[56:59], a[204:207], v[124:127]
    v_mfma_f32_16x16x32_bf16 v[192:195], v[60:63], a[200:203], v[192:195]
    ds_read_b128 v[56:59], v239 offset:12288
    v_mfma_f32_16x16x32_bf16 v[196:199], v[60:63], a[204:207], v[196:199]
    s_waitcnt lgkmcnt(3)
    v_mfma_f32_16x16x32_bf16 v[120:123], v[40:43], a[208:211], v[120:123]
    ds_read_b128 v[60:63], v239 offset:13312
    v_mfma_f32_16x16x32_bf16 v[124:127], v[40:43], a[212:215], v[124:127]
    v_mfma_f32_16x16x32_bf16 v[192:195], v[44:47], a[208:211], v[192:195]
    ds_read_b128 v[40:43], v239 offset:14336
    v_mfma_f32_16x16x32_bf16 v[196:199], v[44:47], a[212:215], v[196:199]
    s_waitcnt lgkmcnt(3)
    v_mfma_f32_16x16x32_bf16 v[120:123], v[48:51], a[216:219], v[120:123]
    ds_read_b128 v[44:47], v239 offset:15360
    v_mfma_f32_16x16x32_bf16 v[124:127], v[48:51], a[220:223], v[124:127]
    v_mfma_f32_16x16x32_bf16 v[192:195], v[52:55], a[216:219], v[192:195]
    ds_read_b128 v[48:51], v239 offset:16384
    v_mfma_f32_16x16x32_bf16 v[196:199], v[52:55], a[220:223], v[196:199]
    s_waitcnt lgkmcnt(3)
    v_mfma_f32_16x16x32_bf16 v[120:123], v[56:59], a[224:227], v[120:123]
    ds_read_b128 v[52:55], v239 offset:17408
    v_mfma_f32_16x16x32_bf16 v[124:127], v[56:59], a[228:231], v[124:127]
    v_mfma_f32_16x16x32_bf16 v[192:195], v[60:63], a[224:227], v[192:195]
    ds_read_b128 v[56:59], v239 offset:18432
    v_mfma_f32_16x16x32_bf16 v[196:199], v[60:63], a[228:231], v[196:199]
    s_waitcnt lgkmcnt(3)
    v_mfma_f32_16x16x32_bf16 v[120:123], v[40:43], a[232:235], v[120:123]
    ds_read_b128 v[60:63], v239 offset:19456
    v_mfma_f32_16x16x32_bf16 v[124:127], v[40:43], a[236:239], v[124:127]
    v_mfma_f32_16x16x32_bf16 v[192:195], v[44:47], a[232:235], v[192:195]
    v_mfma_f32_16x16x32_bf16 v[196:199], v[44:47], a[236:239], v[196:199]
    s_waitcnt lgkmcnt(2)
    v_mfma_f32_16x16x32_bf16 v[120:123], v[48:51], a[240:243], v[120:123]
    v_mfma_f32_16x16x32_bf16 v[124:127], v[48:51], a[244:247], v[124:127]
    v_mfma_f32_16x16x32_bf16 v[192:195], v[52:55], a[240:243], v[192:195]
    v_mfma_f32_16x16x32_bf16 v[196:199], v[52:55], a[244:247], v[196:199]
    s_waitcnt lgkmcnt(0)
    v_mfma_f32_16x16x32_bf16 v[120:123], v[56:59], a[248:251], v[120:123]
    v_mfma_f32_16x16x32_bf16 v[124:127], v[56:59], a[252:255], v[124:127]
    v_mfma_f32_16x16x32_bf16 v[192:195], v[60:63], a[248:251], v[192:195]
    v_mfma_f32_16x16x32_bf16 v[196:199], v[60:63], a[252:255], v[196:199]
    s_waitcnt vmcnt(2)
    s_mov_b32 s16, 0
RX1_CHK:
    v_max3_u32 v246, v128, v129, v130
    v_max3_u32 v246, v246, v131, v132
    v_max3_u32 v246, v246, v133, v134
    v_max3_u32 v246, v246, v135, v136
    v_max3_u32 v246, v246, v137, v138
    v_max3_u32 v246, v246, v139, v140
    v_max3_u32 v246, v246, v141, v142
    v_max3_u32 v246, v246, v143, v152
    v_max3_u32 v246, v246, v153, v154
    v_max3_u32 v246, v246, v155, v156
    v_max3_u32 v246, v246, v157, v158
    v_max3_u32 v246, v246, v159, v160
    v_max3_u32 v246, v246, v161, v162
    v_max_u32 v246, v246, v163
    v_cmp_eq_u32 vcc, -1, v246
    s_add_u32 s16, s16, 1
    s_cmp_ge_u32 s16, 60000
    s_cbranch_scc1 RX1_OK
    s_cbranch_vccz RX1_OK
    s_sub_u32 s9, s57, 4096
    buffer_load_dwordx4 v[128:131], v1, s[28:31], s9 offen offset:0 sc1
    buffer_load_dwordx4 v[132:135], v1, s[28:31], s9 offen offset:1024 sc1
    buffer_load_dwordx4 v[136:139], v1, s[28:31], s9 offen offset:2048 sc1
    buffer_load_dwordx4 v[140:143], v1, s[28:31], s9 offen offset:3072 sc1
    buffer_load_dwordx4 v[152:155], v1, s[28:31], s38 offen sc1
    buffer_load_dwordx4 v[156:159], v1, s[28:31], s39 offen sc1
    buffer_load_dwordx4 v[160:163], v1, s[28:31], s40 offen sc1
    s_waitcnt vmcnt(0)
    s_branch RX1_CHK
RX1_OK:
    v_dot2c_f32_bf16 v96, v152, v247
    v_dot2c_f32_bf16 v97, v152, v248
    v_dot2c_f32_bf16 v98, v153, v247
    v_dot2c_f32_bf16 v99, v153, v248
    v_dot2c_f32_bf16 v100, v154, v247
    v_dot2c_f32_bf16 v101, v154, v248
    v_dot2c_f32_bf16 v102, v155, v247
    v_dot2c_f32_bf16 v103, v155, v248
    v_dot2c_f32_bf16 v96, v156, v247
    v_dot2c_f32_bf16 v97, v156, v248
    v_dot2c_f32_bf16 v98, v157, v247
    v_dot2c_f32_bf16 v99, v157, v248
    v_dot2c_f32_bf16 v100, v158, v247
    v_dot2c_f32_bf16 v101, v158, v248
    v_dot2c_f32_bf16 v102, v159, v247
    v_dot2c_f32_bf16 v103, v159, v248
    v_dot2c_f32_bf16 v96, v160, v247
    v_dot2c_f32_bf16 v97, v160, v248
    v_dot2c_f32_bf16 v98, v161, v247
    v_dot2c_f32_bf16 v99, v161, v248
    v_dot2c_f32_bf16 v100, v162, v247
    v_dot2c_f32_bf16 v101, v162, v248
    v_dot2c_f32_bf16 v102, v163, v247
    v_dot2c_f32_bf16 v103, v163, v248
    v_dot2c_f32_bf16 v120, v128, v247
    v_dot2c_f32_bf16 v121, v128, v248
    v_dot2c_f32_bf16 v122, v129, v247
    v_dot2c_f32_bf16 v123, v129, v248
    v_dot2c_f32_bf16 v192, v130, v247
    v_dot2c_f32_bf16 v193, v130, v248
    v_dot2c_f32_bf16 v194, v131, v247
    v_dot2c_f32_bf16 v195, v131, v248
    v_dot2c_f32_bf16 v120, v136, v247
    v_dot2c_f32_bf16 v121, v136, v248
    v_dot2c_f32_bf16 v122, v137, v247
    v_dot2c_f32_bf16 v123, v137, v248
    v_dot2c_f32_bf16 v192, v138, v247
    v_dot2c_f32_bf16 v193, v138, v248
    v_dot2c_f32_bf16 v194, v139, v247
    v_dot2c_f32_bf16 v195, v139, v248
    v_dot2c_f32_bf16 v124, v132, v247
    v_dot2c_f32_bf16 v125, v132, v248
    v_dot2c_f32_bf16 v126, v133, v247
    v_dot2c_f32_bf16 v127, v133, v248
    v_dot2c_f32_bf16 v196, v134, v247
    v_dot2c_f32_bf16 v197, v134, v248
    v_dot2c_f32_bf16 v198, v135, v247
    v_dot2c_f32_bf16 v199, v135, v248
    v_dot2c_f32_bf16 v124, v140, v247
    v_dot2c_f32_bf16 v125, v140, v248
    v_dot2c_f32_bf16 v126, v141, v247
    v_dot2c_f32_bf16 v127, v141, v248
    v_dot2c_f32_bf16 v196, v142, v247
    v_dot2c_f32_bf16 v197, v142, v248
    v_dot2c_f32_bf16 v198, v143, v247
    v_dot2c_f32_bf16 v199, v143, v248
    v_pk_fma_f32 v[80:81], v[96:97], v[172:173], v[80:81]
    v_pk_fma_f32 v[82:83], v[98:99], v[174:175], v[82:83]
    v_pk_fma_f32 v[84:85], v[100:101], v[172:173], v[84:85]
    v_pk_fma_f32 v[86:87], v[102:103], v[174:175], v[86:87]
    v_cvt_pk_bf16_f32 v96, v80, v81
    v_cvt_pk_bf16_f32 v97, v82, v83
    v_cvt_pk_bf16_f32 v98, v84, v85
    v_cvt_pk_bf16_f32 v99, v86, v87
    s_mov_b32 s16, 0
RX2_CHK:
    s_waitcnt vmcnt(0)
    v_max3_u32 v246, v144, v145, v146
    v_max3_u32 v246, v246, v147, v148
    v_max3_u32 v246, v246, v149, v150
    v_max_u32 v246, v246, v151
    v_cmp_eq_u32 vcc, -1, v246
    s_add_u32 s16, s16, 1
    s_cmp_ge_u32 s16, 60000
    s_cbranch_scc1 RX2_OK
    s_cbranch_vccz RX2_OK
    buffer_load_dwordx4 v[144:147], v1, s[28:31], s57 offen offset:0 sc1
    buffer_load_dwordx4 v[148:151], v1, s[28:31], s57 offen offset:1024 sc1
    s_branch RX2_CHK
RX2_OK:
    v_dot2c_f32_bf16 v120, v144, v247
    v_dot2c_f32_bf16 v121, v144, v248
    v_dot2c_f32_bf16 v122, v145, v247
    v_dot2c_f32_bf16 v123, v145, v248
    v_dot2c_f32_bf16 v192, v146, v247
    v_dot2c_f32_bf16 v193, v146, v248
    v_dot2c_f32_bf16 v194, v147, v247
    v_dot2c_f32_bf16 v195, v147, v248
    v_dot2c_f32_bf16 v124, v148, v247
    v_dot2c_f32_bf16 v125, v148, v248
    v_dot2c_f32_bf16 v126, v149, v247
    v_dot2c_f32_bf16 v127, v149, v248
    v_dot2c_f32_bf16 v196, v150, v247
    v_dot2c_f32_bf16 v197, v150, v248
    v_dot2c_f32_bf16 v198, v151, v247
    v_dot2c_f32_bf16 v199, v151, v248
    v_pk_fma_f32 v[64:65], v[120:121], v[164:165], v[64:65]
    v_pk_fma_f32 v[66:67], v[122:123], v[166:167], v[66:67]
    v_pk_fma_f32 v[68:69], v[192:193], v[168:169], v[68:69]
    v_pk_fma_f32 v[70:71], v[194:195], v[170:171], v[70:71]
    v_cvt_pk_bf16_f32 v176, v64, v65
    v_cvt_pk_bf16_f32 v177, v66, v67
    v_cvt_pk_bf16_f32 v178, v68, v69
    v_cvt_pk_bf16_f32 v179, v70, v71
    buffer_store_dwordx4 v[176:179], v3, s[32:35], s45 offen
    s_add_u32 s45, s45, 18432
    v_pk_fma_f32 v[72:73], v[124:125], v[164:165], v[72:73]
    v_pk_fma_f32 v[74:75], v[126:127], v[166:167], v[74:75]
    v_pk_fma_f32 v[76:77], v[196:197], v[168:169], v[76:77]
    v_pk_fma_f32 v[78:79], v[198:199], v[170:171], v[78:79]
    v_cvt_pk_bf16_f32 v180, v72, v73
    v_cvt_pk_bf16_f32 v181, v74, v75
    v_cvt_pk_bf16_f32 v182, v76, v77
    v_cvt_pk_bf16_f32 v183, v78, v79
    buffer_store_dwordx4 v[180:183], v3, s[32:35], s45 offen
    s_cmp_lg_u32 s3, s10
    s_cbranch_scc1 KB_END
    buffer_store_dwordx2 v[96:97], v4, s[32:35], s46 offen
    s_add_u32 s46, s46, 18432
    buffer_store_dwordx2 v[98:99], v4, s[32:35], s46 offen
    s_cmp_lg_u32 s2, 0
    s_cbranch_scc1 KB_END
    v_and_b32 v2, 1, v0
    v_mul_u32_u24 v2, 201728, v2
    v_lshlrev_b32 v2, 8, v2
    v_add_u32 v2, 524288, v2
    buffer_store_dword v252, v2, s[28:31], 0 offen
KB_END:
    s_endpgm
HV_SLOW0:
    s_mov_b32 s16, 0
HV_SL0:
    buffer_load_dword v239, v195, s[28:31], s9 offen sc1
    s_add_u32 s16, s16, 1
    s_waitcnt vmcnt(0)
    v_cmp_ne_u32 vcc, s8, v239
    s_cmp_ge_u32 s16, 60000
    s_cbranch_scc1 HV_SL0_X
    s_and_b64 vcc, vcc, exec
    s_cbranch_scc0 HV_SL0_X
    s_mov_b64 exec, vcc
    s_branch HV_SL0
HV_SL0_X:
    s_mov_b64 exec, -1
    s_mul_i32 s16, s69, 18432
    s_add_u32 s16, s16, 9437184
    buffer_load_dwordx4 v[8:11], v1, s[28:31], s16 offen sc1
    buffer_load_dwordx4 v[12:15], v226, s[28:31], s16 offen sc1
    buffer_load_dwordx4 v[16:19], v227, s[28:31], s16 offen sc1
    buffer_load_dwordx4 v[20:23], v228, s[28:31], s16 offen sc1
    s_waitcnt vmcnt(0)
    s_branch HV_RET0
HV_SLOW1:
    s_mov_b32 s16, 0
HV_SL1:
    buffer_load_dword v239, v195, s[28:31], s9 offen sc1
    s_add_u32 s16, s16, 1
    s_waitcnt vmcnt(0)
    v_cmp_ne_u32 vcc, s8, v239
    s_cmp_ge_u32 s16, 60000
    s_cbranch_scc1 HV_SL1_X
    s_and_b64 vcc, vcc, exec
    s_cbranch_scc0 HV_SL1_X
    s_mov_b64 exec, vcc
    s_branch HV_SL1
HV_SL1_X:
    s_mov_b64 exec, -1
    s_mul_i32 s16, s69, 18432
    s_add_u32 s16, s16, 9438208
    buffer_load_dwordx4 v[24:27], v1, s[28:31], s16 offen sc1
    buffer_load_dwordx4 v[28:31], v226, s[28:31], s16 offen sc1
    buffer_load_dwordx4 v[32:35], v227, s[28:31], s16 offen sc1
    buffer_load_dwordx4 v[36:39], v228, s[28:31], s16 offen sc1
    s_waitcnt vmcnt(0)
    s_branch HV_RET1
HV_SLOW2:
    s_mov_b32 s16, 0
HV_SL2:
    buffer_load_dword v239, v195, s[28:31], s9 offen sc1
    s_add_u32 s16, s16, 1
    s_waitcnt vmcnt(0)
    v_cmp_ne_u32 vcc, s8, v239
    s_cmp_ge_u32 s16, 60000
    s_cbranch_scc1 HV_SL2_X
    s_and_b64 vcc, vcc, exec
    s_cbranch_scc0 HV_SL2_X
    s_mov_b64 exec, vcc
    s_branch HV_SL2
HV_SL2_X:
    s_mov_b64 exec, -1
    s_mul_i32 s16, s69, 18432
    s_add_u32 s16, s16, 9439232
    buffer_load_dwordx4 a[0:3], v1, s[28:31], s16 offen sc1
    buffer_load_dwordx4 a[4:7], v226, s[28:31], s16 offen sc1
    buffer_load_dwordx4 a[8:11], v227, s[28:31], s16 offen sc1
    buffer_load_dwordx4 a[12:15], v228, s[28:31], s16 offen sc1
    s_waitcnt vmcnt(0)
    s_branch HV_RET2
HV_SLOW3:
    s_mov_b32 s16, 0
HV_SL3:
    buffer_load_dword v239, v195, s[28:31], s9 offen sc1
    s_add_u32 s16, s16, 1
    s_waitcnt vmcnt(0)
    v_cmp_ne_u32 vcc, s8, v239
    s_cmp_ge_u32 s16, 60000
    s_cbranch_scc1 HV_SL3_X
    s_and_b64 vcc, vcc, exec
    s_cbranch_scc0 HV_SL3_X
    s_mov_b64 exec, vcc
    s_branch HV_SL3
HV_SL3_X:
    s_mov_b64 exec, -1
    s_mul_i32 s16, s69, 18432
    s_add_u32 s16, s16, 9440256
    buffer_load_dwordx4 a[16:19], v1, s[28:31], s16 offen sc1
    buffer_load_dwordx4 a[20:23], v226, s[28:31], s16 offen sc1
    buffer_load_dwordx4 a[24:27], v227, s[28:31], s16 offen sc1
    buffer_load_dwordx4 a[28:31], v228, s[28:31], s16 offen sc1
    s_waitcnt vmcnt(0)
    s_branch HV_RET3
HV_SLOW4:
    s_mov_b32 s16, 0
HV_SL4:
    buffer_load_dword v239, v195, s[28:31], s9 offen sc1
    s_add_u32 s16, s16, 1
    s_waitcnt vmcnt(0)
    v_cmp_ne_u32 vcc, s8, v239
    s_cmp_ge_u32 s16, 60000
    s_cbranch_scc1 HV_SL4_X
    s_and_b64 vcc, vcc, exec
    s_cbranch_scc0 HV_SL4_X
    s_mov_b64 exec, vcc
    s_branch HV_SL4
HV_SL4_X:
    s_mov_b64 exec, -1
    s_mul_i32 s16, s69, 18432
    s_add_u32 s16, s16, 9441280
    buffer_load_dwordx4 a[32:35], v1, s[28:31], s16 offen sc1
    buffer_load_dwordx4 a[36:39], v226, s[28:31], s16 offen sc1
    buffer_load_dwordx4 a[40:43], v227, s[28:31], s16 offen sc1
    buffer_load_dwordx4 a[44:47], v228, s[28:31], s16 offen sc1
    s_waitcnt vmcnt(0)
    s_branch HV_RET4
PB_SLOW:
    s_mov_b32 s16, 0
PB_SL:
    buffer_load_dwordx2 v[34:35], v33, s[28:31], 0 offen sc1
    s_add_u32 s16, s16, 1
    s_waitcnt vmcnt(0)
    v_cmp_ne_u32 vcc, s8, v35
    s_cmp_ge_u32 s16, 60000
    s_cbranch_scc1 PB_SL_X
    s_and_b64 vcc, vcc, exec
    s_cbranch_scc0 PB_SL_X
    s_mov_b64 exec, vcc
    s_sleep 1
    s_branch PB_SL
PB_SL_X:
    s_mov_b64 exec, -1
    s_branch PB_RET
K4_SLOW0:
    s_mov_b32 s16, 0
K4_SL0:
    buffer_load_dword v193, v195, s[28:31], s9 offen sc1
    s_add_u32 s16, s16, 1
    s_waitcnt vmcnt(0)
    v_cmp_ne_u32 vcc, s8, v193
    s_cmp_ge_u32 s16, 60000
    s_cbranch_scc1 K4_SL0_X
    s_and_b64 vcc, vcc, exec
    s_cbranch_scc0 K4_SL0_X
    s_mov_b64 exec, vcc
    s_branch K4_SL0
K4_SL0_X:
    s_mov_b64 exec, -1
    s_branch K4_RET0
K4_SLOW1:
    s_mov_b32 s16, 0
K4_SL1:
    buffer_load_dword v193, v192, s[28:31], s61 offen sc1
    s_add_u32 s16, s16, 1
    s_waitcnt vmcnt(0)
    v_cmp_ne_u32 vcc, s8, v193
    s_cmp_ge_u32 s16, 60000
    s_cbranch_scc1 K4_SL1_X
    s_and_b64 vcc, vcc, exec
    s_cbranch_scc0 K4_SL1_X
    s_mov_b64 exec, vcc
    s_branch K4_SL1
K4_SL1_X:
    s_mov_b64 exec, -1
    s_branch K4_RET1
K4_SLOW2:
    s_mov_b32 s16, 0
K4_SL2:
    buffer_load_dword v250, v249, s[28:31], s66 offen sc1
    s_add_u32 s16, s16, 1
    s_waitcnt vmcnt(0)
    v_cmp_ne_u32 vcc, s8, v250
    s_cmp_ge_u32 s16, 60000
    s_cbranch_scc1 K4_SL2_X
    s_and_b64 vcc, vcc, exec
    s_cbranch_scc0 K4_SL2_X
    s_mov_b64 exec, vcc
    s_branch K4_SL2
K4_SL2_X:
    s_mov_b64 exec, -1
    s_branch K4_RET2
K4_SLOW3:
    s_mov_b32 s16, 0
K4_SL3:
    buffer_load_dword v250, v249, s[28:31], s67 offen sc1
    s_add_u32 s16, s16, 1
    s_waitcnt vmcnt(0)
    v_cmp_ne_u32 vcc, s8, v250
    s_cmp_ge_u32 s16, 60000
    s_cbranch_scc1 K4_SL3_X
    s_and_b64 vcc, vcc, exec
    s_cbranch_scc0 K4_SL3_X
    s_mov_b64 exec, vcc
    s_branch K4_SL3
K4_SL3_X:
    s_mov_b64 exec, -1
    s_branch K4_RET3
K4_SLOW4:
    s_mov_b32 s16, 0
K4_SL4:
    buffer_load_dword v250, v249, s[28:31], s68 offen sc1
    s_add_u32 s16, s16, 1
    s_waitcnt vmcnt(0)
    v_cmp_ne_u32 vcc, s8, v250
    s_cmp_ge_u32 s16, 60000
    s_cbranch_scc1 K4_SL4_X
    s_and_b64 vcc, vcc, exec
    s_cbranch_scc0 K4_SL4_X
    s_mov_b64 exec, vcc
    s_branch K4_SL4
K4_SL4_X:
    s_mov_b64 exec, -1
    s_branch K4_RET4
K4_SLOW5:
    s_mov_b32 s16, 0
K4_SL5:
    buffer_load_dword v250, v245, s[28:31], 0 offen sc1
    s_add_u32 s16, s16, 1
    s_waitcnt vmcnt(0)
    v_cmp_ne_u32 vcc, s8, v250
    s_cmp_ge_u32 s16, 60000
    s_cbranch_scc1 K4_SL5_X
    s_and_b64 vcc, vcc, exec
    s_cbranch_scc0 K4_SL5_X
    s_mov_b64 exec, vcc
    s_branch K4_SL5
K4_SL5_X:
    s_mov_b64 exec, -1
    s_branch K4_RET5
CODE_END:
    s_nop 0
.section .rodata,"a"
.p2align 6
.amdhsa_kernel adaLN_cond__ssm_conv_s4__glu_gated_reglu__prompt_kernel
  .amdhsa_next_free_vgpr 512
  .amdhsa_next_free_sgpr 70
  .amdhsa_accum_offset 256
  .amdhsa_group_segment_fixed_size 0
  .amdhsa_kernarg_size 144
  .amdhsa_user_sgpr_count 2
  .amdhsa_user_sgpr_kernarg_segment_ptr 1
  .amdhsa_system_sgpr_workgroup_id_x 1
  .amdhsa_float_denorm_mode_32 3
  .amdhsa_float_denorm_mode_16_64 3
.end_amdhsa_kernel
```
